```python
import torch

def _softmax(x, axis=-1):
    return torch.softmax(x, dim=axis)
def _gelu(x):
    return torch.nn.functional.gelu(x, approximate="tanh")
def _silu(x):
    return torch.nn.functional.silu(x)
def _sigmoid(x):
    return torch.sigmoid(x)
def _layernorm(x, axis=-1, eps=1e-5):
    m = x.mean(dim=axis, keepdim=True)
    v = x.var(dim=axis, keepdim=True, unbiased=False)
    return (x - m) / torch.sqrt(v + eps)
def _scatter_add(tgt, idx, src, axis=0):
    return tgt.clone().index_add_(axis, idx, src)
def _segment_sum(src, seg, n):
    out = torch.zeros((n,) + src.shape[1:], dtype=src.dtype)
    return out.index_add_(0, seg, src)
def _pad(x, pw):
    flat = tuple(v for pair in reversed(pw) for v in pair)
    return torch.nn.functional.pad(x, flat)

kernel_name = 'interleave_layers__spectral_gfnet__mixer_channel_mlp__prompt'

def setup_inputs():

    _w = (lambda a: (lambda t: t.to(torch.bfloat16) if t.is_floating_point() else t)(torch.as_tensor(a)))
    def _A_setup():
        B, S, D = 1, 2048, 512
        Df = D // 2 + 1
        return {
            "x": _w((lambda *s: torch.randn(*s, dtype=torch.bfloat16) * 0.05)(B, S, D)),
            "w_r": _w((lambda *s: torch.randn(*s, dtype=torch.bfloat16) * 0.8)(S, Df) * 0.02),
            "w_i": _w((lambda *s: torch.randn(*s, dtype=torch.bfloat16) * 0.8)(S, Df) * 0.02),
        }
    _A_in = _A_setup()

    def _B_setup():
        B, S, D, F = 1, 2048, 512, 1792
        return {
            "x": _w((lambda *s: torch.randn(*s, dtype=torch.bfloat16) * 0.05)(B, S, D)),
            "w1": _w((lambda *s: torch.randn(*s, dtype=torch.bfloat16) * 0.8)(D, F) * (D ** -0.5)),
            "b1": _w((lambda *s: torch.randn(*s, dtype=torch.bfloat16) * 0.4)(F)),
            "w2": _w((lambda *s: torch.randn(*s, dtype=torch.bfloat16) * 0.05)(F, D) * (F ** -0.5)),
            "b2": _w((lambda *s: torch.randn(*s, dtype=torch.bfloat16) * 0.05)(D)),
        }
    _B_in = _B_setup()

    return {
        "A_x": _A_in["x"],
        "A_w_r": _A_in["w_r"],
        "A_w_i": _A_in["w_i"],
        "B_x": _B_in["x"],
        "B_w1": _B_in["w1"],
        "B_b1": _B_in["b1"],
        "B_w2": _B_in["w2"],
        "B_b2": _B_in["b2"],
    }

def reference(A_x, A_w_r, A_w_i, B_x, B_w1, B_b1, B_w2, B_b2):
    def _A_ref(x, w_r, w_i):
        B, S, D = x.shape
        X = (lambda x, axes=(-2,-1): torch.fft.rfft2(x.float(), dim=axes))(x, axes=(-2, -1))
        W = w_r + 1j * w_i
        X = X * W
        y = (lambda x, s, axes=(-2,-1): torch.fft.irfft2(x, s=s, dim=axes).to(torch.bfloat16))(X, (S, D), axes=(-2, -1))
        return y

    def _B_ref(x, w1, b1, w2, b2):
        y = _layernorm(x, axis=-1)
        h = _gelu(torch.einsum("bsd,df->bsf", y, w1) + b1)
        return torch.einsum("bsf,fd->bsd", h, w2) + b2

    x = A_x
    x = x + _A_ref(_layernorm(x, axis=-1), A_w_r, A_w_i)
    x = x + _B_ref(_layernorm(x, axis=-1), B_w1, B_b1, B_w2, B_b2)
    x = x + _A_ref(_layernorm(x, axis=-1), A_w_r, A_w_i)
    x = x + _B_ref(_layernorm(x, axis=-1), B_w1, B_b1, B_w2, B_b2)
    return x
```

```asm
; @launch kernel=interleave_layers__spectral_gfnet__mixer_channel_mlp__prompt_kernel grid=(256,1,1) block=(256,1,1) lds=163840
.amdgcn_target "amdgcn-amd-amdhsa--gfx950"
.text
.globl interleave_layers__spectral_gfnet__mixer_channel_mlp__prompt_kernel
.p2align 8
.type interleave_layers__spectral_gfnet__mixer_channel_mlp__prompt_kernel,@function
interleave_layers__spectral_gfnet__mixer_channel_mlp__prompt_kernel:
    s_cmp_ge_u32 s2, 256
    s_cbranch_scc1 MAIN_END
    s_load_dwordx16 s[16:31], s[0:1], 0
    s_load_dwordx2 s[4:5], s[0:1], 80
    s_load_dwordx2 s[44:45], s[0:1], 64
    s_load_dwordx2 s[40:41], s[0:1], 56
    s_cmp_lt_u32 s2, 240
    s_cbranch_scc1 PRE_NOPF
    s_getpc_b64 s[12:13]
PRE_PC:
    s_bfe_u32 s42, s2, 0x10003
    s_lshl_b32 s42, s42, 15
    v_lshl_add_u32 v20, v0, 7, s42
    v_min_u32 v20, CODE_END-PRE_PC-4, v20
    v_mov_b32 v21, s13
    v_add_co_u32 v20, vcc, s12, v20
    s_nop 1
    v_addc_co_u32 v21, vcc, 0, v21, vcc
    global_load_dword v2, v[20:21], off
PRE_NOPF:
    v_lshrrev_b32 v10, 6, v0
    v_and_b32 v1, 63, v0
    v_readfirstlane_b32 s3, v10
    v_lshlrev_b32 v20, 4, v1
    s_mov_b32 s11, 0x20000
    s_mul_i32 s43, s3, 8704
    s_mov_b64 vcc, 0
    s_cmp_lt_u32 s2, 64
    s_cbranch_scc1 PRE_IN_X
    s_and_b32 s42, s2, 0xc7
    s_sub_u32 s37, s42, 128
    s_cmp_ge_u32 s37, 7
    s_cbranch_scc1 PRE_OTHER
    s_lshl_b32 s37, s37, 3
    s_bfe_u32 s42, s2, 0x30003
    s_add_u32 s37, s37, s42
    s_mul_i32 s38, s3, 458752
    s_lshl_b32 s42, s37, 6
    s_add_u32 s38, s38, s42
    s_add_u32 s39, s38, 229376
    s_lshl_b32 s43, s3, 13
    v_bfe_u32 v20, v0, 2, 4
    v_mul_u32_u24 v20, 3584, v20
    v_lshrrev_b32 v21, 4, v0
    v_xor_b32 v21, v0, v21
    v_and_b32_e64 v21, 3, v21
    v_lshl_add_u32 v20, v21, 4, v20
    s_lshl_b32 s37, s37, 2
    s_add_u32 s37, s37, s3
    s_mov_b32 s10, 0x1c0000
    s_waitcnt lgkmcnt(0)
    s_mov_b64 s[8:9], s[24:25]
    s_mov_b32 s19, 2
    s_mov_b32 s20, s43
    s_mov_b32 s21, 1024
    s_mov_b32 s22, 57344
    v_bfe_u32 v21, v0, 2, 4
    v_mul_u32_u24 v21, 3584, v21
    v_and_b32 v22, 3, v0
    v_lshl_add_u32 v21, v22, 7, v21
    s_and_b32 s42, s37, 31
    s_mul_i32 s42, s42, 57344
    s_lshr_b32 s23, s37, 5
    s_lshl_b32 s23, s23, 9
    s_add_u32 s42, s42, s23
    buffer_load_dword v2, v21, s[8:11], s42 offen
    s_branch PRE_CONST
PRE_IN_X:
    s_and_b32 s38, s2, 32
    s_lshl_b32 s38, s38, 4
    s_and_b32 s42, s2, 8
    s_lshl_b32 s42, s42, 7
    s_add_u32 s38, s38, s42
    s_and_b32 s42, s2, 16
    s_add_u32 s38, s38, s42
    s_bfe_u32 s42, s2, 0x20001
    s_lshl_b32 s42, s42, 7
    s_add_u32 s38, s38, s42
    s_and_b32 s42, s2, 1
    s_lshl_b32 s42, s42, 2
    s_add_u32 s42, s42, s3
    s_lshl_b32 s42, s42, 1
    s_add_u32 s38, s38, s42
    s_lshl_b32 s38, s38, 10
    s_add_u32 s39, s38, 1024
    s_mov_b32 s10, 0x200000
    s_waitcnt lgkmcnt(0)
    s_mov_b64 s[8:9], s[16:17]
    s_mov_b32 s19, 0
    s_mov_b32 s20, s43
    s_mov_b32 s21, 1088
    s_mov_b32 s22, 32768
PRE_CONST:
    s_cbranch_vccnz PRE_SK
    s_mov_b32 m0, s20
    s_mov_b32 s42, s38
    s_mov_b32 s23, 0
PRE_RL0:
    buffer_load_dwordx4 v20, s[8:11], s42 offen lds
    s_add_u32 m0, m0, s21
    s_add_u32 s42, s42, s22
    s_add_u32 s23, s23, 1
    s_cmp_eq_u32 s23, 4
    s_cselect_b32 s42, s39, s42
    s_cmp_lt_u32 s23, 8
    s_cbranch_scc1 PRE_RL0
PRE_SK:
    v_and_b32 v6, 15, v0
    v_lshrrev_b32 v7, 4, v1
    v_lshlrev_b32_e64 v1, 4, v1
    s_mov_b32 s6, 0x2400000
    s_mov_b32 s7, 0x20000
    s_mov_b32 s46, 0x05040100
    s_mov_b32 s47, 0x07060302
    s_mov_b32 s49, s2
    s_mov_b32 s32, 0x00010001
    s_mov_b32 s33, s32
    s_mov_b32 s34, 0xff00ff00
    s_mov_b32 s35, s34
    s_cmp_eq_u32 s19, 2
    s_cselect_b32 s36, 0, 0x3d3504f3
    v_cvt_f32_u32 v8, v6
    v_lshlrev_b32 v11, 2, v7
    v_cvt_f32_u32 v9, v11
    v_mul_f32 v10, 0x3d000000, v8
    v_mul_f32 v11, v10, v9
    v_cndmask_b32 v12, v10, 0.5, s[32:33]
    v_mov_b32 v14, 0x3e800000
    v_cndmask_b32 v14, v14, 0, s[32:33]
    v_fma_f32 v13, v12, v9, v14
    v_fmamk_f32 v148, v10, 0x00000000, v11
    v_fmamk_f32 v156, v12, 0x00000000, v13
    v_fmamk_f32 v149, v10, 0x3f800000, v11
    v_fmamk_f32 v157, v12, 0x3f800000, v13
    v_fmamk_f32 v150, v10, 0x40000000, v11
    v_fmamk_f32 v158, v12, 0x40000000, v13
    v_fmamk_f32 v151, v10, 0x40400000, v11
    v_fmamk_f32 v159, v12, 0x40400000, v13
    v_fmamk_f32 v152, v10, 0x41800000, v11
    v_fmamk_f32 v160, v12, 0x41800000, v13
    v_fmamk_f32 v153, v10, 0x41880000, v11
    v_fmamk_f32 v161, v12, 0x41880000, v13
    v_fmamk_f32 v154, v10, 0x41900000, v11
    v_fmamk_f32 v162, v12, 0x41900000, v13
    v_fmamk_f32 v155, v10, 0x41980000, v11
    v_fmamk_f32 v163, v12, 0x41980000, v13
    v_cos_f32 v148, v148
    v_cos_f32 v149, v149
    v_cos_f32 v150, v150
    v_cos_f32 v151, v151
    v_cos_f32 v152, v152
    v_cos_f32 v153, v153
    v_cos_f32 v154, v154
    v_cos_f32 v155, v155
    v_cos_f32 v156, v156
    v_cos_f32 v157, v157
    v_cos_f32 v158, v158
    v_cos_f32 v159, v159
    v_cos_f32 v160, v160
    v_cos_f32 v161, v161
    v_cos_f32 v162, v162
    v_cos_f32 v163, v163
    v_cvt_pk_bf16_f32 v116, v148, v149
    v_cvt_pk_bf16_f32 v120, v156, v157
    v_cvt_pk_bf16_f32 v117, v150, v151
    v_cvt_pk_bf16_f32 v121, v158, v159
    v_cvt_pk_bf16_f32 v118, v152, v153
    v_cvt_pk_bf16_f32 v122, v160, v161
    v_cvt_pk_bf16_f32 v119, v154, v155
    v_cvt_pk_bf16_f32 v123, v162, v163
    v_mul_f32 v10, 0x3b000000, v8
    v_mul_f32 v11, 0x3d800000, v8
    v_add_f32 v12, 0xbef00000, v11
    v_cndmask_b32 v12, v11, v12, s[34:35]
    v_cndmask_b32 v12, v12, 0.5, s[32:33]
    v_mov_b32 v14, 0x3d800000
    v_cndmask_b32 v13, v14, 0, s[32:33]
    v_mov_b32 v17, 0x3d3504f3
    v_cndmask_b32 v14, v14, v17, s[32:33]
    v_cndmask_b32 v15, 0, 16, s[34:35]
    v_mov_b32 v16, 0x80008000
    v_cndmask_b32 v16, 0, v16, s[34:35]
    v_add_f32 v160, 0x00000000, v9
    v_mul_f32 v148, v160, v10
    v_mul_f32 v152, v160, v11
    v_mul_f32 v156, v160, v12
    v_add_f32 v161, 0x3f800000, v9
    v_mul_f32 v149, v161, v10
    v_mul_f32 v153, v161, v11
    v_mul_f32 v157, v161, v12
    v_add_f32 v162, 0x40000000, v9
    v_mul_f32 v150, v162, v10
    v_mul_f32 v154, v162, v11
    v_mul_f32 v158, v162, v12
    v_add_f32 v163, 0x40400000, v9
    v_mul_f32 v151, v163, v10
    v_mul_f32 v155, v163, v11
    v_mul_f32 v159, v163, v12
    v_cos_f32 v140, v148
    v_sin_f32 v144, v148
    v_cos_f32 v164, v152
    v_sin_f32 v168, v152
    v_cos_f32 v132, v156
    v_sin_f32 v136, v156
    v_cos_f32 v141, v149
    v_sin_f32 v145, v149
    v_cos_f32 v165, v153
    v_sin_f32 v169, v153
    v_cos_f32 v133, v157
    v_sin_f32 v137, v157
    v_cos_f32 v142, v150
    v_sin_f32 v146, v150
    v_cos_f32 v166, v154
    v_sin_f32 v170, v154
    v_cos_f32 v134, v158
    v_sin_f32 v138, v158
    v_cos_f32 v143, v151
    v_sin_f32 v147, v151
    v_cos_f32 v167, v155
    v_sin_f32 v171, v155
    v_cos_f32 v135, v159
    s_cbranch_vccz PRE_NL
    s_mov_b32 m0, s20
    s_mov_b32 s42, s38
    s_mov_b32 s23, 0
PRE_RL1:
    buffer_load_dwordx4 v20, s[8:11], s42 offen lds
    s_add_u32 m0, m0, s21
    s_add_u32 s42, s42, s22
    s_add_u32 s23, s23, 1
    s_cmp_eq_u32 s23, 4
    s_cselect_b32 s42, s39, s42
    s_cmp_lt_u32 s23, 8
    s_cbranch_scc1 PRE_RL1
PRE_NL:
    v_sin_f32 v139, v159
    v_mov_b32 v17, s36
    v_mul_f32 v140, v140, v13
    v_mul_f32 v144, v144, v13
    v_cvt_pk_bf16_f32 v124, v164, v168
    v_cvt_pk_bf16_f32 v128, -v168, v164
    v_xor_b32 v128, v128, v16
    v_mul_f32_e64 v132, v132, v14
    v_mul_f32 v136, 0xbd800000, v136
    v_cndmask_b32 v136, v136, v17, s[32:33]
    v_cvt_pk_bf16_f32 v132, v132, 0
    v_cvt_pk_bf16_f32 v136, v136, 0
    v_lshlrev_b32 v132, v15, v132
    v_lshlrev_b32 v136, v15, v136
    v_mul_f32 v141, v141, v13
    v_mul_f32 v145, v145, v13
    v_cvt_pk_bf16_f32 v125, v165, v169
    v_cvt_pk_bf16_f32 v129, -v169, v165
    v_xor_b32 v129, v129, v16
    v_mul_f32 v133, v133, v14
    v_mul_f32 v137, 0xbd800000, v137
    v_cndmask_b32 v137, v137, v17, s[32:33]
    v_cvt_pk_bf16_f32 v133, v133, 0
    v_cvt_pk_bf16_f32 v137, v137, 0
    v_lshlrev_b32 v133, v15, v133
    v_lshlrev_b32 v137, v15, v137
    v_mul_f32 v142, v142, v13
    v_mul_f32 v146, v146, v13
    v_cvt_pk_bf16_f32 v126, v166, v170
    v_cvt_pk_bf16_f32 v130, -v170, v166
    v_xor_b32 v130, v130, v16
    v_mul_f32 v134, v134, v14
    v_mul_f32 v138, 0xbd800000, v138
    v_cndmask_b32 v138, v138, v17, s[32:33]
    v_cvt_pk_bf16_f32 v134, v134, 0
    v_cvt_pk_bf16_f32 v138, v138, 0
    v_lshlrev_b32 v134, v15, v134
    v_lshlrev_b32 v138, v15, v138
    v_mul_f32 v143, v143, v13
    v_mul_f32 v147, v147, v13
    v_cvt_pk_bf16_f32 v127, v167, v171
    v_cvt_pk_bf16_f32 v131, -v171, v167
    v_xor_b32 v131, v131, v16
    v_mul_f32 v135, v135, v14
    v_mul_f32 v139, 0xbd800000, v139
    v_cndmask_b32 v139, v139, v17, s[32:33]
    v_cvt_pk_bf16_f32 v135, v135, 0
    v_cvt_pk_bf16_f32 v139, v139, 0
    v_lshlrev_b32 v135, v15, v135
    v_lshlrev_b32 v139, v15, v139
    v_mov_b32 v196, 0
    v_mov_b32 v197, 0
    v_mov_b32 v198, 0
    v_mov_b32 v199, 0
    v_mov_b32 v200, 0
    v_mov_b32 v201, 0
    v_mov_b32 v202, 0
    v_mov_b32 v203, 0
    v_mov_b32 v204, 0
    v_mov_b32 v205, 0
    v_mov_b32 v206, 0
    v_mov_b32 v207, 0
    v_mov_b32 v208, 0
    v_mov_b32 v209, 0
    v_mov_b32 v210, 0
    v_mov_b32 v211, 0
    v_mov_b32 v212, 0
    v_mov_b32 v213, 0
    v_mov_b32 v214, 0
    v_mov_b32 v215, 0
    v_mov_b32 v216, 0
    v_mov_b32 v217, 0
    v_mov_b32 v218, 0
    v_mov_b32 v219, 0
    v_mov_b32 v220, 0
    v_mov_b32 v221, 0
    v_mov_b32 v222, 0
    v_mov_b32 v223, 0
    v_mov_b32 v224, 0
    v_mov_b32 v225, 0
    v_mov_b32 v226, 0
    v_mov_b32 v227, 0
    s_cmp_eq_u32 s19, 2
    s_cbranch_scc1 PRE_A_W1
    v_lshrrev_b32 v10, 1, v1
    v_add_u32_e64 v10, s43, v10
    s_waitcnt vmcnt(0)
    ds_read_b64_tr_b16 v[20:21], v10 offset:0
    ds_read_b64_tr_b16 v[22:23], v10 offset:512
    ds_read_b64_tr_b16 v[24:25], v10 offset:1088
    ds_read_b64_tr_b16 v[26:27], v10 offset:1600
    ds_read_b64_tr_b16 v[28:29], v10 offset:2176
    ds_read_b64_tr_b16 v[30:31], v10 offset:2688
    ds_read_b64_tr_b16 v[32:33], v10 offset:3264
    ds_read_b64_tr_b16 v[34:35], v10 offset:3776
    ds_read_b64_tr_b16 v[36:37], v10 offset:4352
    ds_read_b64_tr_b16 v[38:39], v10 offset:4864
    ds_read_b64_tr_b16 v[40:41], v10 offset:5440
    ds_read_b64_tr_b16 v[42:43], v10 offset:5952
    ds_read_b64_tr_b16 v[44:45], v10 offset:6528
    ds_read_b64_tr_b16 v[46:47], v10 offset:7040
    ds_read_b64_tr_b16 v[48:49], v10 offset:7616
    ds_read_b64_tr_b16 v[50:51], v10 offset:8128
    s_branch PRE_CORE
PRE_A_W1:
    v_lshrrev_b32 v11, 2, v6
    v_xor_b32 v11, s3, v11
    v_lshlrev_b32 v11, 4, v11
    v_lshl_add_u32 v10, v6, 6, v11
    v_lshl_add_u32 v10, v7, 12, v10
    s_waitcnt vmcnt(0)
    s_barrier
    ds_read_b128 v[52:55], v10 offset:0
    ds_read_b128 v[56:59], v10 offset:1024
    ds_read_b128 v[60:63], v10 offset:2048
    ds_read_b128 v[64:67], v10 offset:3072
    ds_read_b128 v[68:71], v10 offset:16384
    ds_read_b128 v[72:75], v10 offset:17408
    ds_read_b128 v[76:79], v10 offset:18432
    ds_read_b128 v[80:83], v10 offset:19456
    s_waitcnt lgkmcnt(6)
    v_perm_b32 v20, v56, v52, s46
    s_waitcnt lgkmcnt(4)
    v_perm_b32 v21, v64, v60, s46
    s_waitcnt lgkmcnt(2)
    v_perm_b32 v22, v72, v68, s46
    s_waitcnt lgkmcnt(0)
    v_perm_b32 v23, v80, v76, s46
    v_perm_b32 v24, v56, v52, s47
    v_perm_b32 v25, v64, v60, s47
    v_perm_b32 v26, v72, v68, s47
    v_perm_b32 v27, v80, v76, s47
    v_perm_b32 v28, v57, v53, s46
    v_perm_b32 v29, v65, v61, s46
    v_perm_b32 v30, v73, v69, s46
    v_perm_b32 v31, v81, v77, s46
    v_perm_b32 v32, v57, v53, s47
    v_perm_b32 v33, v65, v61, s47
    v_perm_b32 v34, v73, v69, s47
    v_perm_b32 v35, v81, v77, s47
    v_perm_b32 v36, v58, v54, s46
    v_perm_b32 v37, v66, v62, s46
    v_perm_b32 v38, v74, v70, s46
    v_perm_b32 v39, v82, v78, s46
    v_perm_b32 v40, v58, v54, s47
    v_perm_b32 v41, v66, v62, s47
    v_perm_b32 v42, v74, v70, s47
    v_perm_b32 v43, v82, v78, s47
    v_perm_b32 v44, v59, v55, s46
    v_perm_b32 v45, v67, v63, s46
    v_perm_b32 v46, v75, v71, s46
    v_perm_b32 v47, v83, v79, s46
    v_perm_b32 v48, v59, v55, s47
    v_perm_b32 v49, v67, v63, s47
    v_perm_b32 v50, v75, v71, s47
    v_perm_b32 v51, v83, v79, s47
PRE_CORE:
    s_waitcnt lgkmcnt(14)
    v_mfma_f32_16x16x32_bf16 v[52:55], v[20:23], v[116:119], 0
    s_lshl_b32 s49, s49, 7
    s_add_u32 s49, s49, 0x1000000
    v_mfma_f32_16x16x32_bf16 v[56:59], v[20:23], v[120:123], 0
    s_mov_b32 s42, 0xbc8000
    v_lshrrev_b32 v4, 2, v1
    v_mov_b32_e64 v164, 0
    s_waitcnt lgkmcnt(12)
    v_mfma_f32_16x16x32_bf16 v[60:63], v[24:27], v[116:119], 0
    buffer_load_dword v3, v164, s[4:7], s42 offen sc1
    v_mfma_f32_16x16x32_bf16 v[64:67], v[24:27], v[120:123], 0
    s_lshl_b32 s42, s3, 8
    s_add_u32 s42, s42, s2
    s_waitcnt lgkmcnt(10)
    v_mfma_f32_16x16x32_bf16 v[68:71], v[28:31], v[116:119], 0
    s_lshl_b32 s42, s42, 7
    s_add_u32 s42, s42, 0x1080000
    v_mfma_f32_16x16x32_bf16 v[72:75], v[28:31], v[120:123], 0
    s_lshl_b32 s48, s2, 7
    s_add_u32 s48, s48, 0xbc0000
    s_waitcnt lgkmcnt(8)
    v_mfma_f32_16x16x32_bf16 v[76:79], v[32:35], v[116:119], 0
    s_mov_b32 exec_hi, 0
    buffer_store_dword v164, v4, s[4:7], s42 offen sc1
    s_mov_b32 exec_hi, -1
    v_mfma_f32_16x16x32_bf16 v[80:83], v[32:35], v[120:123], 0
    s_cmp_eq_u32 s3, 0
    s_cselect_b32 s42, s49, s42
    s_waitcnt lgkmcnt(6)
    v_mfma_f32_16x16x32_bf16 v[84:87], v[36:39], v[116:119], 0
    s_cmp_lt_u32 s2, 64
    s_cselect_b32 s48, s48, s42
    v_mfma_f32_16x16x32_bf16 v[88:91], v[36:39], v[120:123], 0
    s_cmp_eq_u32 s3, 1
    s_cselect_b32 s42, s48, s42
    s_waitcnt lgkmcnt(4)
    v_mfma_f32_16x16x32_bf16 v[92:95], v[40:43], v[116:119], 0
    s_mov_b32 exec_hi, 0
    buffer_store_dword v164, v4, s[4:7], s42 offen sc1
    s_mov_b32 exec_hi, -1
    v_mfma_f32_16x16x32_bf16 v[96:99], v[40:43], v[120:123], 0
    s_waitcnt lgkmcnt(2)
    v_mfma_f32_16x16x32_bf16 v[100:103], v[44:47], v[116:119], 0
    v_mfma_f32_16x16x32_bf16 v[104:107], v[44:47], v[120:123], 0
    s_waitcnt lgkmcnt(0)
    v_mfma_f32_16x16x32_bf16 v[108:111], v[48:51], v[116:119], 0
    v_mfma_f32_16x16x32_bf16 v[112:115], v[48:51], v[120:123], 0
    s_mov_b64 exec, s[32:33]
    v_cvt_pk_bf16_f32 v196, v52, v56
    v_cvt_pk_bf16_f32 v197, v53, v57
    v_cvt_pk_bf16_f32 v198, v54, v58
    v_cvt_pk_bf16_f32 v199, v55, v59
    v_cvt_pk_bf16_f32 v200, v60, v64
    v_cvt_pk_bf16_f32 v201, v61, v65
    v_cvt_pk_bf16_f32 v202, v62, v66
    v_cvt_pk_bf16_f32 v203, v63, v67
    v_cvt_pk_bf16_f32 v204, v68, v72
    v_cvt_pk_bf16_f32 v205, v69, v73
    v_cvt_pk_bf16_f32 v206, v70, v74
    v_cvt_pk_bf16_f32 v207, v71, v75
    v_cvt_pk_bf16_f32 v208, v76, v80
    v_cvt_pk_bf16_f32 v209, v77, v81
    v_cvt_pk_bf16_f32 v210, v78, v82
    v_cvt_pk_bf16_f32 v211, v79, v83
    v_cvt_pk_bf16_f32 v212, v84, v88
    v_cvt_pk_bf16_f32 v213, v85, v89
    v_cvt_pk_bf16_f32 v214, v86, v90
    v_cvt_pk_bf16_f32 v215, v87, v91
    v_cvt_pk_bf16_f32 v216, v92, v96
    v_cvt_pk_bf16_f32 v217, v93, v97
    v_cvt_pk_bf16_f32 v218, v94, v98
    v_cvt_pk_bf16_f32 v219, v95, v99
    v_cvt_pk_bf16_f32 v220, v100, v104
    v_cvt_pk_bf16_f32 v221, v101, v105
    v_cvt_pk_bf16_f32 v222, v102, v106
    v_cvt_pk_bf16_f32 v223, v103, v107
    v_cvt_pk_bf16_f32 v224, v108, v112
    v_cvt_pk_bf16_f32 v225, v109, v113
    v_cvt_pk_bf16_f32 v226, v110, v114
    v_cvt_pk_bf16_f32 v227, v111, v115
    s_mov_b64 exec, -1
    v_pk_mul_f32 v[148:149], v[56:57], v[144:145]
    v_pk_mul_f32 v[152:153], v[52:53], v[144:145]
    v_pk_mul_f32 v[150:151], v[58:59], v[146:147]
    v_pk_mul_f32 v[154:155], v[54:55], v[146:147]
    v_pk_fma_f32 v[148:149], v[52:53], v[140:141], v[148:149]
    v_pk_fma_f32 v[152:153], v[56:57], v[140:141], v[152:153] neg_lo:[0,0,1] neg_hi:[0,0,1]
    v_pk_fma_f32 v[150:151], v[54:55], v[142:143], v[150:151]
    v_pk_fma_f32 v[154:155], v[58:59], v[142:143], v[154:155] neg_lo:[0,0,1] neg_hi:[0,0,1]
    v_cvt_pk_bf16_f32 v20, v148, v152
    v_cvt_pk_bf16_f32 v21, v149, v153
    v_cvt_pk_bf16_f32 v22, v150, v154
    v_cvt_pk_bf16_f32 v23, v151, v155
    v_pk_mul_f32 v[156:157], v[64:65], v[144:145]
    v_pk_mul_f32 v[160:161], v[60:61], v[144:145]
    v_pk_mul_f32 v[158:159], v[66:67], v[146:147]
    v_pk_mul_f32 v[162:163], v[62:63], v[146:147]
    v_pk_fma_f32 v[156:157], v[60:61], v[140:141], v[156:157]
    v_pk_fma_f32 v[160:161], v[64:65], v[140:141], v[160:161] neg_lo:[0,0,1] neg_hi:[0,0,1]
    v_pk_fma_f32 v[158:159], v[62:63], v[142:143], v[158:159]
    v_pk_fma_f32 v[162:163], v[66:67], v[142:143], v[162:163] neg_lo:[0,0,1] neg_hi:[0,0,1]
    v_cvt_pk_bf16_f32 v24, v156, v160
    v_cvt_pk_bf16_f32 v25, v157, v161
    v_cvt_pk_bf16_f32 v26, v158, v162
    v_cvt_pk_bf16_f32 v27, v159, v163
    v_pk_mul_f32 v[148:149], v[72:73], v[144:145]
    v_pk_mul_f32 v[152:153], v[68:69], v[144:145]
    v_pk_mul_f32 v[150:151], v[74:75], v[146:147]
    v_pk_mul_f32 v[154:155], v[70:71], v[146:147]
    v_pk_fma_f32 v[148:149], v[68:69], v[140:141], v[148:149]
    v_pk_fma_f32 v[152:153], v[72:73], v[140:141], v[152:153] neg_lo:[0,0,1] neg_hi:[0,0,1]
    v_pk_fma_f32 v[150:151], v[70:71], v[142:143], v[150:151]
    v_pk_fma_f32 v[154:155], v[74:75], v[142:143], v[154:155] neg_lo:[0,0,1] neg_hi:[0,0,1]
    v_cvt_pk_bf16_f32 v28, v148, v152
    v_cvt_pk_bf16_f32 v29, v149, v153
    v_cvt_pk_bf16_f32 v30, v150, v154
    v_cvt_pk_bf16_f32 v31, v151, v155
    v_pk_mul_f32 v[156:157], v[80:81], v[144:145]
    v_pk_mul_f32 v[160:161], v[76:77], v[144:145]
    v_pk_mul_f32 v[158:159], v[82:83], v[146:147]
    v_pk_mul_f32 v[162:163], v[78:79], v[146:147]
    v_pk_fma_f32 v[156:157], v[76:77], v[140:141], v[156:157]
    v_pk_fma_f32 v[160:161], v[80:81], v[140:141], v[160:161] neg_lo:[0,0,1] neg_hi:[0,0,1]
    v_pk_fma_f32 v[158:159], v[78:79], v[142:143], v[158:159]
    v_pk_fma_f32 v[162:163], v[82:83], v[142:143], v[162:163] neg_lo:[0,0,1] neg_hi:[0,0,1]
    v_cvt_pk_bf16_f32 v32, v156, v160
    v_cvt_pk_bf16_f32 v33, v157, v161
    v_cvt_pk_bf16_f32 v34, v158, v162
    v_cvt_pk_bf16_f32 v35, v159, v163
    v_pk_mul_f32 v[148:149], v[88:89], v[144:145]
    v_pk_mul_f32 v[152:153], v[84:85], v[144:145]
    v_pk_mul_f32 v[150:151], v[90:91], v[146:147]
    v_pk_mul_f32 v[154:155], v[86:87], v[146:147]
    v_pk_fma_f32 v[148:149], v[84:85], v[140:141], v[148:149]
    v_pk_fma_f32 v[152:153], v[88:89], v[140:141], v[152:153] neg_lo:[0,0,1] neg_hi:[0,0,1]
    v_pk_fma_f32 v[150:151], v[86:87], v[142:143], v[150:151]
    v_pk_fma_f32 v[154:155], v[90:91], v[142:143], v[154:155] neg_lo:[0,0,1] neg_hi:[0,0,1]
    v_cvt_pk_bf16_f32 v36, v148, v152
    v_cvt_pk_bf16_f32 v37, v149, v153
    v_cvt_pk_bf16_f32 v38, v150, v154
    v_cvt_pk_bf16_f32 v39, v151, v155
    v_pk_mul_f32 v[156:157], v[96:97], v[144:145]
    v_pk_mul_f32 v[160:161], v[92:93], v[144:145]
    v_pk_mul_f32 v[158:159], v[98:99], v[146:147]
    v_pk_mul_f32 v[162:163], v[94:95], v[146:147]
    v_pk_fma_f32 v[156:157], v[92:93], v[140:141], v[156:157]
    v_pk_fma_f32 v[160:161], v[96:97], v[140:141], v[160:161] neg_lo:[0,0,1] neg_hi:[0,0,1]
    v_pk_fma_f32 v[158:159], v[94:95], v[142:143], v[158:159]
    v_pk_fma_f32 v[162:163], v[98:99], v[142:143], v[162:163] neg_lo:[0,0,1] neg_hi:[0,0,1]
    v_cvt_pk_bf16_f32 v40, v156, v160
    v_cvt_pk_bf16_f32 v41, v157, v161
    v_cvt_pk_bf16_f32 v42, v158, v162
    v_cvt_pk_bf16_f32 v43, v159, v163
    v_pk_mul_f32 v[148:149], v[104:105], v[144:145]
    v_pk_mul_f32 v[152:153], v[100:101], v[144:145]
    v_pk_mul_f32 v[150:151], v[106:107], v[146:147]
    v_pk_mul_f32 v[154:155], v[102:103], v[146:147]
    v_pk_fma_f32 v[148:149], v[100:101], v[140:141], v[148:149]
    v_pk_fma_f32 v[152:153], v[104:105], v[140:141], v[152:153] neg_lo:[0,0,1] neg_hi:[0,0,1]
    v_pk_fma_f32 v[150:151], v[102:103], v[142:143], v[150:151]
    v_pk_fma_f32 v[154:155], v[106:107], v[142:143], v[154:155] neg_lo:[0,0,1] neg_hi:[0,0,1]
    v_cvt_pk_bf16_f32 v44, v148, v152
    v_cvt_pk_bf16_f32 v45, v149, v153
    v_cvt_pk_bf16_f32 v46, v150, v154
    v_cvt_pk_bf16_f32 v47, v151, v155
    v_pk_mul_f32 v[156:157], v[112:113], v[144:145]
    v_pk_mul_f32 v[160:161], v[108:109], v[144:145]
    v_pk_mul_f32 v[158:159], v[114:115], v[146:147]
    v_pk_mul_f32 v[162:163], v[110:111], v[146:147]
    v_pk_fma_f32 v[156:157], v[108:109], v[140:141], v[156:157]
    v_pk_fma_f32 v[160:161], v[112:113], v[140:141], v[160:161] neg_lo:[0,0,1] neg_hi:[0,0,1]
    v_pk_fma_f32 v[158:159], v[110:111], v[142:143], v[158:159]
    v_pk_fma_f32 v[162:163], v[114:115], v[142:143], v[162:163] neg_lo:[0,0,1] neg_hi:[0,0,1]
    v_cvt_pk_bf16_f32 v48, v156, v160
    v_cvt_pk_bf16_f32 v49, v157, v161
    v_cvt_pk_bf16_f32 v50, v158, v162
    v_cvt_pk_bf16_f32 v51, v159, v163
    s_cmp_eq_u32 s19, 0
    s_cbranch_scc0 PRE_OUT_W
    v_mfma_f32_16x16x32_bf16 v[52:55], v[124:127], v[20:23], 0
    v_lshl_add_u32 v10, v7, 6, v6
    v_mul_u32_u24 v10, 144, v10
    v_mfma_f32_16x16x32_bf16 v[52:55], v[132:135], v[196:199], v[52:55]
    s_lshl_b32 s38, s3, 5
    s_add_u32 s42, s38, 40960
    v_mfma_f32_16x16x32_bf16 v[56:59], v[128:131], v[20:23], 0
    v_add_u32 v10, s42, v10
    v_lshrrev_b32 v12, 3, v0
    v_mfma_f32_16x16x32_bf16 v[56:59], v[136:139], v[196:199], v[56:59]
    v_and_b32 v13, 7, v12
    v_and_b32 v12, 0xc0, v0
    v_mfma_f32_16x16x32_bf16 v[60:63], v[124:127], v[24:27], 0
    v_add_u32_e64 v12, v12, v13
    v_and_b32 v13, 0x70, v1
    v_mfma_f32_16x16x32_bf16 v[60:63], v[132:135], v[200:203], v[60:63]
    v_mul_u32_u24 v11, 144, v12
    v_add_u32 v11, v11, v13
    v_mfma_f32_16x16x32_bf16 v[64:67], v[128:131], v[24:27], 0
    v_lshl_add_u32 v12, v12, 13, v13
    s_lshl_b32 s39, s2, 7
    v_mfma_f32_16x16x32_bf16 v[64:67], v[136:139], v[200:203], v[64:67]
    v_mfma_f32_16x16x32_bf16 v[68:71], v[124:127], v[28:31], 0
    v_mfma_f32_16x16x32_bf16 v[68:71], v[132:135], v[204:207], v[68:71]
    v_cvt_pk_bf16_f32 v164, v52, v56
    v_cvt_pk_bf16_f32 v172, v53, v57
    v_mfma_f32_16x16x32_bf16 v[72:75], v[128:131], v[28:31], 0
    v_cvt_pk_bf16_f32 v180, v54, v58
    v_cvt_pk_bf16_f32 v188, v55, v59
    v_mfma_f32_16x16x32_bf16 v[72:75], v[136:139], v[204:207], v[72:75]
    v_mfma_f32_16x16x32_bf16 v[76:79], v[124:127], v[32:35], 0
    v_mfma_f32_16x16x32_bf16 v[76:79], v[132:135], v[208:211], v[76:79]
    v_cvt_pk_bf16_f32 v165, v60, v64
    v_cvt_pk_bf16_f32 v173, v61, v65
    v_mfma_f32_16x16x32_bf16 v[80:83], v[128:131], v[32:35], 0
    v_cvt_pk_bf16_f32 v181, v62, v66
    v_cvt_pk_bf16_f32 v189, v63, v67
    v_mfma_f32_16x16x32_bf16 v[80:83], v[136:139], v[208:211], v[80:83]
    v_mfma_f32_16x16x32_bf16 v[84:87], v[124:127], v[36:39], 0
    v_mfma_f32_16x16x32_bf16 v[84:87], v[132:135], v[212:215], v[84:87]
    v_cvt_pk_bf16_f32 v166, v68, v72
    v_cvt_pk_bf16_f32 v174, v69, v73
    v_mfma_f32_16x16x32_bf16 v[88:91], v[128:131], v[36:39], 0
    v_cvt_pk_bf16_f32 v182, v70, v74
    v_cvt_pk_bf16_f32 v190, v71, v75
    v_mfma_f32_16x16x32_bf16 v[88:91], v[136:139], v[212:215], v[88:91]
    v_mfma_f32_16x16x32_bf16 v[92:95], v[124:127], v[40:43], 0
    v_mfma_f32_16x16x32_bf16 v[92:95], v[132:135], v[216:219], v[92:95]
    v_cvt_pk_bf16_f32 v167, v76, v80
    v_cvt_pk_bf16_f32 v175, v77, v81
    v_mfma_f32_16x16x32_bf16 v[96:99], v[128:131], v[40:43], 0
    v_cvt_pk_bf16_f32 v183, v78, v82
    v_cvt_pk_bf16_f32 v191, v79, v83
    v_mfma_f32_16x16x32_bf16 v[96:99], v[136:139], v[216:219], v[96:99]
    v_mfma_f32_16x16x32_bf16 v[100:103], v[124:127], v[44:47], 0
    ds_write_b128 v10, v[164:167] offset:0
    v_mfma_f32_16x16x32_bf16 v[100:103], v[132:135], v[220:223], v[100:103]
    v_cvt_pk_bf16_f32 v168, v84, v88
    v_cvt_pk_bf16_f32 v176, v85, v89
    v_mfma_f32_16x16x32_bf16 v[104:107], v[128:131], v[44:47], 0
    v_cvt_pk_bf16_f32 v184, v86, v90
    v_cvt_pk_bf16_f32 v192, v87, v91
    ds_write_b128 v10, v[172:175] offset:2304
    v_mfma_f32_16x16x32_bf16 v[104:107], v[136:139], v[220:223], v[104:107]
    ds_write_b128 v10, v[180:183] offset:4608
    v_mfma_f32_16x16x32_bf16 v[108:111], v[124:127], v[48:51], 0
    v_mfma_f32_16x16x32_bf16 v[108:111], v[132:135], v[224:227], v[108:111]
    v_cvt_pk_bf16_f32 v169, v92, v96
    v_cvt_pk_bf16_f32 v177, v93, v97
    ds_write_b128 v10, v[188:191] offset:6912
    v_mfma_f32_16x16x32_bf16 v[112:115], v[128:131], v[48:51], 0
    v_cvt_pk_bf16_f32 v185, v94, v98
    v_cvt_pk_bf16_f32 v193, v95, v99
    v_mfma_f32_16x16x32_bf16 v[112:115], v[136:139], v[224:227], v[112:115]
    v_cvt_pk_bf16_f32 v170, v100, v104
    v_cvt_pk_bf16_f32 v178, v101, v105
    v_cvt_pk_bf16_f32 v186, v102, v106
    v_cvt_pk_bf16_f32 v194, v103, v107
    s_nop 3
    v_cvt_pk_bf16_f32 v171, v108, v112
    v_cvt_pk_bf16_f32 v179, v109, v113
    v_cvt_pk_bf16_f32 v187, v110, v114
    v_cvt_pk_bf16_f32 v195, v111, v115
    ds_write_b128 v10, v[168:171] offset:16
    ds_write_b128 v10, v[176:179] offset:2320
    ds_write_b128 v10, v[184:187] offset:4624
    ds_write_b128 v10, v[192:195] offset:6928
    s_mov_b64 exec, 1
    v_mov_b32 v56, 0
    v_mov_b32 v64, 0
    v_mov_b32 v72, 0
    v_mov_b32 v80, 0
    v_mov_b32 v88, 0
    v_mov_b32 v96, 0
    v_mov_b32 v104, 0
    v_mov_b32_e64 v112, 0
    s_mov_b64 exec, -1
    s_waitcnt lgkmcnt(0)
    s_barrier
    ds_read_b128 v[164:167], v11 offset:40960
    ds_read_b128 v[168:171], v11 offset:42112
    ds_read_b128 v[172:175], v11 offset:43264
    ds_read_b128 v[176:179], v11 offset:44416
    ds_read_b128 v[180:183], v11 offset:45568
    ds_read_b128 v[184:187], v11 offset:46720
    ds_read_b128 v[188:191], v11 offset:47872
    ds_read_b128 v[192:195], v11 offset:49024
    v_pk_mul_f32 v[148:149], v[52:53], v[52:53]
    v_pk_mul_f32 v[150:151], v[60:61], v[60:61]
    v_pk_mul_f32 v[152:153], v[68:69], v[68:69]
    v_pk_mul_f32 v[154:155], v[76:77], v[76:77]
    v_pk_mul_f32 v[156:157], v[84:85], v[84:85]
    v_pk_mul_f32 v[158:159], v[92:93], v[92:93]
    v_pk_mul_f32 v[160:161], v[100:101], v[100:101]
    v_pk_mul_f32 v[162:163], v[108:109], v[108:109]
    s_add_u32 s42, s39, 0x0
    s_waitcnt lgkmcnt(7)
    buffer_store_dwordx4 v[164:167], v12, s[4:7], s42 offen offset:0 sc1
    v_pk_fma_f32 v[148:149], v[54:55], v[54:55], v[148:149]
    v_pk_fma_f32 v[150:151], v[62:63], v[62:63], v[150:151]
    v_pk_fma_f32 v[152:153], v[70:71], v[70:71], v[152:153]
    v_pk_fma_f32 v[154:155], v[78:79], v[78:79], v[154:155]
    v_pk_fma_f32 v[156:157], v[86:87], v[86:87], v[156:157]
    v_pk_fma_f32 v[158:159], v[94:95], v[94:95], v[158:159]
    v_pk_fma_f32 v[160:161], v[102:103], v[102:103], v[160:161]
    v_pk_fma_f32 v[162:163], v[110:111], v[110:111], v[162:163]
    s_add_u32 s42, s39, 0x10000
    s_waitcnt lgkmcnt(6)
    buffer_store_dwordx4 v[168:171], v12, s[4:7], s42 offen offset:0 sc1
    v_pk_fma_f32 v[148:149], v[56:57], v[56:57], v[148:149]
    v_pk_fma_f32 v[150:151], v[64:65], v[64:65], v[150:151]
    v_pk_fma_f32 v[152:153], v[72:73], v[72:73], v[152:153]
    v_pk_fma_f32 v[154:155], v[80:81], v[80:81], v[154:155]
    v_pk_fma_f32 v[156:157], v[88:89], v[88:89], v[156:157]
    v_pk_fma_f32 v[158:159], v[96:97], v[96:97], v[158:159]
    v_pk_fma_f32 v[160:161], v[104:105], v[104:105], v[160:161]
    v_pk_fma_f32 v[162:163], v[112:113], v[112:113], v[162:163]
    s_add_u32 s42, s39, 0x20000
    s_waitcnt lgkmcnt(5)
    buffer_store_dwordx4 v[172:175], v12, s[4:7], s42 offen offset:0 sc1
    v_pk_fma_f32 v[148:149], v[58:59], v[58:59], v[148:149]
    v_pk_fma_f32 v[150:151], v[66:67], v[66:67], v[150:151]
    v_pk_fma_f32 v[152:153], v[74:75], v[74:75], v[152:153]
    v_pk_fma_f32 v[154:155], v[82:83], v[82:83], v[154:155]
    v_pk_fma_f32 v[156:157], v[90:91], v[90:91], v[156:157]
    v_pk_fma_f32 v[158:159], v[98:99], v[98:99], v[158:159]
    v_pk_fma_f32 v[160:161], v[106:107], v[106:107], v[160:161]
    v_pk_fma_f32 v[162:163], v[114:115], v[114:115], v[162:163]
    s_add_u32 s42, s39, 0x30000
    s_waitcnt lgkmcnt(4)
    buffer_store_dwordx4 v[176:179], v12, s[4:7], s42 offen offset:0 sc1
    v_add_f32 v20, v148, v149
    v_add_f32 v21, v150, v151
    v_add_f32 v22, v152, v153
    v_add_f32 v23, v154, v155
    v_add_f32 v24, v156, v157
    v_add_f32 v25, v158, v159
    v_add_f32 v26, v160, v161
    v_add_f32 v27, v162, v163
    s_add_u32 s42, s39, 0x40000
    s_waitcnt lgkmcnt(3)
    buffer_store_dwordx4 v[180:183], v12, s[4:7], s42 offen offset:0 sc1
    v_permlane32_swap_b32 v20, v24
    v_permlane32_swap_b32 v21, v25
    v_permlane32_swap_b32 v22, v26
    v_permlane32_swap_b32 v23, v27
    v_add_f32 v20, v20, v24
    v_add_f32 v21, v21, v25
    v_add_f32 v22, v22, v26
    v_add_f32 v23, v23, v27
    s_add_u32 s42, s39, 0x50000
    s_waitcnt lgkmcnt(2)
    buffer_store_dwordx4 v[184:187], v12, s[4:7], s42 offen offset:0 sc1
    v_permlane16_swap_b32 v20, v22
    v_permlane16_swap_b32 v21, v23
    v_add_f32 v20, v20, v22
    v_add_f32_e64 v21, v21, v23
    s_nop 0
    v_add_f32_dpp v20, v20, v20 row_ror:8 row_mask:0xf bank_mask:0xf
    v_add_f32_dpp v21, v21, v21 row_ror:8 row_mask:0xf bank_mask:0xf
    s_nop 0
    v_add_f32_dpp v20, v20, v20 row_ror:4 row_mask:0xf bank_mask:0xf
    v_add_f32_dpp v21, v21, v21 row_ror:4 row_mask:0xf bank_mask:0xf
    s_add_u32 s42, s39, 0x60000
    s_waitcnt lgkmcnt(1)
    buffer_store_dwordx4 v[188:191], v12, s[4:7], s42 offen offset:0 sc1
    v_add_f32_dpp v20, v20, v20 row_ror:2 row_mask:0xf bank_mask:0xf
    v_add_f32_dpp v21, v21, v21 row_ror:2 row_mask:0xf bank_mask:0xf
    s_nop 0
    v_add_f32_dpp v20, v20, v20 row_ror:1 row_mask:0xf bank_mask:0xf
    v_add_f32_dpp v21, v21, v21 row_ror:1 row_mask:0xf bank_mask:0xf
    v_mov_b32 v22, 0x4227c5ac
    v_fmamk_f32 v20, v20, 0x46000000, v22
    v_fmamk_f32 v21, v21, 0x46000000, v22
    v_rsq_f32 v20, v20
    s_add_u32 s42, s39, 0x70000
    s_waitcnt lgkmcnt(0)
    buffer_store_dwordx4 v[192:195], v12, s[4:7], s42 offen offset:0 sc1
    v_rsq_f32 v21, v21
    v_lshlrev_b32 v10, 3, v7
    s_add_u32 s42, s38, s39
    s_add_u32 s42, s42, 0xbc0000
    s_waitcnt vmcnt(8)
    s_barrier
    s_mov_b64 exec, s[32:33]
    buffer_store_dwordx2 v[20:21], v10, s[4:7], s42 offen sc1
    s_mov_b64 exec, -1
    s_branch PRE_DONE
PRE_OUT_W:
    s_cmp_eq_u32 s19, 2
    s_cbranch_scc1 PRE_OUT_W1
    v_lshrrev_b32 v11, 2, v6
    v_mul_u32_u24 v11, 1088, v11
    v_and_b32 v12, 3, v6
    v_lshl_add_u32 v11, v12, 5, v11
    v_lshl_add_u32 v11, v7, 3, v11
    v_add_u32 v11, s43, v11
    v_lshlrev_b32 v10, 10, v7
    v_lshl_add_u32 v10, v6, 4, v10
    ds_read_b64_tr_b16 a[224:225], v11 offset:0
    ds_read_b64_tr_b16 a[226:227], v11 offset:4352
    ds_read_b64_tr_b16 a[228:229], v11 offset:128
    ds_read_b64_tr_b16 a[230:231], v11 offset:4480
    v_mfma_f32_16x16x32_bf16 v[52:55], v[124:127], v[20:23], 0
    ds_read_b64_tr_b16 a[232:233], v11 offset:256
    ds_read_b64_tr_b16 a[234:235], v11 offset:4608
    v_mfma_f32_16x16x32_bf16 v[52:55], v[132:135], v[196:199], v[52:55]
    v_mfma_f32_16x16x32_bf16 v[56:59], v[128:131], v[20:23], 0
    s_add_u32 s42, s24, 0xdc0000
    v_mfma_f32_16x16x32_bf16 v[56:59], v[136:139], v[196:199], v[56:59]
    s_waitcnt lgkmcnt(4)
    buffer_store_dwordx4 a[224:227], v10, s[4:7], s42 offen offset:0 sc1
    v_mfma_f32_16x16x32_bf16 v[60:63], v[124:127], v[24:27], 0
    ds_read_b64_tr_b16 a[236:237], v11 offset:384
    ds_read_b64_tr_b16 a[238:239], v11 offset:4736
    v_mfma_f32_16x16x32_bf16 v[60:63], v[132:135], v[200:203], v[60:63]
    v_mfma_f32_16x16x32_bf16 v[64:67], v[128:131], v[24:27], 0
    s_add_u32 s42, s24, 0xdf8000
    v_mfma_f32_16x16x32_bf16 v[64:67], v[136:139], v[200:203], v[64:67]
    s_waitcnt lgkmcnt(4)
    buffer_store_dwordx4 a[228:231], v10, s[4:7], s42 offen offset:0 sc1
    v_mfma_f32_16x16x32_bf16 v[68:71], v[124:127], v[28:31], 0
    ds_read_b64_tr_b16 a[240:241], v11 offset:512
    ds_read_b64_tr_b16 a[242:243], v11 offset:4864
    v_mfma_f32_16x16x32_bf16 v[68:71], v[132:135], v[204:207], v[68:71]
    v_mfma_f32_16x16x32_bf16 v[72:75], v[128:131], v[28:31], 0
    s_add_u32 s42, s24, 0xe30000
    v_mfma_f32_16x16x32_bf16 v[72:75], v[136:139], v[204:207], v[72:75]
    s_waitcnt lgkmcnt(4)
    buffer_store_dwordx4 a[232:235], v10, s[4:7], s42 offen offset:0 sc1
    v_mfma_f32_16x16x32_bf16 v[76:79], v[124:127], v[32:35], 0
    ds_read_b64_tr_b16 a[244:245], v11 offset:640
    ds_read_b64_tr_b16 a[246:247], v11 offset:4992
    v_mfma_f32_16x16x32_bf16 v[76:79], v[132:135], v[208:211], v[76:79]
    v_mfma_f32_16x16x32_bf16 v[80:83], v[128:131], v[32:35], 0
    s_add_u32 s42, s24, 0xe68000
    v_mfma_f32_16x16x32_bf16 v[80:83], v[136:139], v[208:211], v[80:83]
    s_waitcnt lgkmcnt(4)
    buffer_store_dwordx4 a[236:239], v10, s[4:7], s42 offen offset:0 sc1
    v_mfma_f32_16x16x32_bf16 v[84:87], v[124:127], v[36:39], 0
    ds_read_b64_tr_b16 a[248:249], v11 offset:768
    ds_read_b64_tr_b16 a[250:251], v11 offset:5120
    v_mfma_f32_16x16x32_bf16 v[84:87], v[132:135], v[212:215], v[84:87]
    v_mfma_f32_16x16x32_bf16 v[88:91], v[128:131], v[36:39], 0
    s_add_u32 s42, s24, 0xea0000
    v_mfma_f32_16x16x32_bf16 v[88:91], v[136:139], v[212:215], v[88:91]
    s_waitcnt lgkmcnt(4)
    buffer_store_dwordx4 a[240:243], v10, s[4:7], s42 offen offset:0 sc1
    v_mfma_f32_16x16x32_bf16 v[92:95], v[124:127], v[40:43], 0
    ds_read_b64_tr_b16 a[252:253], v11 offset:896
    ds_read_b64_tr_b16 a[254:255], v11 offset:5248
    v_mfma_f32_16x16x32_bf16 v[92:95], v[132:135], v[216:219], v[92:95]
    v_mfma_f32_16x16x32_bf16 v[96:99], v[128:131], v[40:43], 0
    s_add_u32 s42, s24, 0xed8000
    v_mfma_f32_16x16x32_bf16 v[96:99], v[136:139], v[216:219], v[96:99]
    s_waitcnt lgkmcnt(4)
    buffer_store_dwordx4 a[244:247], v10, s[4:7], s42 offen offset:0 sc1
    v_mfma_f32_16x16x32_bf16 v[100:103], v[124:127], v[44:47], 0
    v_mfma_f32_16x16x32_bf16 v[100:103], v[132:135], v[220:223], v[100:103]
    v_mfma_f32_16x16x32_bf16 v[104:107], v[128:131], v[44:47], 0
    s_add_u32 s42, s24, 0xf10000
    v_mfma_f32_16x16x32_bf16 v[104:107], v[136:139], v[220:223], v[104:107]
    s_waitcnt lgkmcnt(2)
    buffer_store_dwordx4 a[248:251], v10, s[4:7], s42 offen offset:0 sc1
    v_mfma_f32_16x16x32_bf16 v[108:111], v[124:127], v[48:51], 0
    v_mfma_f32_16x16x32_bf16 v[108:111], v[132:135], v[224:227], v[108:111]
    v_mfma_f32_16x16x32_bf16 v[112:115], v[128:131], v[48:51], 0
    s_add_u32 s42, s24, 0xf48000
    v_mfma_f32_16x16x32_bf16 v[112:115], v[136:139], v[224:227], v[112:115]
    s_waitcnt lgkmcnt(0)
    buffer_store_dwordx4 a[252:255], v10, s[4:7], s42 offen offset:0 sc1
    s_cmp_eq_u32 s19, 3
    s_cbranch_scc1 PRE_OUT_B2
    v_mul_u32_u24 v10, 458752, v7
    v_lshl_add_u32 v10, v6, 4, v10
    s_add_u32 s42, s24, 0xc00000
    v_cvt_pk_bf16_f32 v164, v52, v60
    v_cvt_pk_bf16_f32 v165, v68, v76
    v_cvt_pk_bf16_f32 v166, v84, v92
    v_cvt_pk_bf16_f32 v167, v100, v108
    buffer_store_dwordx4 v[164:167], v10, s[4:7], s42 offen offset:0 sc1
    v_cvt_pk_bf16_f32 v168, v56, v64
    v_cvt_pk_bf16_f32 v169, v72, v80
    v_cvt_pk_bf16_f32 v170, v88, v96
    v_cvt_pk_bf16_f32 v171, v104, v112
    buffer_store_dwordx4 v[168:171], v10, s[4:7], s42 offen offset:1024 sc1
    s_add_u32 s42, s24, 0xc00800
    v_cvt_pk_bf16_f32 v172, v53, v61
    v_cvt_pk_bf16_f32 v173, v69, v77
    v_cvt_pk_bf16_f32 v174, v85, v93
    v_cvt_pk_bf16_f32 v175, v101, v109
    buffer_store_dwordx4 v[172:175], v10, s[4:7], s42 offen offset:0 sc1
    v_cvt_pk_bf16_f32 v176, v57, v65
    v_cvt_pk_bf16_f32 v177, v73, v81
    v_cvt_pk_bf16_f32 v178, v89, v97
    v_cvt_pk_bf16_f32 v179, v105, v113
    buffer_store_dwordx4 v[176:179], v10, s[4:7], s42 offen offset:1024 sc1
    s_add_u32 s42, s24, 0xc38000
    v_cvt_pk_bf16_f32 v180, v54, v62
    v_cvt_pk_bf16_f32 v181, v70, v78
    v_cvt_pk_bf16_f32 v182, v86, v94
    v_cvt_pk_bf16_f32 v183, v102, v110
    buffer_store_dwordx4 v[180:183], v10, s[4:7], s42 offen offset:0 sc1
    v_cvt_pk_bf16_f32 v184, v58, v66
    v_cvt_pk_bf16_f32 v185, v74, v82
    v_cvt_pk_bf16_f32 v186, v90, v98
    v_cvt_pk_bf16_f32 v187, v106, v114
    buffer_store_dwordx4 v[184:187], v10, s[4:7], s42 offen offset:1024 sc1
    s_add_u32 s42, s24, 0xc38800
    v_cvt_pk_bf16_f32 v188, v55, v63
    v_cvt_pk_bf16_f32 v189, v71, v79
    v_cvt_pk_bf16_f32 v190, v87, v95
    v_cvt_pk_bf16_f32 v191, v103, v111
    buffer_store_dwordx4 v[188:191], v10, s[4:7], s42 offen offset:0 sc1
    v_cvt_pk_bf16_f32 v192, v59, v67
    v_cvt_pk_bf16_f32 v193, v75, v83
    v_cvt_pk_bf16_f32 v194, v91, v99
    v_cvt_pk_bf16_f32 v195, v107, v115
    buffer_store_dwordx4 v[192:195], v10, s[4:7], s42 offen offset:1024 sc1
    s_branch PRE_DONE
PRE_OUT_B2:
    v_lshl_add_u32 v10, v7, 6, v6
    v_lshlrev_b32 v10, 2, v10
    s_mov_b32 s42, 0xbc4000
    buffer_store_dword v52, v10, s[4:7], s42 offen offset:0 sc1
    buffer_store_dword v56, v10, s[4:7], s42 offen offset:1024 sc1
    buffer_store_dword v53, v10, s[4:7], s42 offen offset:64 sc1
    buffer_store_dword v57, v10, s[4:7], s42 offen offset:1088 sc1
    buffer_store_dword v54, v10, s[4:7], s42 offen offset:128 sc1
    buffer_store_dword v58, v10, s[4:7], s42 offen offset:1152 sc1
    buffer_store_dword v55, v10, s[4:7], s42 offen offset:192 sc1
    buffer_store_dword v59, v10, s[4:7], s42 offen offset:1216 sc1
    s_branch PRE_FT
PRE_OUT_W1:
    v_mfma_f32_16x16x32_bf16 v[52:55], v[124:127], v[20:23], 0
    s_mul_i32 s43, s3, 9216
    s_add_u32 s43, s43, 40960
    v_mfma_f32_16x16x32_bf16 v[52:55], v[132:135], v[196:199], v[52:55]
    v_mul_u32_u24 v14, 9, v1
    v_add_u32_e64 v14, s43, v14
    v_mfma_f32_16x16x32_bf16 v[56:59], v[128:131], v[20:23], 0
    v_bfe_u32 v12, v0, 3, 3
    v_and_b32 v13, 0x70, v1
    v_mfma_f32_16x16x32_bf16 v[56:59], v[136:139], v[196:199], v[56:59]
    v_mul_u32_u24 v11, 144, v12
    v_add3_u32 v11, v11, v13, s43
    v_mfma_f32_16x16x32_bf16 v[60:63], v[124:127], v[24:27], 0
    s_mul_i32 s16, s37, 4682
    s_lshr_b32 s16, s16, 16
    v_mfma_f32_16x16x32_bf16 v[60:63], v[132:135], v[200:203], v[60:63]
    s_mul_i32 s17, s16, 14
    s_sub_u32 s17, s37, s17
    v_mfma_f32_16x16x32_bf16 v[64:67], v[128:131], v[24:27], 0
    s_lshr_b32 s38, s17, 1
    s_mul_i32 s39, s16, 112
    v_mfma_f32_16x16x32_bf16 v[64:67], v[136:139], v[200:203], v[64:67]
    s_add_u32 s39, s39, s38
    s_movk_i32 s18, 0x1000
    s_cmp_lt_u32 s38, 4
    s_cselect_b32 s38, 0, 60
    s_cselect_b32 s18, s18, 0xc00
    v_mfma_f32_16x16x32_bf16 v[68:71], v[124:127], v[28:31], 0
    s_add_u32 s38, s38, s39
    s_lshl_b32 s38, s38, 10
    v_mfma_f32_16x16x32_bf16 v[68:71], v[132:135], v[204:207], v[68:71]
    v_cvt_pk_bf16_f32 v164, v52, v56
    v_cvt_pk_bf16_f32 v165, v53, v57
    v_mfma_f32_16x16x32_bf16 v[72:75], v[128:131], v[28:31], 0
    v_cvt_pk_bf16_f32 v166, v54, v58
    v_cvt_pk_bf16_f32 v167, v55, v59
    v_mfma_f32_16x16x32_bf16 v[72:75], v[136:139], v[204:207], v[72:75]
    ds_write_b128 v14, v[164:167] offset:0
    v_mfma_f32_16x16x32_bf16 v[76:79], v[124:127], v[32:35], 0
    s_and_b32 s17, s17, 1
    s_lshl_b32 s17, s17, 7
    v_mfma_f32_16x16x32_bf16 v[76:79], v[132:135], v[208:211], v[76:79]
    v_cvt_pk_bf16_f32 v168, v60, v64
    v_cvt_pk_bf16_f32 v169, v61, v65
    v_mfma_f32_16x16x32_bf16 v[80:83], v[128:131], v[32:35], 0
    v_cvt_pk_bf16_f32 v170, v62, v66
    v_cvt_pk_bf16_f32 v171, v63, v67
    v_mfma_f32_16x16x32_bf16 v[80:83], v[136:139], v[208:211], v[80:83]
    ds_write_b128 v14, v[168:171] offset:16
    v_mfma_f32_16x16x32_bf16 v[84:87], v[124:127], v[36:39], 0
    s_add_u32 s38, s38, s17
    s_add_u32 s38, s38, 0xa00000
    v_mfma_f32_16x16x32_bf16 v[84:87], v[132:135], v[212:215], v[84:87]
    v_cvt_pk_bf16_f32 v172, v68, v72
    v_cvt_pk_bf16_f32 v173, v69, v73
    v_mfma_f32_16x16x32_bf16 v[88:91], v[128:131], v[36:39], 0
    v_cvt_pk_bf16_f32 v174, v70, v74
    v_cvt_pk_bf16_f32 v175, v71, v75
    v_mfma_f32_16x16x32_bf16 v[88:91], v[136:139], v[212:215], v[88:91]
    ds_write_b128 v14, v[172:175] offset:32
    v_mfma_f32_16x16x32_bf16 v[92:95], v[124:127], v[40:43], 0
    s_lshl_b32 s42, s18, 3
    s_add_u32 s42, s42, s38
    v_mfma_f32_16x16x32_bf16 v[92:95], v[132:135], v[216:219], v[92:95]
    v_cvt_pk_bf16_f32 v176, v76, v80
    v_cvt_pk_bf16_f32 v177, v77, v81
    v_mfma_f32_16x16x32_bf16 v[96:99], v[128:131], v[40:43], 0
    v_cvt_pk_bf16_f32 v178, v78, v82
    v_cvt_pk_bf16_f32 v179, v79, v83
    v_mfma_f32_16x16x32_bf16 v[96:99], v[136:139], v[216:219], v[96:99]
    ds_write_b128 v14, v[176:179] offset:48
    v_mfma_f32_16x16x32_bf16 v[100:103], v[124:127], v[44:47], 0
    v_mad_u32_u24 v10, v12, s18, v13
    v_mfma_f32_16x16x32_bf16 v[100:103], v[132:135], v[220:223], v[100:103]
    v_cvt_pk_bf16_f32 v180, v84, v88
    v_cvt_pk_bf16_f32 v181, v85, v89
    v_mfma_f32_16x16x32_bf16 v[104:107], v[128:131], v[44:47], 0
    v_cvt_pk_bf16_f32 v182, v86, v90
    v_cvt_pk_bf16_f32 v183, v87, v91
    v_mfma_f32_16x16x32_bf16 v[104:107], v[136:139], v[220:223], v[104:107]
    ds_write_b128 v14, v[180:183] offset:64
    v_mfma_f32_16x16x32_bf16 v[108:111], v[124:127], v[48:51], 0
    v_mfma_f32_16x16x32_bf16 v[108:111], v[132:135], v[224:227], v[108:111]
    v_cvt_pk_bf16_f32 v184, v92, v96
    v_cvt_pk_bf16_f32 v185, v93, v97
    v_mfma_f32_16x16x32_bf16 v[112:115], v[128:131], v[48:51], 0
    v_cvt_pk_bf16_f32 v186, v94, v98
    v_cvt_pk_bf16_f32 v187, v95, v99
    v_mfma_f32_16x16x32_bf16 v[112:115], v[136:139], v[224:227], v[112:115]
    ds_write_b128 v14, v[184:187] offset:80
    v_cvt_pk_bf16_f32 v188, v100, v104
    v_cvt_pk_bf16_f32 v189, v101, v105
    v_cvt_pk_bf16_f32 v190, v102, v106
    v_cvt_pk_bf16_f32 v191, v103, v107
    ds_write_b128 v14, v[188:191] offset:96
    s_nop 1
    v_cvt_pk_bf16_f32 v192, v108, v112
    v_cvt_pk_bf16_f32 v193, v109, v113
    v_cvt_pk_bf16_f32 v194, v110, v114
    v_cvt_pk_bf16_f32 v195, v111, v115
    ds_write_b128 v14, v[192:195] offset:112
    ds_read_b128 v[20:23], v11 offset:0
    ds_read_b128 v[24:27], v11 offset:1152
    ds_read_b128 v[28:31], v11 offset:2304
    ds_read_b128 v[32:35], v11 offset:3456
    ds_read_b128 v[36:39], v11 offset:4608
    ds_read_b128 v[40:43], v11 offset:5760
    ds_read_b128 v[44:47], v11 offset:6912
    ds_read_b128 v[48:51], v11 offset:8064
    s_waitcnt lgkmcnt(7)
    buffer_store_dwordx4 v[20:23], v10, s[4:7], s38 offen offset:0 sc1
    s_waitcnt lgkmcnt(6)
    buffer_store_dwordx4 v[24:27], v10, s[4:7], s42 offen offset:0 sc1
    s_waitcnt lgkmcnt(5)
    buffer_store_dwordx4 v[28:31], v10, s[4:7], s38 offen offset:256 sc1
    s_waitcnt lgkmcnt(4)
    buffer_store_dwordx4 v[32:35], v10, s[4:7], s42 offen offset:256 sc1
    s_waitcnt lgkmcnt(3)
    buffer_store_dwordx4 v[36:39], v10, s[4:7], s38 offen offset:512 sc1
    s_waitcnt lgkmcnt(2)
    buffer_store_dwordx4 v[40:43], v10, s[4:7], s42 offen offset:512 sc1
    s_waitcnt lgkmcnt(1)
    buffer_store_dwordx4 v[44:47], v10, s[4:7], s38 offen offset:768 sc1
    s_waitcnt lgkmcnt(0)
    buffer_store_dwordx4 v[48:51], v10, s[4:7], s42 offen offset:768 sc1
    s_branch PRE_DONE
PRE_OTHER:
    s_cmp_ge_u32 s2, 240
    s_cbranch_scc1 PRE_MISC
    s_cmp_lt_u32 s2, 128
    s_cbranch_scc1 PRE_FILT
    s_mov_b32 s10, 0x1c0000
    s_waitcnt lgkmcnt(0)
    s_mov_b64 s[8:9], s[28:29]
    s_mov_b32 s19, 1
    s_mov_b32 s20, s43
    s_mov_b32 s21, 1088
    s_mov_b32 s22, 1024
    s_lshr_b32 s42, s2, 3
    s_add_u32 s42, s42, 32
    s_sub_u32 s37, s2, 192
    s_cselect_b32 s37, s42, s37
    s_lshl_b32 s37, s37, 2
    s_add_u32 s37, s37, s3
    s_mul_i32 s16, s37, 4682
    s_lshr_b32 s16, s16, 16
    s_mul_i32 s17, s16, 14
    s_sub_u32 s17, s37, s17
    s_and_b32 s39, s16, 3
    s_lshr_b32 s42, s17, 2
    s_lshl_b32 s24, s39, 1
    s_add_u32 s24, s24, s42
    s_add_u32 s18, s39, 8
    s_cmp_eq_u32 s42, 2
    s_cselect_b32 s24, s18, s24
    s_lshr_b32 s18, s39, 1
    s_add_u32 s18, s18, 12
    s_and_b32 s39, s39, 1
    s_lshl_b32 s39, s39, 1
    s_cmp_eq_u32 s42, 3
    s_cselect_b32 s24, s18, s24
    s_cselect_b32 s39, s39, 0
    s_and_b32 s18, s17, 3
    s_add_u32 s18, s18, s39
    s_lshr_b32 s39, s16, 2
    s_mul_i32 s39, s39, 14
    s_add_u32 s24, s24, s39
    s_lshl_b32 s24, s24, 12
    s_lshl_b32 s18, s18, 8
    s_add_u32 s24, s24, s18
    s_lshr_b32 s18, s17, 2
    s_mul_i32 s38, s16, 112
    s_lshl_b32 s42, s18, 5
    s_add_u32 s38, s38, s42
    s_and_b32 s42, s17, 3
    s_cmp_eq_u32 s18, 3
    s_cselect_b32 s39, 3, 2
    s_cselect_b32 s18, 4, 16
    s_lshl_b32 s42, s42, s39
    s_add_u32 s38, s38, s42
    s_add_u32 s39, s38, s18
    s_lshl_b32 s38, s38, 10
    s_lshl_b32 s39, s39, 10
    s_mov_b64 vcc, -1
    s_branch PRE_CONST
PRE_MISC:
    s_lshl_b32 s37, s2, 2
    s_add_u32 s37, s37, s3
    s_cmp_eq_u32 s37, 1016
    s_cbranch_scc1 PRE_IN_B2
    v_and_b32 v6, 15, v0
    v_lshrrev_b32 v7, 4, v1
    v_lshlrev_b32_e64 v1, 4, v1
    s_mov_b32 s6, 0x2400000
    s_mov_b32 s7, 0x20000
    s_mov_b32 s46, 0x05040100
    s_mov_b32 s47, 0x07060302
    s_mov_b32 s49, s2
    s_bitcmp1_b32 s2, 3
    s_waitcnt lgkmcnt(0)
    s_cselect_b64 s[8:9], s[20:21], s[18:19]
    s_mov_b32 s10, 1052672
    s_and_b32 s42, s2, 7
    s_mul_i32 s42, s42, 131584
    s_add_u32 s42, s42, 0x20000
    v_lshlrev_b32 v10, 7, v7
    buffer_load_dword v2, v10, s[8:11], s42 offen
    s_lshl_b32 s49, s49, 7
    s_add_u32 s49, s49, 0x1000000
    s_mov_b32 s42, 0xbc8000
    v_lshrrev_b32 v4, 2, v1
    v_mov_b32 v196, 0
    buffer_load_dword v3, v196, s[4:7], s42 offen sc1
    s_lshl_b32 s42, s3, 8
    s_add_u32 s42, s42, s2
    s_lshl_b32 s42, s42, 7
    s_add_u32 s42, s42, 0x1080000
    s_lshl_b32 s48, s2, 7
    s_add_u32 s48, s48, 0xbc0000
    s_mov_b32 exec_hi, 0
    buffer_store_dword v196, v4, s[4:7], s42 offen sc1
    s_mov_b32 exec_hi, -1
    s_cmp_eq_u32 s3, 0
    s_cselect_b32 s42, s49, s42
    s_cmp_lt_u32 s2, 64
    s_cselect_b32 s48, s48, s42
    s_cmp_eq_u32 s3, 1
    s_cselect_b32 s42, s48, s42
    s_mov_b32 exec_hi, 0
    buffer_store_dword v196, v4, s[4:7], s42 offen sc1
    s_mov_b32 exec_hi, -1
    s_cmp_eq_u32 s37, 1017
    s_cbranch_scc1 PRE_B1
    s_cmp_eq_u32 s37, 1018
    s_cbranch_scc1 PRE_ZERO
    s_branch PRE_FT
PRE_IN_B2:
    s_mov_b32 s38, 0
    s_movk_i32 s39, 0x1000
    s_mov_b32 s10, 0x400
    s_waitcnt lgkmcnt(0)
    s_mov_b64 s[8:9], s[30:31]
    s_mov_b32 s19, 3
    s_mov_b32 s20, s43
    s_mov_b32 s21, 1088
    s_mov_b32 s22, 1024
    s_mov_b32 s24, 0x40000000
    s_branch PRE_CONST
PRE_B1:
    s_mov_b32 s10, 3584
    s_mov_b64 s[8:9], s[26:27]
    v_lshrrev_b32 v11, 1, v1
    buffer_load_dwordx2 v[52:53], v11, s[8:11], 0 offen offset:0
    buffer_load_dwordx2 v[54:55], v11, s[8:11], 0 offen offset:512
    buffer_load_dwordx2 v[56:57], v11, s[8:11], 0 offen offset:1024
    buffer_load_dwordx2 v[58:59], v11, s[8:11], 0 offen offset:1536
    buffer_load_dwordx2 v[60:61], v11, s[8:11], 0 offen offset:2048
    buffer_load_dwordx2 v[62:63], v11, s[8:11], 0 offen offset:2560
    buffer_load_dwordx2 v[64:65], v11, s[8:11], 0 offen offset:3072
    s_waitcnt vmcnt(6)
    v_lshlrev_b32 v164, 16, v52
    v_and_b32 v165, 0xffff0000, v52
    v_lshlrev_b32_e64 v166, 16, v53
    v_and_b32 v167, 0xffff0000, v53
    s_mov_b32 s42, 0xbc5000
    buffer_store_dwordx4 v[164:167], v1, s[4:7], s42 offen offset:0 sc1
    s_waitcnt vmcnt(6)
    v_lshlrev_b32 v168, 16, v54
    v_and_b32 v169, 0xffff0000, v54
    v_lshlrev_b32_e64 v170, 16, v55
    v_and_b32 v171, 0xffff0000, v55
    s_mov_b32 s42, 0xbc5400
    buffer_store_dwordx4 v[168:171], v1, s[4:7], s42 offen offset:0 sc1
    s_waitcnt vmcnt(6)
    v_lshlrev_b32 v172, 16, v56
    v_and_b32 v173, 0xffff0000, v56
    v_lshlrev_b32_e64 v174, 16, v57
    v_and_b32 v175, 0xffff0000, v57
    s_mov_b32 s42, 0xbc5800
    buffer_store_dwordx4 v[172:175], v1, s[4:7], s42 offen offset:0 sc1
    s_waitcnt vmcnt(6)
    v_lshlrev_b32 v176, 16, v58
    v_and_b32 v177, 0xffff0000, v58
    v_lshlrev_b32_e64 v178, 16, v59
    v_and_b32 v179, 0xffff0000, v59
    s_mov_b32 s42, 0xbc5c00
    buffer_store_dwordx4 v[176:179], v1, s[4:7], s42 offen offset:0 sc1
    s_waitcnt vmcnt(6)
    v_lshlrev_b32 v180, 16, v60
    v_and_b32 v181, 0xffff0000, v60
    v_lshlrev_b32_e64 v182, 16, v61
    v_and_b32 v183, 0xffff0000, v61
    s_mov_b32 s42, 0xbc6000
    buffer_store_dwordx4 v[180:183], v1, s[4:7], s42 offen offset:0 sc1
    s_waitcnt vmcnt(6)
    v_lshlrev_b32 v184, 16, v62
    v_and_b32 v185, 0xffff0000, v62
    v_lshlrev_b32_e64 v186, 16, v63
    v_and_b32 v187, 0xffff0000, v63
    s_mov_b32 s42, 0xbc6400
    buffer_store_dwordx4 v[184:187], v1, s[4:7], s42 offen offset:0 sc1
    s_waitcnt vmcnt(6)
    v_lshlrev_b32 v188, 16, v64
    v_and_b32 v189, 0xffff0000, v64
    v_lshlrev_b32_e64 v190, 16, v65
    v_and_b32 v191, 0xffff0000, v65
    s_mov_b32 s42, 0xbc6800
    buffer_store_dwordx4 v[188:191], v1, s[4:7], s42 offen offset:0 sc1
    s_branch PRE_FT
PRE_ZERO:
    v_mov_b32 v164, 0
    v_mov_b32 v165, 0
    v_mov_b32 v166, 0
    v_mov_b32_e64 v167, 0
    s_mov_b32 s42, 0xbcc000
    buffer_store_dwordx4 v[164:167], v1, s[4:7], s42 offen offset:0 sc1
    s_mov_b32 s42, 0xbcc400
    buffer_store_dwordx4 v[164:167], v1, s[4:7], s42 offen offset:0 sc1
    s_mov_b32 s42, 0xbcc800
    buffer_store_dwordx4 v[164:167], v1, s[4:7], s42 offen offset:0 sc1
    s_mov_b32 s42, 0xbccc00
    buffer_store_dwordx4 v[164:167], v1, s[4:7], s42 offen offset:0 sc1
    s_mov_b32 s42, 0xbcd000
    buffer_store_dwordx4 v[164:167], v1, s[4:7], s42 offen offset:0 sc1
    s_mov_b32 s42, 0xbcd400
    buffer_store_dwordx4 v[164:167], v1, s[4:7], s42 offen offset:0 sc1
    s_mov_b32 s42, 0xbcd800
    buffer_store_dwordx4 v[164:167], v1, s[4:7], s42 offen offset:0 sc1
    s_mov_b32 s42, 0xbcdc00
    buffer_store_dwordx4 v[164:167], v1, s[4:7], s42 offen offset:0 sc1
    s_mov_b32 s42, 0xbce000
    buffer_store_dwordx4 v[164:167], v1, s[4:7], s42 offen offset:0 sc1
    s_mov_b32 s42, 0xbce400
    buffer_store_dwordx4 v[164:167], v1, s[4:7], s42 offen offset:0 sc1
    s_mov_b32 s42, 0xbce800
    buffer_store_dwordx4 v[164:167], v1, s[4:7], s42 offen offset:0 sc1
    s_mov_b32 s42, 0xbcec00
    buffer_store_dwordx4 v[164:167], v1, s[4:7], s42 offen offset:0 sc1
    s_mov_b32 s42, 0xbcf000
    buffer_store_dwordx4 v[164:167], v1, s[4:7], s42 offen offset:0 sc1
    s_mov_b32 s42, 0xbcf400
    buffer_store_dwordx4 v[164:167], v1, s[4:7], s42 offen offset:0 sc1
    s_mov_b32 s42, 0xbcf800
    buffer_store_dwordx4 v[164:167], v1, s[4:7], s42 offen offset:0 sc1
    s_mov_b32 s42, 0xbcfc00
    buffer_store_dwordx4 v[164:167], v1, s[4:7], s42 offen offset:0 sc1
PRE_FT:
    s_sub_u32 s19, s2, 240
    s_lshl_b32 s19, s19, 2
    s_add_u32 s19, s19, s3
PRE_FT_LOOP:
    s_lshr_b32 s38, s19, 5
    s_lshl_b32 s38, s38, 6
    s_and_b32 s39, s19, 1
    s_lshl_b32 s39, s39, 3
    s_add_u32 s38, s38, s39
    s_bfe_u32 s39, s19, 0x40001
    s_lshl_b32 s37, s19, 11
    s_add_u32 s37, s37, 0xf80000
    v_and_b32 v15, 12, v6
    v_and_b32 v14, 3, v6
    v_lshl_add_u32 v14, v15, 2, v14
    v_add_u32 v14, s38, v14
    s_mov_b32 s34, 0
    s_mov_b32 s35, -1
    v_mov_b32 v16, 0x3d800000
    v_mov_b32 v17, 0x3d3504f3
    s_cmp_eq_u32 s39, 0
    s_cselect_b64 vcc, -1, 0
    v_lshl_add_u32 v148, v7, 7, s39
    v_add_u32 v148, 0, v148
    v_sub_u32 v15, 512, v148
    v_add_u32 v11, -240, v148
    v_cndmask_b32 v15, v15, v11, vcc
    v_cndmask_b32 v148, v148, v15, s[34:35]
    v_lshl_add_u32 v149, v7, 7, s39
    v_add_u32 v149, 32, v149
    v_sub_u32 v15, 512, v149
    v_add_u32 v11, -240, v149
    v_cndmask_b32 v15, v15, v11, vcc
    v_cndmask_b32 v149, v149, v15, s[34:35]
    v_lshl_add_u32 v150, v7, 7, s39
    v_add_u32_e64 v150, 64, v150
    v_sub_u32 v15, 512, v150
    v_add_u32 v11, -240, v150
    v_cndmask_b32 v15, v15, v11, vcc
    v_cndmask_b32 v150, v150, v15, s[34:35]
    v_lshl_add_u32 v151, v7, 7, s39
    v_add_u32 v151, 96, v151
    v_sub_u32 v15, 512, v151
    v_add_u32 v11, -240, v151
    v_cndmask_b32 v15, v15, v11, vcc
    v_cndmask_b32 v151, v151, v15, s[34:35]
    v_cmp_eq_u32 vcc, 0, v148
    v_mov_b32 v15, 256
    s_nop 0
    v_cndmask_b32 v148, v148, v15, vcc
    v_cndmask_b32 v15, v16, v17, vcc
    v_add_u32 v11, 0, v14
    v_mul_u32_u24 v152, v148, v11
    v_and_b32 v152, 511, v152
    v_cvt_f32_u32 v152, v152
    v_mul_f32 v152, 0x3b000000, v152
    v_cos_f32 v156, v152
    v_sin_f32 v160, v152
    v_mul_u32_u24 v153, v149, v11
    v_and_b32 v153, 511, v153
    v_cvt_f32_u32 v153, v153
    v_mul_f32 v153, 0x3b000000, v153
    v_cos_f32 v157, v153
    v_sin_f32 v161, v153
    v_mul_u32_u24 v154, v150, v11
    v_and_b32 v154, 511, v154
    v_cvt_f32_u32 v154, v154
    v_mul_f32 v154, 0x3b000000, v154
    v_cos_f32 v158, v154
    v_sin_f32 v162, v154
    v_mul_u32_u24 v155, v151, v11
    v_and_b32 v155, 511, v155
    v_cvt_f32_u32 v155, v155
    v_mul_f32 v155, 0x3b000000, v155
    v_cos_f32 v159, v155
    v_sin_f32 v163, v155
    v_mul_f32 v156, v15, v156
    v_mul_f32 v160, 0xbd800000, v160
    v_cndmask_b32 v160, v160, v17, vcc
    v_cvt_pk_bf16_f32 v200, v156, v160
    v_mul_f32 v157, v16, v157
    v_mul_f32 v161, 0xbd800000, v161
    v_cvt_pk_bf16_f32 v201, v157, v161
    v_mul_f32 v158, v16, v158
    v_mul_f32 v162, 0xbd800000, v162
    v_cvt_pk_bf16_f32 v202, v158, v162
    v_mul_f32_e64 v159, v16, v159
    v_mul_f32 v163, 0xbd800000, v163
    v_cvt_pk_bf16_f32 v203, v159, v163
    buffer_store_dwordx4 v[200:203], v1, s[4:7], s37 offen offset:0 sc1
    v_add_u32 v11, 4, v14
    v_mul_u32_u24 v152, v148, v11
    v_and_b32 v152, 511, v152
    v_cvt_f32_u32 v152, v152
    v_mul_f32 v152, 0x3b000000, v152
    v_cos_f32 v156, v152
    v_sin_f32 v160, v152
    v_mul_u32_u24 v153, v149, v11
    v_and_b32 v153, 511, v153
    v_cvt_f32_u32 v153, v153
    v_mul_f32 v153, 0x3b000000, v153
    v_cos_f32 v157, v153
    v_sin_f32 v161, v153
    v_mul_u32_u24 v154, v150, v11
    v_and_b32 v154, 511, v154
    v_cvt_f32_u32 v154, v154
    v_mul_f32 v154, 0x3b000000, v154
    v_cos_f32 v158, v154
    v_sin_f32 v162, v154
    v_mul_u32_u24 v155, v151, v11
    v_and_b32 v155, 511, v155
    v_cvt_f32_u32 v155, v155
    v_mul_f32 v155, 0x3b000000, v155
    v_cos_f32 v159, v155
    v_sin_f32 v163, v155
    v_mul_f32 v156, v15, v156
    v_mul_f32 v160, 0xbd800000, v160
    v_cndmask_b32 v160, v160, v17, vcc
    v_cvt_pk_bf16_f32 v204, v156, v160
    v_mul_f32 v157, v16, v157
    v_mul_f32 v161, 0xbd800000, v161
    v_cvt_pk_bf16_f32 v205, v157, v161
    v_mul_f32 v158, v16, v158
    v_mul_f32 v162, 0xbd800000, v162
    v_cvt_pk_bf16_f32 v206, v158, v162
    v_mul_f32 v159, v16, v159
    v_mul_f32 v163, 0xbd800000, v163
    v_cvt_pk_bf16_f32 v207, v159, v163
    buffer_store_dwordx4 v[204:207], v1, s[4:7], s37 offen offset:1024 sc1
    s_add_u32 s19, s19, 64
    s_cmp_lt_u32 s19, 128
    s_cbranch_scc1 PRE_FT_LOOP
    s_branch PRE_DONE
PRE_FILT:
    v_and_b32 v6, 15, v0
    v_lshrrev_b32 v7, 4, v1
    v_lshlrev_b32 v1, 4, v1
    s_mov_b32 s6, 0x2400000
    s_mov_b32 s7, 0x20000
    s_mov_b32 s46, 0x05040100
    s_mov_b32 s47, 0x07060302
    s_mov_b32 s49, s2
    s_mov_b32 s10, 1052672
    s_mov_b32 s14, 1052672
    s_mov_b32 s15, 0x20000
    s_waitcnt lgkmcnt(0)
    s_mov_b64 s[8:9], s[18:19]
    s_mov_b64 s[12:13], s[20:21]
    v_lshlrev_b32 v10, 7, v0
    s_and_b32 s42, s2, 7
    s_mul_i32 s42, s42, 131584
    s_bfe_u32 s38, s2, 0x20003
    s_lshl_b32 s38, s38, 15
    s_add_u32 s42, s42, s38
    s_bitcmp1_b32 s2, 5
    s_cbranch_scc1 PRE_FL1
    buffer_load_dword v2, v10, s[8:11], s42 offen
    s_branch PRE_FL2
PRE_FL1:
    buffer_load_dword v2, v10, s[12:15], s42 offen
PRE_FL2:
    s_and_b32 s17, s2, 7
    s_bfe_u32 s42, s2, 0x20004
    s_lshl_b32 s42, s42, 3
    s_add_u32 s17, s17, s42
    s_bfe_u32 s42, s2, 0x10003
    s_lshl_b32 s49, s17, 1
    s_add_u32 s49, s49, s42
    s_add_u32 s49, s49, 64
    s_lshl_b32 s16, s42, 2
    s_add_u32 s16, s16, s3
    s_and_b32 s38, s2, 32
    s_bfe_u32 s42, s2, 0x10004
    s_add_u32 s38, s38, s42
    s_and_b32 s42, s17, 7
    s_lshl_b32 s42, s42, 8
    s_add_u32 s38, s38, s42
    s_mul_i32 s38, s38, 514
    s_lshl_b32 s42, s16, 6
    s_add_u32 s38, s38, s42
    v_bfe_u32 v11, v0, 2, 4
    v_mul_u32_u24 v10, 1028, v11
    v_and_b32 v12, 48, v1
    v_add_u32_e64 v10, v12, v10
    s_add_u32 s42, s38, 2
    buffer_load_dwordx4 v[20:23], v10, s[8:11], s42 offen
    buffer_load_dwordx4 v[24:27], v10, s[12:15], s42 offen
    s_add_u32 s42, s38, 32898
    buffer_load_dwordx4 v[28:31], v10, s[8:11], s42 offen
    buffer_load_dwordx4 v[32:35], v10, s[12:15], s42 offen
    s_add_u32 s42, s38, 65794
    buffer_load_dwordx4 v[36:39], v10, s[8:11], s42 offen
    buffer_load_dwordx4 v[40:43], v10, s[12:15], s42 offen
    s_add_u32 s42, s38, 98690
    buffer_load_dwordx4 v[44:47], v10, s[8:11], s42 offen
    buffer_load_dwordx4 v[48:51], v10, s[12:15], s42 offen
    s_lshl_b32 s49, s49, 7
    s_add_u32 s49, s49, 0x1000000
    s_mov_b32 s39, 0xbc8000
    v_lshrrev_b32 v4, 2, v1
    v_mov_b32 v196, 0
    buffer_load_dword v3, v196, s[4:7], s39 offen sc1
    s_lshl_b32 s39, s3, 8
    s_add_u32 s39, s39, s2
    s_lshl_b32 s39, s39, 7
    s_add_u32 s39, s39, 0x1080000
    s_lshl_b32 s48, s2, 7
    s_add_u32 s48, s48, 0xbc0000
    s_mov_b32 exec_hi, 0
    buffer_store_dword v196, v4, s[4:7], s39 offen sc1
    s_mov_b32 exec_hi, -1
    s_cmp_eq_u32 s3, 0
    s_cselect_b32 s39, s49, s39
    s_cmp_lt_u32 s2, 64
    s_cselect_b32 s48, s48, s39
    s_cmp_eq_u32 s3, 1
    s_cselect_b32 s39, s48, s39
    s_mov_b32 exec_hi, 0
    buffer_store_dword v196, v4, s[4:7], s39 offen sc1
    s_mov_b32 exec_hi, -1
    v_mul_u32_u24 v12, 17, v12
    v_lshl_add_u32 v12, v11, 4, v12
    v_add_u32 v12, s43, v12
    v_lshl_add_u32 v13, v7, 4, v1
    v_add_u32 v13, s43, v13
    s_lshl_b32 s38, s16, 4
    s_add_u32 s39, s38, 1
    v_lshl_add_u32 v14, v7, 3, s39
    s_sub_u32 s39, 271, s38
    v_lshlrev_b32 v17, 3, v7
    v_sub_u32 v17, s39, v17
    s_mov_b32 vcc_lo, 0
    s_mov_b32 vcc_hi, -1
    v_cndmask_b32 v14, v14, v17, vcc
    v_cndmask_b32 v15, 1, -1, vcc
    s_add_u32 s39, s38, 128
    s_add_u32 s42, s38, 16
    s_and_b32 s42, s42, 127
    v_mov_b32 v16, s39
    v_mov_b32_e64 v17, s42
    v_cndmask_b32 v16, v16, v17, vcc
    v_mad_i32_i24 v17, v15, 7, v14
    s_mov_b32 vcc_lo, 0xffff0000
    s_mov_b32 vcc_hi, 0xffff0000
    v_cndmask_b32 v16, v17, v16, vcc
    v_lshlrev_b32 v17, 4, v6
    v_lshl_add_u32 v14, v14, 13, v17
    v_lshl_add_u32 v16, v16, 13, v17
    v_lshlrev_b32 v15, 13, v15
    s_lshl_b32 s42, s17, 8
    s_add_u32 s42, s42, 0x800000
    s_waitcnt vmcnt(10)
    ds_write_b128 v12, v[20:23] offset:0
    s_waitcnt vmcnt(9)
    ds_write_b128 v12, v[24:27] offset:1088
    s_waitcnt vmcnt(8)
    ds_write_b128 v12, v[28:31] offset:2176
    s_waitcnt vmcnt(7)
    ds_write_b128 v12, v[32:35] offset:3264
    s_waitcnt vmcnt(6)
    ds_write_b128 v12, v[36:39] offset:4352
    s_waitcnt vmcnt(5)
    ds_write_b128 v12, v[40:43] offset:5440
    s_waitcnt vmcnt(4)
    ds_write_b128 v12, v[44:47] offset:6528
    s_waitcnt vmcnt(3)
    ds_write_b128 v12, v[48:51] offset:7616
    ds_read_b128 v[52:55], v13 offset:0
    ds_read_b128 v[56:59], v13 offset:1088
    ds_read_b128 v[60:63], v13 offset:2176
    ds_read_b128 v[64:67], v13 offset:3264
    ds_read_b128 v[68:71], v13 offset:4352
    ds_read_b128 v[72:75], v13 offset:5440
    ds_read_b128 v[76:79], v13 offset:6528
    ds_read_b128 v[80:83], v13 offset:7616
    s_waitcnt lgkmcnt(6)
    v_perm_b32 v164, v56, v52, s46
    s_waitcnt lgkmcnt(4)
    v_perm_b32 v165, v64, v60, s46
    s_waitcnt lgkmcnt(2)
    v_perm_b32 v166, v72, v68, s46
    s_waitcnt lgkmcnt(0)
    v_perm_b32 v167, v80, v76, s46
    buffer_store_dwordx4 v[164:167], v14, s[4:7], s42 offen offset:0 sc1
    v_add_u32_e64 v14, v14, v15
    v_perm_b32 v168, v56, v52, s47
    v_perm_b32 v169, v64, v60, s47
    v_perm_b32 v170, v72, v68, s47
    v_perm_b32 v171, v80, v76, s47
    buffer_store_dwordx4 v[168:171], v14, s[4:7], s42 offen offset:0 sc1
    v_add_u32_e64 v14, v14, v15
    v_perm_b32 v172, v57, v53, s46
    v_perm_b32 v173, v65, v61, s46
    v_perm_b32 v174, v73, v69, s46
    v_perm_b32 v175, v81, v77, s46
    buffer_store_dwordx4 v[172:175], v14, s[4:7], s42 offen offset:0 sc1
    v_add_u32_e64 v14, v14, v15
    v_perm_b32 v176, v57, v53, s47
    v_perm_b32 v177, v65, v61, s47
    v_perm_b32 v178, v73, v69, s47
    v_perm_b32 v179, v81, v77, s47
    buffer_store_dwordx4 v[176:179], v14, s[4:7], s42 offen offset:0 sc1
    v_add_u32_e64 v14, v14, v15
    v_perm_b32 v180, v58, v54, s46
    v_perm_b32 v181, v66, v62, s46
    v_perm_b32 v182, v74, v70, s46
    v_perm_b32 v183, v82, v78, s46
    buffer_store_dwordx4 v[180:183], v14, s[4:7], s42 offen offset:0 sc1
    v_add_u32_e64 v14, v14, v15
    v_perm_b32 v184, v58, v54, s47
    v_perm_b32 v185, v66, v62, s47
    v_perm_b32 v186, v74, v70, s47
    v_perm_b32 v187, v82, v78, s47
    buffer_store_dwordx4 v[184:187], v14, s[4:7], s42 offen offset:0 sc1
    v_add_u32_e64 v14, v14, v15
    v_perm_b32 v188, v59, v55, s46
    v_perm_b32 v189, v67, v63, s46
    v_perm_b32 v190, v75, v71, s46
    v_perm_b32 v191, v83, v79, s46
    buffer_store_dwordx4 v[188:191], v14, s[4:7], s42 offen offset:0 sc1
    v_perm_b32 v192, v59, v55, s47
    v_perm_b32 v193, v67, v63, s47
    v_perm_b32 v194, v75, v71, s47
    v_perm_b32 v195, v83, v79, s47
    buffer_store_dwordx4 v[192:195], v16, s[4:7], s42 offen offset:0 sc1
    s_branch PRE_DONE
PRE_DONE:
    v_lshrrev_b32 v14, 6, v0
    v_lshl_add_u32 v6, v14, 11, v1
    s_mov_b32 s42, 0x400
    s_mov_b32 s43, 0x20000
    s_mov_b32 s46, 0x200000
    s_mov_b32 s47, 0x20000
    s_lshl_b32 s34, s2, 13
    s_mul_i32 s16, s3, 12288
    s_add_u32 s16, s16, 114688
    s_and_b32 s12, s2, 6
    s_lshl_b32 s12, s12, 1
    s_lshr_b32 s19, s2, 6
    s_add_u32 s12, s12, s19
    s_bfe_u32 s13, s2, 0x30003
    s_and_b32 s15, s2, 1
    s_lshl_b32 s19, s15, 3
    s_add_u32 s13, s13, s19
    s_bfe_u32 s14, s2, 0x10005
    s_lshl_b32 s15, s15, 1
    s_bfe_u32 s19, s2, 0x10003
    s_add_u32 s15, s15, s19
    s_bfe_u32 s19, s2, 0x10004
    s_lshl_b32 s19, s19, 2
    s_add_u32 s15, s15, s19
    s_lshl_b32 s38, s3, 12
    s_mul_i32 s18, s13, 114688
    s_add_u32 s18, s18, s38
    s_add_u32 s18, s18, 0xa00000
    s_mul_i32 s39, s15, 229376
    s_mul_i32 s25, s3, 57344
    s_add_u32 s39, s39, s25
    s_and_b32 s25, s3, 1
    s_xor_b32 s25, s25, 1
    s_lshl_b32 s25, s25, 11
    s_add_u32 s21, s39, s25
    s_add_u32 s21, s21, 0xc00000
    v_add_u32 v7, s16, v1
    v_and_b32_e64 v19, 1, v14
    v_lshl_add_u32 v8, v19, 10, v1
    v_add_u32 v8, 114688, v8
    v_bfe_u32 v15, v0, 4, 2
    v_lshlrev_b32 v15, 2, v15
    v_cvt_f32_u32 v9, v15
    v_and_b32 v16, 15, v0
    v_cvt_f32_u32 v11, v16
    v_lshrrev_b32_e64 v17, 1, v14
    v_lshl_add_u32 v19, v17, 5, v19
    v_lshl_add_u32 v17, v17, 4, v16
    v_lshl_add_u32 v16, v16, 1, v19
    v_cvt_f32_u32 v10, v16
    v_lshl_add_u32 v16, v15, 1, v19
    v_cvt_f32_u32 v16, v16
    v_cvt_f32_u32 v19, v17
    v_and_b32 v12, 1, v0
    v_mul_u32_u24 v12, 0x8000, v12
    v_lshl_or_b32 v12, v12, 16, v12
    v_mov_b32 v13, 0x4227c5ac
    v_mul_f32 v17, 0x3c800000, v10
    v_mul_f32_e64 v18, v17, v9
    v_fmamk_f32 v124, v17, 0x00000000, v18
    v_fmamk_f32 v125, v17, 0x3f800000, v18
    v_fmamk_f32 v126, v17, 0x40000000, v18
    v_fmamk_f32 v127, v17, 0x40400000, v18
    v_fmamk_f32 v128, v17, 0x41800000, v18
    v_fmamk_f32 v129, v17, 0x41880000, v18
    v_fmamk_f32 v130, v17, 0x41900000, v18
    v_fmamk_f32 v131, v17, 0x41980000, v18
    v_sin_f32 v244, v124
    v_cos_f32 v236, v124
    v_sin_f32 v245, v125
    v_cos_f32 v237, v125
    v_sin_f32 v246, v126
    v_cos_f32 v238, v126
    v_sin_f32 v247, v127
    v_cos_f32 v239, v127
    v_sin_f32 v248, v128
    v_cos_f32 v240, v128
    v_sin_f32 v249, v129
    v_cos_f32 v241, v129
    v_sin_f32 v250, v130
    v_cos_f32 v242, v130
    v_sin_f32 v251, v131
    v_cos_f32 v243, v131
    v_cvt_pk_bf16_f32 v44, v236, v244
    v_cvt_pk_bf16_f32 v48, -v244, v236
    v_cvt_pk_bf16_f32 v45, v237, v245
    v_cvt_pk_bf16_f32 v49, -v245, v237
    v_cvt_pk_bf16_f32 v46, v238, v246
    v_cvt_pk_bf16_f32 v50, -v246, v238
    v_cvt_pk_bf16_f32 v47, v239, v247
    v_cvt_pk_bf16_f32 v51, -v247, v239
    v_cvt_pk_bf16_f32 v52, v240, v248
    v_cvt_pk_bf16_f32 v56, -v248, v240
    v_cvt_pk_bf16_f32 v53, v241, v249
    v_cvt_pk_bf16_f32 v57, -v249, v241
    v_cvt_pk_bf16_f32 v54, v242, v250
    v_cvt_pk_bf16_f32 v58, -v250, v242
    v_cvt_pk_bf16_f32 v55, v243, v251
    v_cvt_pk_bf16_f32 v59, -v251, v243
    v_mul_f32 v124, 0x3d000000, v124
    v_mul_f32 v125, 0x3d000000, v125
    v_mul_f32 v126, 0x3d000000, v126
    v_mul_f32 v127, 0x3d000000, v127
    v_mul_f32 v128, 0x3d000000, v128
    v_mul_f32 v129, 0x3d000000, v129
    v_mul_f32 v130, 0x3d000000, v130
    v_mul_f32 v131, 0x3d000000, v131
    v_sin_f32 v132, v124
    v_cos_f32 v124, v124
    v_sin_f32 v133, v125
    v_cos_f32 v125, v125
    v_sin_f32 v134, v126
    v_cos_f32 v126, v126
    v_sin_f32 v135, v127
    v_cos_f32 v127, v127
    v_sin_f32 v136, v128
    v_cos_f32 v128, v128
    v_sin_f32 v137, v129
    v_cos_f32 v129, v129
    v_sin_f32 v138, v130
    v_cos_f32 v130, v130
    v_sin_f32 v139, v131
    v_cos_f32 v131, v131
    v_mul_f32 v17, 0x3d000000, v11
    v_mul_f32 v18, v17, v9
    v_fmamk_f32 v140, v17, 0x00000000, v18
    s_waitcnt vmcnt(0)
    v_add_u32 v3, 1, v3
    v_max_u32_e64 v3, 1, v3
    s_nop 0
    v_readfirstlane_b32 s48, v3
    s_barrier
    s_cmp_lg_u32 s3, 0
    s_cbranch_scc1 PUB1
    s_mov_b32 exec_hi, 0
    buffer_store_dword v3, v4, s[4:7], s49 offen sc1
    s_mov_b64 exec, -1
PUB1:
    v_fmamk_f32 v141, v17, 0x3f800000, v18
    v_fmamk_f32 v142, v17, 0x40000000, v18
    v_fmamk_f32 v143, v17, 0x40400000, v18
    v_sin_f32 v148, v140
    v_cos_f32 v140, v140
    v_sin_f32 v149, v141
    v_cos_f32 v141, v141
    v_sin_f32 v150, v142
    v_cos_f32 v142, v142
    v_sin_f32 v151, v143
    v_cos_f32 v143, v143
    v_cvt_pk_bf16_f32 v92, v140, v148
    v_cvt_pk_bf16_f32 v96, -v148, v140
    v_cvt_pk_bf16_f32 v93, v141, v149
    v_cvt_pk_bf16_f32 v97, -v149, v141
    v_cvt_pk_bf16_f32 v94, v142, v150
    v_cvt_pk_bf16_f32 v98, -v150, v142
    v_cvt_pk_bf16_f32 v95, v143, v151
    v_cvt_pk_bf16_f32 v99, -v151, v143
    v_xor_b32 v100, v12, v92
    v_xor_b32 v101, v12, v93
    v_xor_b32 v102, v12, v94
    v_xor_b32 v103, v12, v95
    v_xor_b32 v104, v12, v96
    v_xor_b32 v105, v12, v97
    v_xor_b32 v106, v12, v98
    v_xor_b32 v107, v12, v99
    v_mov_b32 v108, v92
    v_xor_b32 v109, 0x80008000, v93
    v_mov_b32 v110, v94
    v_xor_b32 v111, 0x80008000, v95
    v_mov_b32 v112, v96
    v_xor_b32 v113, 0x80008000, v97
    v_mov_b32 v114, v98
    v_xor_b32 v115, 0x80008000, v99
    v_mov_b32 v116, v100
    v_xor_b32 v117, 0x80008000, v101
    v_mov_b32 v118, v102
    v_xor_b32 v119, 0x80008000, v103
    v_mov_b32 v120, v104
    v_xor_b32 v121, 0x80008000, v105
    v_mov_b32 v122, v106
    v_xor_b32 v123, 0x80008000, v107
    v_mul_f32 v17, 0x3a000000, v11
    v_mul_f32_e64 v18, v17, v16
    v_fmamk_f32 v140, v17, 0x00000000, v18
    v_fmamk_f32 v141, v17, 0x40000000, v18
    v_fmamk_f32 v142, v17, 0x40800000, v18
    v_fmamk_f32 v143, v17, 0x40c00000, v18
    v_add_f32 v17, 0x3c000000, v17
    v_mul_f32_e64 v18, v17, v16
    v_fmamk_f32 v144, v17, 0x00000000, v18
    v_fmamk_f32 v145, v17, 0x40000000, v18
    v_fmamk_f32 v146, v17, 0x40800000, v18
    v_fmamk_f32 v147, v17, 0x40c00000, v18
    v_sin_f32 v148, v140
    v_cos_f32 v140, v140
    v_sin_f32 v149, v141
    v_cos_f32 v141, v141
    v_sin_f32 v150, v142
    v_cos_f32 v142, v142
    v_sin_f32 v151, v143
    v_cos_f32 v143, v143
    v_sin_f32 v152, v144
    v_cos_f32 v144, v144
    v_sin_f32 v153, v145
    v_cos_f32 v145, v145
    v_sin_f32 v154, v146
    v_cos_f32 v146, v146
    v_sin_f32 v155, v147
    v_cos_f32 v147, v147
    v_and_b32 v213, 15, v0
    v_lshl_add_u32 v213, v14, 4, v213
    v_lshlrev_b32 v213, 7, v213
    v_and_b32 v5, 31, v0
    v_lshl_add_u32 v5, v14, 5, v5
    v_lshlrev_b32 v5, 7, v5
    s_mov_b32 s35, 0x1000000
    buffer_load_dword v2, v213, s[4:7], s35 offen sc1
    s_waitcnt vmcnt(0)
    v_cmp_ne_u32 vcc, s48, v2
    s_cbranch_vccz GO2
    s_mov_b32 s25, 0
POLL2:
    s_mov_b64 exec, vcc
    buffer_load_dword v2, v213, s[4:7], s35 offen sc1
    s_add_u32 s25, s25, 1
    s_waitcnt vmcnt(0)
    v_cmp_ne_u32 vcc, s48, v2
    s_cmp_lt_u32 s25, 0x8000
    s_cselect_b64 vcc, vcc, 0
    s_cbranch_vccnz POLL2
    s_mov_b64 exec, -1
GO2:
    s_mov_b32 s26, 0xbc0000
    s_add_u32 s19, s34, 0x0
    buffer_load_dwordx4 v[20:23], v6, s[4:7], s19 offen offset:0 sc1
    buffer_load_dwordx4 v[28:31], v6, s[4:7], s26 offen offset:0 sc1
    buffer_load_dwordx4 v[24:27], v6, s[4:7], s19 offen offset:1024 sc1
    buffer_load_dwordx4 v[32:35], v6, s[4:7], s26 offen offset:1024 sc1
    s_add_u32 s27, s35, 8192
    buffer_load_dword v2, v213, s[4:7], s27 offen sc1
    s_add_u32 s35, s35, 16384
    v_mul_f32 v17, 0x3c800000, v19
    v_mul_f32 v18, v17, v9
    v_add_f32 v18, v18, v18
    v_fmamk_f32 v76, v17, 0x00000000, v18
    v_fmamk_f32 v77, v17, 0x40000000, v18
    v_fmamk_f32 v78, v17, 0x40800000, v18
    v_fmamk_f32 v79, v17, 0x40c00000, v18
    v_fmamk_f32 v80, v17, 0x3f800000, v18
    v_fmamk_f32 v81, v17, 0x40400000, v18
    v_fmamk_f32 v82, v17, 0x40a00000, v18
    v_fmamk_f32 v83, v17, 0x40e00000, v18
    v_sin_f32 v84, v76
    v_cos_f32 v76, v76
    v_sin_f32 v85, v77
    v_cos_f32 v77, v77
    v_sin_f32 v86, v78
    v_cos_f32 v78, v78
    v_sin_f32 v87, v79
    v_cos_f32 v79, v79
    v_sin_f32 v88, v80
    v_cos_f32 v80, v80
    v_sin_f32 v89, v81
    v_cos_f32 v81, v81
    v_sin_f32 v90, v82
    v_cos_f32 v82, v82
    v_sin_f32 v91, v83
    v_cos_f32 v83, v83
    v_cvt_pk_bf16_f32 v60, v76, v84
    v_cvt_pk_bf16_f32 v64, -v84, v76
    v_cvt_pk_bf16_f32 v61, v77, v85
    v_cvt_pk_bf16_f32 v65, -v85, v77
    v_cvt_pk_bf16_f32 v62, v78, v86
    v_cvt_pk_bf16_f32 v66, -v86, v78
    v_cvt_pk_bf16_f32 v63, v79, v87
    v_cvt_pk_bf16_f32 v67, -v87, v79
    v_cvt_pk_bf16_f32 v68, v80, v88
    v_cvt_pk_bf16_f32 v72, -v88, v80
    v_cvt_pk_bf16_f32 v69, v81, v89
    v_cvt_pk_bf16_f32 v73, -v89, v81
    v_cvt_pk_bf16_f32 v70, v82, v90
    v_cvt_pk_bf16_f32 v74, -v90, v82
    v_cvt_pk_bf16_f32 v71, v83, v91
    v_cvt_pk_bf16_f32 v75, -v91, v83
    v_xor_b32 v76, v12, v60
    v_xor_b32 v77, v12, v61
    v_xor_b32 v78, v12, v62
    v_xor_b32 v79, v12, v63
    v_xor_b32 v80, v12, v64
    v_xor_b32 v81, v12, v65
    v_xor_b32 v82, v12, v66
    v_xor_b32 v83, v12, v67
    v_xor_b32 v84, v12, v68
    v_xor_b32 v85, v12, v69
    v_xor_b32 v86, v12, v70
    v_xor_b32 v87, v12, v71
    v_xor_b32 v88, v12, v72
    v_xor_b32 v89, v12, v73
    v_xor_b32 v90, v12, v74
    v_xor_b32 v91, v12, v75
    s_waitcnt vmcnt(4)
    v_lshlrev_b32 v172, 16, v20
    v_and_b32 v176, 0xffff0000, v20
    v_lshlrev_b32 v173, 16, v21
    v_and_b32 v177, 0xffff0000, v21
    v_lshlrev_b32 v174, 16, v22
    v_and_b32 v178, 0xffff0000, v22
    v_lshlrev_b32 v175, 16, v23
    v_and_b32 v179, 0xffff0000, v23
    s_waitcnt vmcnt(3)
    v_pk_mul_f32 v[236:237], v[172:173], v[28:29]
    v_pk_mul_f32 v[238:239], v[174:175], v[30:31]
    v_pk_mul_f32 v[240:241], v[176:177], v[28:29]
    v_pk_mul_f32 v[242:243], v[178:179], v[30:31]
    s_waitcnt vmcnt(2)
    v_lshlrev_b32 v180, 16, v24
    v_and_b32 v184, 0xffff0000, v24
    v_lshlrev_b32 v181, 16, v25
    v_and_b32 v185, 0xffff0000, v25
    v_lshlrev_b32 v182, 16, v26
    v_and_b32 v186, 0xffff0000, v26
    v_lshlrev_b32 v183, 16, v27
    v_and_b32 v187, 0xffff0000, v27
    s_waitcnt vmcnt(1)
    v_pk_fma_f32 v[244:245], v[180:181], v[32:33], v[236:237]
    v_pk_fma_f32 v[246:247], v[182:183], v[34:35], v[238:239]
    v_pk_fma_f32 v[248:249], v[184:185], v[32:33], v[240:241]
    v_pk_fma_f32 v[250:251], v[186:187], v[34:35], v[242:243]
    v_cvt_pk_bf16_f32 v228, v244, v248
    v_cvt_pk_bf16_f32 v229, v245, v249
    v_cvt_pk_bf16_f32 v230, v246, v250
    v_cvt_pk_bf16_f32 v231, v247, v251
    v_pk_fma_f32 v[244:245], v[180:181], v[32:33], v[236:237] neg_lo:[1,0,0] neg_hi:[1,0,0]
    v_pk_fma_f32 v[246:247], v[182:183], v[34:35], v[238:239] neg_lo:[1,0,0] neg_hi:[1,0,0]
    v_pk_fma_f32 v[248:249], v[184:185], v[32:33], v[240:241] neg_lo:[1,0,0] neg_hi:[1,0,0]
    v_pk_fma_f32 v[250:251], v[186:187], v[34:35], v[242:243] neg_lo:[1,0,0] neg_hi:[1,0,0]
    v_cvt_pk_bf16_f32 v232, v244, v248
    v_cvt_pk_bf16_f32 v233, v245, v249
    v_cvt_pk_bf16_f32 v234, v246, v250
    v_cvt_pk_bf16_f32 v235, v247, v251
    s_cmp_lg_u32 s2, 0
    s_cbranch_scc1 COL_A0
    v_and_b32 v228, 0xffff, v228
    v_and_b32 v229, 0xffff, v229
    v_and_b32 v230, 0xffff, v230
    v_and_b32 v231, 0xffff, v231
    v_and_b32 v232, 0xffff, v232
    v_and_b32 v233, 0xffff, v233
    v_and_b32 v234, 0xffff, v234
    v_and_b32 v235, 0xffff, v235
COL_A0:
    ds_write_b128 v7, v[228:231] offset:0
    ds_write_b128 v7, v[232:235] offset:1024
    s_waitcnt vmcnt(0)
    v_cmp_ne_u32 vcc, s48, v2
    s_cbranch_vccz GO3
    s_mov_b32 s25, 0
POLL3:
    s_mov_b64 exec, vcc
    buffer_load_dword v2, v213, s[4:7], s27 offen sc1
    s_add_u32 s25, s25, 1
    s_waitcnt vmcnt(0)
    v_cmp_ne_u32 vcc, s48, v2
    s_cmp_lt_u32 s25, 0x8000
    s_cselect_b64 vcc, vcc, 0
    s_cbranch_vccnz POLL3
    s_mov_b64 exec, -1
GO3:
    s_add_u32 s19, s34, 0x800000
    buffer_load_dwordx4 v[36:39], v6, s[4:7], s19 offen offset:0 sc1
    buffer_load_dwordx4 v[40:43], v6, s[4:7], s19 offen offset:1024 sc1
    s_waitcnt lgkmcnt(0)
    s_barrier
    ds_read_b128 v[188:191], v8 offset:0
    ds_read_b128 v[192:195], v8 offset:24576
    ds_read_b128 v[196:199], v8 offset:12288
    ds_read_b128 v[200:203], v8 offset:36864
    v_pk_mul_f32 v[236:237], v[172:173], 0.5 op_sel_hi:[1,0]
    v_pk_mul_f32 v[238:239], v[174:175], 0.5 op_sel_hi:[1,0]
    v_pk_mul_f32 v[240:241], v[176:177], 0.5 op_sel_hi:[1,0]
    v_pk_mul_f32 v[242:243], v[178:179], 0.5 op_sel_hi:[1,0]
    v_pk_fma_f32 v[172:173], v[180:181], 0.5, v[236:237] op_sel_hi:[1,0,1]
    v_pk_fma_f32 v[180:181], v[180:181], -0.5, v[236:237] op_sel_hi:[1,0,1]
    v_pk_fma_f32 v[174:175], v[182:183], 0.5, v[238:239] op_sel_hi:[1,0,1]
    v_pk_fma_f32 v[182:183], v[182:183], -0.5, v[238:239] op_sel_hi:[1,0,1]
    v_pk_fma_f32 v[176:177], v[184:185], 0.5, v[240:241] op_sel_hi:[1,0,1]
    v_pk_fma_f32 v[184:185], v[184:185], -0.5, v[240:241] op_sel_hi:[1,0,1]
    v_pk_fma_f32 v[178:179], v[186:187], 0.5, v[242:243] op_sel_hi:[1,0,1]
    v_pk_fma_f32 v[186:187], v[186:187], -0.5, v[242:243] op_sel_hi:[1,0,1]
    buffer_load_dword v2, v5, s[4:7], s35 offen sc1
    s_waitcnt lgkmcnt(3)
    v_mfma_f32_16x16x32_bf16 v[212:215], v[188:191], v[44:47], 0
    v_mov_b32 v28, -1
    v_mov_b32 v29, -1
    s_waitcnt lgkmcnt(2)
    v_mfma_f32_16x16x32_bf16 v[212:215], v[192:195], v[52:55], v[212:215]
    s_add_u32 s26, s34, 0x400000
    v_mov_b32 v30, -1
    v_mov_b32_e64 v31, -1
    v_mfma_f32_16x16x32_bf16 v[216:219], v[188:191], v[48:51], 0
    buffer_store_dwordx4 v[28:31], v6, s[4:7], s26 offen offset:0 sc1
    v_mfma_f32_16x16x32_bf16 v[216:219], v[192:195], v[56:59], v[216:219]
    s_waitcnt lgkmcnt(1)
    v_mfma_f32_16x16x32_bf16 v[220:223], v[196:199], v[44:47], 0
    s_waitcnt lgkmcnt(0)
    v_mfma_f32_16x16x32_bf16 v[220:223], v[200:203], v[52:55], v[220:223]
    v_mfma_f32_16x16x32_bf16 v[224:227], v[196:199], v[48:51], 0
    buffer_store_dwordx4 v[28:31], v6, s[4:7], s26 offen offset:1024 sc1
    v_mfma_f32_16x16x32_bf16 v[224:227], v[200:203], v[56:59], v[224:227]
    s_nop 0
    v_pk_mul_f32 v[236:237], v[216:217], v[132:133]
    v_pk_mul_f32 v[240:241], v[212:213], v[132:133]
    v_pk_mul_f32 v[238:239], v[218:219], v[134:135]
    v_pk_mul_f32 v[242:243], v[214:215], v[134:135]
    v_pk_fma_f32 v[236:237], v[212:213], v[124:125], v[236:237]
    v_pk_fma_f32 v[240:241], v[216:217], v[124:125], v[240:241] neg_lo:[0,0,1] neg_hi:[0,0,1]
    v_pk_fma_f32 v[238:239], v[214:215], v[126:127], v[238:239]
    v_pk_fma_f32 v[242:243], v[218:219], v[126:127], v[242:243] neg_lo:[0,0,1] neg_hi:[0,0,1]
    v_cvt_pk_bf16_f32 v228, v236, v240
    v_cvt_pk_bf16_f32 v229, v237, v241
    v_cvt_pk_bf16_f32 v230, v238, v242
    v_cvt_pk_bf16_f32 v231, v239, v243
    v_pk_mul_f32 v[236:237], v[224:225], v[136:137]
    v_pk_mul_f32 v[240:241], v[220:221], v[136:137]
    v_pk_mul_f32 v[238:239], v[226:227], v[138:139]
    v_pk_mul_f32 v[242:243], v[222:223], v[138:139]
    v_pk_fma_f32 v[236:237], v[220:221], v[128:129], v[236:237]
    v_pk_fma_f32 v[240:241], v[224:225], v[128:129], v[240:241] neg_lo:[0,0,1] neg_hi:[0,0,1]
    v_pk_fma_f32 v[238:239], v[222:223], v[130:131], v[238:239]
    v_pk_fma_f32 v[242:243], v[226:227], v[130:131], v[242:243] neg_lo:[0,0,1] neg_hi:[0,0,1]
    v_cvt_pk_bf16_f32 v232, v236, v240
    v_cvt_pk_bf16_f32 v233, v237, v241
    v_cvt_pk_bf16_f32 v234, v238, v242
    v_cvt_pk_bf16_f32 v235, v239, v243
    v_mfma_f32_16x16x32_bf16 v[188:191], v[92:95], v[228:231], 0
    s_waitcnt vmcnt(4)
    v_lshlrev_b32 v156, 16, v36
    v_and_b32 v164, 0xffff0000, v36
    v_mfma_f32_16x16x32_bf16 v[188:191], v[100:103], v[232:235], v[188:191]
    v_lshlrev_b32 v157, 16, v37
    v_and_b32 v165, 0xffff0000, v37
    v_mfma_f32_16x16x32_bf16 v[192:195], v[96:99], v[228:231], 0
    v_lshlrev_b32 v158, 16, v38
    v_and_b32 v166, 0xffff0000, v38
    v_mfma_f32_16x16x32_bf16 v[192:195], v[104:107], v[232:235], v[192:195]
    v_lshlrev_b32 v159, 16, v39
    v_and_b32 v167, 0xffff0000, v39
    v_mfma_f32_16x16x32_bf16 v[196:199], v[108:111], v[228:231], 0
    s_waitcnt vmcnt(3)
    v_lshlrev_b32 v160, 16, v40
    v_and_b32 v168, 0xffff0000, v40
    v_mfma_f32_16x16x32_bf16 v[196:199], v[116:119], v[232:235], v[196:199]
    v_lshlrev_b32 v161, 16, v41
    v_and_b32 v169, 0xffff0000, v41
    v_mfma_f32_16x16x32_bf16 v[200:203], v[112:115], v[228:231], 0
    v_lshlrev_b32 v162, 16, v42
    v_and_b32 v170, 0xffff0000, v42
    v_mfma_f32_16x16x32_bf16 v[200:203], v[120:123], v[232:235], v[200:203]
    v_lshlrev_b32_e64 v163, 16, v43
    v_and_b32 v171, 0xffff0000, v43
    v_pk_mul_f32 v[236:237], v[192:193], v[164:165]
    v_pk_mul_f32 v[240:241], v[188:189], v[164:165]
    v_pk_mul_f32 v[238:239], v[194:195], v[166:167]
    v_pk_mul_f32 v[242:243], v[190:191], v[166:167]
    v_pk_fma_f32 v[236:237], v[188:189], v[156:157], v[236:237] neg_lo:[0,0,1] neg_hi:[0,0,1]
    v_pk_fma_f32 v[240:241], v[192:193], v[156:157], v[240:241]
    v_pk_fma_f32 v[238:239], v[190:191], v[158:159], v[238:239] neg_lo:[0,0,1] neg_hi:[0,0,1]
    v_pk_fma_f32 v[242:243], v[194:195], v[158:159], v[242:243]
    v_cvt_pk_bf16_f32 v204, v240, v236
    v_cvt_pk_bf16_f32 v205, v241, v237
    v_cvt_pk_bf16_f32 v206, v242, v238
    v_cvt_pk_bf16_f32 v207, v243, v239
    v_pk_mul_f32 v[236:237], v[200:201], v[168:169]
    v_pk_mul_f32 v[240:241], v[196:197], v[168:169]
    v_pk_mul_f32 v[238:239], v[202:203], v[170:171]
    v_pk_mul_f32 v[242:243], v[198:199], v[170:171]
    v_pk_fma_f32 v[236:237], v[196:197], v[160:161], v[236:237] neg_lo:[0,0,1] neg_hi:[0,0,1]
    v_pk_fma_f32 v[240:241], v[200:201], v[160:161], v[240:241]
    v_pk_fma_f32 v[238:239], v[198:199], v[162:163], v[238:239] neg_lo:[0,0,1] neg_hi:[0,0,1]
    v_pk_fma_f32 v[242:243], v[202:203], v[162:163], v[242:243]
    v_cvt_pk_bf16_f32 v208, v240, v236
    v_cvt_pk_bf16_f32 v209, v241, v237
    v_cvt_pk_bf16_f32 v210, v242, v238
    v_cvt_pk_bf16_f32 v211, v243, v239
    v_mfma_f32_16x16x32_bf16 v[216:219], v[204:207], v[92:95], 0
    s_nop 0
    v_mfma_f32_16x16x32_bf16 v[216:219], v[208:211], v[100:103], v[216:219]
    v_mfma_f32_16x16x32_bf16 v[212:215], v[204:207], v[96:99], 0
    v_mfma_f32_16x16x32_bf16 v[212:215], v[208:211], v[104:107], v[212:215]
    v_mfma_f32_16x16x32_bf16 v[224:227], v[204:207], v[108:111], 0
    v_mfma_f32_16x16x32_bf16 v[224:227], v[208:211], v[116:119], v[224:227]
    v_mfma_f32_16x16x32_bf16 v[220:223], v[204:207], v[112:115], 0
    v_mfma_f32_16x16x32_bf16 v[220:223], v[208:211], v[120:123], v[220:223]
    s_nop 1
    v_pk_mul_f32 v[236:237], v[216:217], v[148:149]
    s_nop 0
    v_pk_mul_f32 v[240:241], v[212:213], v[148:149]
    v_pk_mul_f32 v[238:239], v[218:219], v[150:151]
    v_pk_mul_f32 v[242:243], v[214:215], v[150:151]
    v_pk_fma_f32 v[236:237], v[212:213], v[140:141], v[236:237] neg_lo:[0,0,1] neg_hi:[0,0,1]
    v_pk_fma_f32 v[240:241], v[216:217], v[140:141], v[240:241]
    v_pk_fma_f32 v[238:239], v[214:215], v[142:143], v[238:239] neg_lo:[0,0,1] neg_hi:[0,0,1]
    v_pk_fma_f32 v[242:243], v[218:219], v[142:143], v[242:243]
    v_cvt_pk_bf16_f32 v228, v240, v236
    v_cvt_pk_bf16_f32 v229, v241, v237
    v_cvt_pk_bf16_f32 v230, v242, v238
    v_cvt_pk_bf16_f32 v231, v243, v239
    ds_write_b128 v7, v[228:231] offset:2048
    v_pk_mul_f32 v[236:237], v[224:225], v[152:153]
    v_pk_mul_f32 v[240:241], v[220:221], v[152:153]
    v_pk_mul_f32 v[238:239], v[226:227], v[154:155]
    v_pk_mul_f32 v[242:243], v[222:223], v[154:155]
    v_pk_fma_f32 v[236:237], v[220:221], v[144:145], v[236:237] neg_lo:[0,0,1] neg_hi:[0,0,1]
    v_pk_fma_f32 v[240:241], v[224:225], v[144:145], v[240:241]
    v_pk_fma_f32 v[238:239], v[222:223], v[146:147], v[238:239] neg_lo:[0,0,1] neg_hi:[0,0,1]
    v_pk_fma_f32 v[242:243], v[226:227], v[146:147], v[242:243]
    v_cvt_pk_bf16_f32 v232, v240, v236
    v_cvt_pk_bf16_f32 v233, v241, v237
    v_cvt_pk_bf16_f32 v234, v242, v238
    v_cvt_pk_bf16_f32 v235, v243, v239
    ds_write_b128 v7, v[232:235] offset:3072
    s_add_u32 s19, s34, 0x200000
    s_waitcnt vmcnt(2)
    v_cmp_ne_u32 vcc, s48, v2
    s_cbranch_vccz GO4
    s_mov_b32 s25, 0
POLL4:
    s_mov_b64 exec, vcc
    buffer_load_dword v2, v5, s[4:7], s35 offen sc1
    s_add_u32 s25, s25, 1
    s_waitcnt vmcnt(0)
    v_cmp_ne_u32 vcc, s48, v2
    s_cmp_lt_u32 s25, 0x8000
    s_cselect_b64 vcc, vcc, 0
    s_cbranch_vccnz POLL4
    s_mov_b64 exec, -1
GO4:
    s_waitcnt lgkmcnt(0)
    s_barrier
    ds_read_b128 v[188:191], v8 offset:2048
    ds_read_b128 v[196:199], v8 offset:26624
    ds_read_b128 v[192:195], v8 offset:14336
    ds_read_b128 v[200:203], v8 offset:38912
    s_waitcnt lgkmcnt(3)
    v_mfma_f32_16x16x32_bf16 v[176:179], v[60:63], v[188:191], v[176:179]
    s_waitcnt lgkmcnt(2)
    v_mfma_f32_16x16x32_bf16 v[176:179], v[76:79], v[196:199], v[176:179]
    v_mfma_f32_16x16x32_bf16 v[172:175], v[64:67], v[188:191], v[172:175]
    v_mfma_f32_16x16x32_bf16 v[172:175], v[80:83], v[196:199], v[172:175]
    s_waitcnt lgkmcnt(1)
    v_mfma_f32_16x16x32_bf16 v[184:187], v[68:71], v[192:195], v[184:187]
    s_waitcnt lgkmcnt(0)
    v_mfma_f32_16x16x32_bf16 v[184:187], v[84:87], v[200:203], v[184:187]
    v_mfma_f32_16x16x32_bf16 v[180:183], v[72:75], v[192:195], v[180:183]
    v_mfma_f32_16x16x32_bf16 v[180:183], v[88:91], v[200:203], v[180:183]
    s_cmp_lg_u32 s2, 0
    s_nop 6
    v_pk_add_f32 v[236:237], v[172:173], v[180:181]
    v_pk_add_f32 v[238:239], v[174:175], v[182:183]
    v_pk_add_f32 v[240:241], v[176:177], v[184:185]
    v_pk_add_f32 v[242:243], v[178:179], v[186:187]
    v_cvt_pk_bf16_f32 v228, v236, v240
    v_cvt_pk_bf16_f32 v229, v237, v241
    v_cvt_pk_bf16_f32 v230, v238, v242
    v_cvt_pk_bf16_f32 v231, v239, v243
    s_cbranch_scc1 COL_B00
    s_mov_b32 s25, 0xffff
    v_bfi_b32 v228, s25, v228, v20
    v_bfi_b32 v229, s25, v229, v21
    v_bfi_b32 v230, s25, v230, v22
    v_bfi_b32 v231, s25, v231, v23
COL_B00:
    buffer_store_dwordx4 v[228:231], v6, s[4:7], s19 offen offset:0 sc1
    v_pk_add_f32 v[236:237], v[172:173], v[180:181] neg_lo:[0,1] neg_hi:[0,1]
    v_pk_add_f32 v[238:239], v[174:175], v[182:183] neg_lo:[0,1] neg_hi:[0,1]
    v_pk_add_f32 v[240:241], v[176:177], v[184:185] neg_lo:[0,1] neg_hi:[0,1]
    v_pk_add_f32 v[242:243], v[178:179], v[186:187] neg_lo:[0,1] neg_hi:[0,1]
    v_cvt_pk_bf16_f32 v232, v236, v240
    v_cvt_pk_bf16_f32 v233, v237, v241
    v_cvt_pk_bf16_f32 v234, v238, v242
    v_cvt_pk_bf16_f32 v235, v239, v243
    s_cbranch_scc1 COL_B01
    s_mov_b32 s25, 0xffff
    v_bfi_b32 v232, s25, v232, v24
    v_bfi_b32 v233, s25, v233, v25
    v_bfi_b32 v234, s25, v234, v26
    v_bfi_b32 v235, s25, v235, v27
COL_B01:
    buffer_store_dwordx4 v[232:235], v6, s[4:7], s19 offen offset:1024 sc1
    s_add_u32 m0, s38, 0
    s_add_u32 s20, s18, 0
    buffer_load_dwordx4 v1, s[4:7], s20 offen offset:0 sc1 lds
    buffer_load_dwordx4 v1, s[4:7], s20 offen offset:1024 sc1 lds
    buffer_load_dwordx4 v1, s[4:7], s20 offen offset:2048 sc1 lds
    buffer_load_dwordx4 v1, s[4:7], s20 offen offset:3072 sc1 lds
    s_add_u32 m0, s38, 16384
    s_add_u32 s20, s18, 16384
    buffer_load_dwordx4 v1, s[4:7], s20 offen offset:0 sc1 lds
    buffer_load_dwordx4 v1, s[4:7], s20 offen offset:1024 sc1 lds
    buffer_load_dwordx4 v1, s[4:7], s20 offen offset:2048 sc1 lds
    buffer_load_dwordx4 v1, s[4:7], s20 offen offset:3072 sc1 lds
    s_add_u32 m0, s38, 32768
    s_add_u32 s20, s18, 32768
    buffer_load_dwordx4 v1, s[4:7], s20 offen offset:0 sc1 lds
    buffer_load_dwordx4 v1, s[4:7], s20 offen offset:1024 sc1 lds
    s_lshl_b32 s25, s3, 8
    s_add_u32 s25, s25, s2
    s_mul_i32 s25, s25, 128
    s_add_u32 s25, s25, 0x1080000
    s_waitcnt vmcnt(10)
    s_mov_b32 exec_hi, 0
    buffer_store_dword v3, v4, s[4:7], s25 offen sc1
    s_mov_b64 exec, -1
    buffer_load_dwordx4 v1, s[4:7], s20 offen offset:2048 sc1 lds
    v_accvgpr_write_b32 a224, v36
    v_accvgpr_write_b32 a225, v37
    v_accvgpr_write_b32 a226, v38
    v_accvgpr_write_b32 a227, v39
    v_accvgpr_write_b32 a228, v40
    buffer_load_dwordx4 v1, s[4:7], s20 offen offset:3072 sc1 lds
    v_accvgpr_write_b32 a229, v41
    v_accvgpr_write_b32 a230, v42
    v_accvgpr_write_b32 a231, v43
    v_mov_b32 v14, 0xbdd2d3e8
    v_mov_b32 v15, 0xc0135761
    s_add_u32 m0, s38, 49152
    s_add_u32 s20, s18, 49152
    buffer_load_dwordx4 v1, s[4:7], s20 offen offset:0 sc1 lds
    v_lshrrev_b32 v16, 6, v0
    v_bfe_u32 v17, v0, 3, 2
    v_lshlrev_b32_e64 v5, 19, v17
    v_bfe_u32 v17, v0, 5, 1
    v_lshl_add_u32 v5, v17, 17, v5
    buffer_load_dwordx4 v1, s[4:7], s20 offen offset:1024 sc1 lds
    v_and_b32_e64 v17, 7, v0
    v_lshl_add_u32 v5, v17, 4, v5
    v_lshl_add_u32 v5, v16, 7, v5
    v_add_u32 v6, 261120, v5
    v_lshrrev_b32 v17, 1, v1
    buffer_load_dwordx4 v1, s[4:7], s20 offen offset:2048 sc1 lds
    v_add_u32 v7, s16, v17
    v_and_b32 v17, 48, v0
    v_add_u32 v9, s16, v17
    v_add_u32 v10, 65536, v1
    v_bfe_u32 v17, v0, 4, 1
    buffer_load_dwordx4 v1, s[4:7], s20 offen offset:3072 sc1 lds
    v_mul_u32_u24 v8, 57344, v17
    v_bfe_u32 v17, v0, 5, 1
    v_lshl_add_u32 v8, v17, 8, v8
    v_and_b32_e64 v17, 15, v0
    v_lshl_add_u32 v8, v17, 4, v8
    s_add_u32 m0, s38, 65536
    s_add_u32 s20, s18, 65536
    buffer_load_dwordx4 v1, s[4:7], s20 offen offset:0 sc1 lds
    v_mul_u32_u24 v11, 128, v0
    s_lshl_b32 s17, s12, 9
    s_add_u32 s17, s17, 0x200000
    s_lshr_b32 s35, s12, 2
    s_mul_i32 s35, s35, 32768
    buffer_load_dwordx4 v1, s[4:7], s20 offen offset:1024 sc1 lds
    s_add_u32 s35, s35, 0x1080000
    s_mul_i32 s22, s12, 458752
    s_add_u32 s22, s22, 0x1200000
    s_mul_i32 s26, s3, 114688
    s_add_u32 s26, s26, s22
    buffer_load_dwordx4 v1, s[4:7], s20 offen offset:2048 sc1 lds
    s_lshr_b32 s25, s13, 2
    s_mul_i32 s25, s25, 14336
    s_add_u32 s26, s26, s25
    s_and_b32 s25, s13, 3
    s_lshl_b32 s25, s25, 9
    buffer_load_dwordx4 v1, s[4:7], s20 offen offset:3072 sc1 lds
    s_add_u32 s28, s26, s25
    s_add_u32 s27, s28, s25
    s_lshl_b32 s25, s25, 2
    s_add_u32 s26, s26, s25
    s_add_u32 s28, s28, 12288
    s_add_u32 m0, s38, 81920
    s_add_u32 s20, s18, 81920
    buffer_load_dwordx4 v1, s[4:7], s20 offen offset:0 sc1 lds
    s_add_u32 s27, s27, 8192
    s_mul_i32 s25, s14, 229376
    s_add_u32 s22, s22, s25
    s_mul_i32 s25, s3, 14336
    s_add_u32 s22, s22, s25
    buffer_load_dwordx4 v1, s[4:7], s20 offen offset:1024 sc1 lds
    s_and_b32 s24, s3, 2
    s_xor_b32 s25, s24, 2
    s_mul_i32 s25, s25, 57344
    s_add_u32 s30, s22, s25
    s_xor_b32 s25, s24, 3
    buffer_load_dwordx4 v1, s[4:7], s20 offen offset:2048 sc1 lds
    s_mul_i32 s25, s25, 57344
    s_add_u32 s31, s22, s25
    s_xor_b32 s25, s24, 0
    s_mul_i32 s25, s25, 57344
    s_add_u32 s32, s22, s25
    buffer_load_dwordx4 v1, s[4:7], s20 offen offset:3072 sc1 lds
    s_xor_b32 s25, s24, 1
    s_mul_i32 s25, s25, 57344
    s_add_u32 s33, s22, s25
    s_lshl_b32 s24, s12, 4
    s_add_u32 s23, s24, s13
    s_add_u32 m0, s38, 98304
    s_add_u32 s20, s18, 98304
    buffer_load_dwordx4 v1, s[4:7], s20 offen offset:0 sc1 lds
    s_lshl_b32 s23, s23, 2
    s_add_u32 s23, s23, s3
    s_lshl_b32 s23, s23, 7
    s_add_u32 s23, s23, 0x10e0000
    s_lshl_b32 s24, s24, 9
    buffer_load_dwordx4 v1, s[4:7], s20 offen offset:1024 sc1 lds
    s_lshl_b32 s25, s3, 11
    s_add_u32 s24, s24, s25
    s_add_u32 s24, s24, 0x10e0000
    s_mov_b32 s8, 0x22222222
    s_mov_b32 s9, 0x22222222
    buffer_load_dwordx4 v1, s[4:7], s20 offen offset:2048 sc1 lds
    s_mov_b32 s10, 0x44444444
    s_mov_b32 s11, 0x44444444
    s_mov_b32 s36, 0x88888888
    s_mov_b32 s37, 0x88888888
    buffer_load_dwordx4 v1, s[4:7], s20 offen offset:3072 sc1 lds
    buffer_load_dword v2, v11, s[4:7], s35 offen sc1
    s_mul_i32 s29, s13, 448
    s_add_u32 s29, s29, 0xbc5000
    v_accvgpr_write_b32 a232, 0
    v_accvgpr_write_b32 a236, -1
    v_accvgpr_write_b32 a233, 0
    v_accvgpr_write_b32 a237, -1
    v_accvgpr_write_b32 a234, 0
    v_accvgpr_write_b32 a238, -1
    v_accvgpr_write_b32 a235, 0
    v_accvgpr_write_b32 a239, -1
    v_bfe_u32 v17, v0, 3, 2
    v_and_b32 v21, 0x70, v1
    v_lshl_add_u32 v21, v17, 17, v21
    s_lshl_b32 s49, s3, 11
    s_add_u32 s49, s49, s34
    s_add_u32 s49, s49, 0x600000
    s_add_u32 s20, s21, 0
    buffer_load_dwordx4 a[0:3], v1, s[4:7], s20 offen offset:0 sc1
    buffer_load_dwordx4 a[4:7], v1, s[4:7], s20 offen offset:1024 sc1
    s_xor_b32 s20, s20, 0x800
    buffer_load_dwordx4 a[8:11], v1, s[4:7], s20 offen offset:0 sc1
    buffer_load_dwordx4 a[12:15], v1, s[4:7], s20 offen offset:1024 sc1
    s_waitcnt vmcnt(4)
    v_cmp_ne_u32 vcc, s48, v2
    s_cbranch_vccz GO5
    s_mov_b32 s25, 0
POLL5:
    s_mov_b64 exec, vcc
    buffer_load_dword v2, v11, s[4:7], s35 offen sc1
    s_add_u32 s25, s25, 1
    s_waitcnt vmcnt(0)
    v_cmp_ne_u32 vcc, s48, v2
    s_cmp_lt_u32 s25, 0x8000
    s_cselect_b64 vcc, vcc, 0
    s_cbranch_vccnz POLL5
    s_mov_b64 exec, -1
GO5:
    s_barrier
    s_or_b32 s25, s2, s3
    s_cbranch_scc1 NO_EPOCH
    s_mov_b32 s25, 0xbc8000
    s_mov_b32 exec_hi, 0
    buffer_store_dword v3, v4, s[4:7], s25 offen sc1
    s_mov_b64 exec, -1
NO_EPOCH:
    s_mov_b32 s35, 0
PASS_A0:
    s_add_u32 m0, s16, 0
    s_add_u32 s19, s17, 0
    buffer_load_dwordx4 v5, s[4:7], s19 offen offset:0 sc1 lds
    buffer_load_dwordx4 v6, s[4:7], s19 offen offset:1024 sc1 lds
    s_add_u32 m0, s16, 2048
    s_add_u32 s19, s17, 8192
    buffer_load_dwordx4 v5, s[4:7], s19 offen offset:0 sc1 lds
    buffer_load_dwordx4 v6, s[4:7], s19 offen offset:1024 sc1 lds
    s_add_u32 m0, s16, 4096
    s_add_u32 s19, s17, 16384
    buffer_load_dwordx4 v5, s[4:7], s19 offen offset:0 sc1 lds
    buffer_load_dwordx4 v6, s[4:7], s19 offen offset:1024 sc1 lds
    s_add_u32 m0, s16, 6144
    s_add_u32 s19, s17, 24576
    buffer_load_dwordx4 v5, s[4:7], s19 offen offset:0 sc1 lds
    buffer_load_dwordx4 v6, s[4:7], s19 offen offset:1024 sc1 lds
    s_add_u32 m0, s16, 8192
    s_add_u32 s19, s17, 32768
    buffer_load_dwordx4 v5, s[4:7], s19 offen offset:0 sc1 lds
    buffer_load_dwordx4 v6, s[4:7], s19 offen offset:1024 sc1 lds
    s_add_u32 m0, s16, 10240
    s_add_u32 s19, s17, 40960
    buffer_load_dwordx4 v5, s[4:7], s19 offen offset:0 sc1 lds
    buffer_load_dwordx4 v6, s[4:7], s19 offen offset:1024 sc1 lds
    ds_read_b128 v[224:227], v1 offset:0
    ds_read_b128 v[228:231], v1 offset:1024
    ds_read_b128 v[232:235], v1 offset:2048
    ds_read_b128 v[236:239], v1 offset:3072
    v_mov_b32 v20, 0xffff
    v_cmp_gt_u32 vcc, 256, v1
    s_nop 1
    v_cndmask_b32 v12, -1, v20, vcc
    v_and_b32 v18, 12, v0
    v_and_b32 v19, 15, v0
    v_lshlrev_b32 v11, 7, v19
    v_lshl_add_u32 v18, v18, 2, v19
    v_lshlrev_b32_e64 v18, 2, v18
    v_mov_b32 v19, 0x2edbe6ff
    s_waitcnt vmcnt(10)
    ds_read_b64 v[32:33], v7 offset:0
    ds_read_b64 v[36:37], v7 offset:512
    ds_read_b64 v[34:35], v7 offset:1024
    ds_read_b64 v[38:39], v7 offset:1536
    s_waitcnt lgkmcnt(2)
    v_swap_b32 v33, v36
    s_waitcnt lgkmcnt(0)
    v_swap_b32 v35, v38
    s_nop 1
    v_mfma_f32_16x16x32_bf16 v[160:163], v[224:227], v[32:35], 0
    s_waitcnt vmcnt(8)
    ds_read_b64 v[40:41], v7 offset:2048
    ds_read_b64 v[44:45], v7 offset:2560
    v_mfma_f32_16x16x32_bf16 v[168:171], v[224:227], v[36:39], 0
    ds_read_b64 v[42:43], v7 offset:3072
    ds_read_b64 v[46:47], v7 offset:3584
    v_mfma_f32_16x16x32_bf16 v[164:167], v[228:231], v[32:35], 0
    ds_read_b128 v[240:243], v1 offset:4096
    v_and_b32 v24, v12, v32
    v_mov_b32 v25, v33
    v_mfma_f32_16x16x32_bf16 v[172:175], v[228:231], v[36:39], 0
    ds_read_b128 v[244:247], v1 offset:5120
    ds_read_b128 v[248:251], v1 offset:6144
    v_mfma_f32_16x16x32_bf16 v[176:179], v[232:235], v[32:35], 0
    s_add_u32 m0, s16, 0
    s_add_u32 s19, s17, 49152
    ds_read_b128 v[252:255], v1 offset:7168
    v_mov_b32 v26, v34
    v_mov_b32 v27, v35
    v_mfma_f32_16x16x32_bf16 v[184:187], v[232:235], v[36:39], 0
    buffer_load_dwordx4 v5, s[4:7], s19 offen offset:0 sc1 lds
    v_and_b32 v28, v12, v36
    v_mov_b32 v29, v37
    v_mfma_f32_16x16x32_bf16 v[180:183], v[236:239], v[32:35], 0
    s_waitcnt lgkmcnt(4)
    v_swap_b32 v41, v44
    v_mov_b32 v30, v38
    v_mov_b32 v31, v39
    v_mfma_f32_16x16x32_bf16 v[188:191], v[236:239], v[36:39], 0
    v_swap_b32 v43, v46
    v_mfma_f32_16x16x32_bf16 v[216:219], v[24:27], v[32:35], 0
    v_mfma_f32_16x16x32_bf16 v[220:223], v[28:31], v[36:39], 0
    buffer_load_dwordx4 v6, s[4:7], s19 offen offset:1024 sc1 lds
    v_mfma_f32_16x16x32_bf16 v[216:219], v[40:43], v[40:43], v[216:219]
    s_waitcnt vmcnt(8)
    ds_read_b64 v[48:49], v7 offset:4096
    ds_read_b64 v[52:53], v7 offset:4608
    v_mfma_f32_16x16x32_bf16 v[220:223], v[44:47], v[44:47], v[220:223]
    ds_read_b64 v[50:51], v7 offset:5120
    ds_read_b64 v[54:55], v7 offset:5632
    s_waitcnt lgkmcnt(4)
    v_mfma_f32_16x16x32_bf16 v[160:163], v[240:243], v[40:43], v[160:163]
    ds_read_b128 v[224:227], v1 offset:8192
    v_mfma_f32_16x16x32_bf16 v[168:171], v[240:243], v[44:47], v[168:171]
    ds_read_b128 v[228:231], v1 offset:9216
    ds_read_b128 v[232:235], v1 offset:10240
    v_mfma_f32_16x16x32_bf16 v[164:167], v[244:247], v[40:43], v[164:167]
    s_add_u32 m0, s16, 2048
    s_add_u32 s19, s17, 57344
    ds_read_b128 v[236:239], v1 offset:11264
    v_mfma_f32_16x16x32_bf16 v[172:175], v[244:247], v[44:47], v[172:175]
    buffer_load_dwordx4 v5, s[4:7], s19 offen offset:0 sc1 lds
    v_mfma_f32_16x16x32_bf16 v[176:179], v[248:251], v[40:43], v[176:179]
    s_waitcnt lgkmcnt(4)
    v_swap_b32 v49, v52
    v_mfma_f32_16x16x32_bf16 v[184:187], v[248:251], v[44:47], v[184:187]
    v_swap_b32 v51, v54
    v_mfma_f32_16x16x32_bf16 v[180:183], v[252:255], v[40:43], v[180:183]
    v_mfma_f32_16x16x32_bf16 v[188:191], v[252:255], v[44:47], v[188:191]
    buffer_load_dwordx4 v6, s[4:7], s19 offen offset:1024 sc1 lds
    v_mfma_f32_16x16x32_bf16 v[216:219], v[48:51], v[48:51], v[216:219]
    s_waitcnt vmcnt(8)
    ds_read_b64 v[56:57], v7 offset:6144
    ds_read_b64 v[60:61], v7 offset:6656
    v_mfma_f32_16x16x32_bf16 v[220:223], v[52:55], v[52:55], v[220:223]
    ds_read_b64 v[58:59], v7 offset:7168
    ds_read_b64 v[62:63], v7 offset:7680
    s_waitcnt lgkmcnt(4)
    v_mfma_f32_16x16x32_bf16 v[160:163], v[224:227], v[48:51], v[160:163]
    s_mov_b32 exec_hi, 0
    buffer_store_dwordx4 a[232:235], v21, s[4:7], s23 offen sc1
    s_mov_b32 exec_hi, -1
    ds_read_b128 v[240:243], v1 offset:12288
    v_mfma_f32_16x16x32_bf16 v[168:171], v[224:227], v[52:55], v[168:171]
    ds_read_b128 v[244:247], v1 offset:13312
    ds_read_b128 v[248:251], v1 offset:14336
    v_mfma_f32_16x16x32_bf16 v[164:167], v[228:231], v[48:51], v[164:167]
    s_add_u32 m0, s16, 4096
    s_add_u32 s19, s17, 65536
    ds_read_b128 v[252:255], v1 offset:15360
    v_mfma_f32_16x16x32_bf16 v[172:175], v[228:231], v[52:55], v[172:175]
    buffer_load_dwordx4 v5, s[4:7], s19 offen offset:0 sc1 lds
    v_mfma_f32_16x16x32_bf16 v[176:179], v[232:235], v[48:51], v[176:179]
    s_waitcnt lgkmcnt(4)
    v_swap_b32 v57, v60
    v_mfma_f32_16x16x32_bf16 v[184:187], v[232:235], v[52:55], v[184:187]
    v_swap_b32 v59, v62
    v_mfma_f32_16x16x32_bf16 v[180:183], v[236:239], v[48:51], v[180:183]
    v_mfma_f32_16x16x32_bf16 v[188:191], v[236:239], v[52:55], v[188:191]
    buffer_load_dwordx4 v6, s[4:7], s19 offen offset:1024 sc1 lds
    v_mfma_f32_16x16x32_bf16 v[216:219], v[56:59], v[56:59], v[216:219]
    s_waitcnt vmcnt(9)
    ds_read_b64 v[64:65], v7 offset:8192
    ds_read_b64 v[68:69], v7 offset:8704
    v_mfma_f32_16x16x32_bf16 v[220:223], v[60:63], v[60:63], v[220:223]
    ds_read_b64 v[66:67], v7 offset:9216
    ds_read_b64 v[70:71], v7 offset:9728
    s_waitcnt lgkmcnt(4)
    v_mfma_f32_16x16x32_bf16 v[160:163], v[240:243], v[56:59], v[160:163]
    ds_read_b128 v[224:227], v1 offset:16384
    v_mfma_f32_16x16x32_bf16 v[168:171], v[240:243], v[60:63], v[168:171]
    ds_read_b128 v[228:231], v1 offset:17408
    ds_read_b128 v[232:235], v1 offset:18432
    v_mfma_f32_16x16x32_bf16 v[164:167], v[244:247], v[56:59], v[164:167]
    s_add_u32 m0, s16, 6144
    s_add_u32 s19, s17, 73728
    ds_read_b128 v[236:239], v1 offset:19456
    v_mfma_f32_16x16x32_bf16 v[172:175], v[244:247], v[60:63], v[172:175]
    buffer_load_dwordx4 v5, s[4:7], s19 offen offset:0 sc1 lds
    v_mfma_f32_16x16x32_bf16 v[176:179], v[248:251], v[56:59], v[176:179]
    s_waitcnt lgkmcnt(4)
    v_swap_b32 v65, v68
    v_mfma_f32_16x16x32_bf16 v[184:187], v[248:251], v[60:63], v[184:187]
    v_swap_b32 v67, v70
    v_mfma_f32_16x16x32_bf16 v[180:183], v[252:255], v[56:59], v[180:183]
    v_mfma_f32_16x16x32_bf16 v[188:191], v[252:255], v[60:63], v[188:191]
    buffer_load_dwordx4 v6, s[4:7], s19 offen offset:1024 sc1 lds
    v_mfma_f32_16x16x32_bf16 v[216:219], v[64:67], v[64:67], v[216:219]
    s_waitcnt vmcnt(9)
    ds_read_b64 v[72:73], v7 offset:10240
    ds_read_b64 v[76:77], v7 offset:10752
    v_mfma_f32_16x16x32_bf16 v[220:223], v[68:71], v[68:71], v[220:223]
    ds_read_b64 v[74:75], v7 offset:11264
    ds_read_b64 v[78:79], v7 offset:11776
    s_waitcnt lgkmcnt(4)
    v_mfma_f32_16x16x32_bf16 v[160:163], v[224:227], v[64:67], v[160:163]
    buffer_store_dwordx4 a[236:239], v1, s[4:7], s49 offen offset:0 sc1
    ds_read_b128 v[240:243], v1 offset:20480
    v_mfma_f32_16x16x32_bf16 v[168:171], v[224:227], v[68:71], v[168:171]
    ds_read_b128 v[244:247], v1 offset:21504
    ds_read_b128 v[248:251], v1 offset:22528
    v_mfma_f32_16x16x32_bf16 v[164:167], v[228:231], v[64:67], v[164:167]
    s_add_u32 m0, s16, 8192
    s_add_u32 s19, s17, 81920
    ds_read_b128 v[252:255], v1 offset:23552
    v_mfma_f32_16x16x32_bf16 v[172:175], v[228:231], v[68:71], v[172:175]
    buffer_load_dwordx4 v5, s[4:7], s19 offen offset:0 sc1 lds
    v_mfma_f32_16x16x32_bf16 v[176:179], v[232:235], v[64:67], v[176:179]
    s_waitcnt lgkmcnt(4)
    v_swap_b32 v73, v76
    v_mfma_f32_16x16x32_bf16 v[184:187], v[232:235], v[68:71], v[184:187]
    v_swap_b32 v75, v78
    v_mfma_f32_16x16x32_bf16 v[180:183], v[236:239], v[64:67], v[180:183]
    v_mfma_f32_16x16x32_bf16 v[188:191], v[236:239], v[68:71], v[188:191]
    buffer_load_dwordx4 v6, s[4:7], s19 offen offset:1024 sc1 lds
    v_mfma_f32_16x16x32_bf16 v[216:219], v[72:75], v[72:75], v[216:219]
    s_waitcnt vmcnt(10)
    ds_read_b64 v[80:81], v7 offset:0
    ds_read_b64 v[84:85], v7 offset:512
    v_mfma_f32_16x16x32_bf16 v[220:223], v[76:79], v[76:79], v[220:223]
    ds_read_b64 v[82:83], v7 offset:1024
    ds_read_b64 v[86:87], v7 offset:1536
    s_waitcnt lgkmcnt(4)
    v_mfma_f32_16x16x32_bf16 v[160:163], v[240:243], v[72:75], v[160:163]
    ds_read_b128 v[224:227], v1 offset:24576
    v_mfma_f32_16x16x32_bf16 v[168:171], v[240:243], v[76:79], v[168:171]
    ds_read_b128 v[228:231], v1 offset:25600
    ds_read_b128 v[232:235], v1 offset:26624
    v_mfma_f32_16x16x32_bf16 v[164:167], v[244:247], v[72:75], v[164:167]
    s_add_u32 m0, s16, 10240
    s_add_u32 s19, s17, 90112
    ds_read_b128 v[236:239], v1 offset:27648
    v_mfma_f32_16x16x32_bf16 v[172:175], v[244:247], v[76:79], v[172:175]
    buffer_load_dwordx4 v5, s[4:7], s19 offen offset:0 sc1 lds
    v_mfma_f32_16x16x32_bf16 v[176:179], v[248:251], v[72:75], v[176:179]
    s_waitcnt lgkmcnt(4)
    v_swap_b32 v81, v84
    v_mfma_f32_16x16x32_bf16 v[184:187], v[248:251], v[76:79], v[184:187]
    v_swap_b32 v83, v86
    v_mfma_f32_16x16x32_bf16 v[180:183], v[252:255], v[72:75], v[180:183]
    v_mfma_f32_16x16x32_bf16 v[188:191], v[252:255], v[76:79], v[188:191]
    buffer_load_dwordx4 v6, s[4:7], s19 offen offset:1024 sc1 lds
    v_mfma_f32_16x16x32_bf16 v[216:219], v[80:83], v[80:83], v[216:219]
    s_waitcnt vmcnt(10)
    ds_read_b64 v[88:89], v7 offset:2048
    ds_read_b64 v[92:93], v7 offset:2560
    v_mfma_f32_16x16x32_bf16 v[220:223], v[84:87], v[84:87], v[220:223]
    ds_read_b64 v[90:91], v7 offset:3072
    ds_read_b64 v[94:95], v7 offset:3584
    s_waitcnt lgkmcnt(4)
    v_mfma_f32_16x16x32_bf16 v[160:163], v[224:227], v[80:83], v[160:163]
    buffer_store_dwordx4 a[236:239], v1, s[4:7], s49 offen offset:1024 sc1
    ds_read_b128 v[240:243], v1 offset:28672
    v_mfma_f32_16x16x32_bf16 v[168:171], v[224:227], v[84:87], v[168:171]
    ds_read_b128 v[244:247], v1 offset:29696
    ds_read_b128 v[248:251], v1 offset:30720
    v_mfma_f32_16x16x32_bf16 v[164:167], v[228:231], v[80:83], v[164:167]
    s_add_u32 m0, s16, 0
    s_add_u32 s19, s17, 98304
    ds_read_b128 v[252:255], v1 offset:31744
    v_mfma_f32_16x16x32_bf16 v[172:175], v[228:231], v[84:87], v[172:175]
    buffer_load_dwordx4 v5, s[4:7], s19 offen offset:0 sc1 lds
    v_mfma_f32_16x16x32_bf16 v[176:179], v[232:235], v[80:83], v[176:179]
    s_waitcnt lgkmcnt(4)
    v_swap_b32 v89, v92
    v_mfma_f32_16x16x32_bf16 v[184:187], v[232:235], v[84:87], v[184:187]
    v_swap_b32 v91, v94
    v_mfma_f32_16x16x32_bf16 v[180:183], v[236:239], v[80:83], v[180:183]
    v_mfma_f32_16x16x32_bf16 v[188:191], v[236:239], v[84:87], v[188:191]
    buffer_load_dwordx4 v6, s[4:7], s19 offen offset:1024 sc1 lds
    v_mfma_f32_16x16x32_bf16 v[216:219], v[88:91], v[88:91], v[216:219]
    s_waitcnt vmcnt(10)
    ds_read_b64 v[96:97], v7 offset:4096
    ds_read_b64 v[100:101], v7 offset:4608
    v_mfma_f32_16x16x32_bf16 v[220:223], v[92:95], v[92:95], v[220:223]
    ds_read_b64 v[98:99], v7 offset:5120
    ds_read_b64 v[102:103], v7 offset:5632
    s_waitcnt lgkmcnt(4)
    v_mfma_f32_16x16x32_bf16 v[160:163], v[240:243], v[88:91], v[160:163]
    ds_read_b128 v[224:227], v1 offset:32768
    v_mfma_f32_16x16x32_bf16 v[168:171], v[240:243], v[92:95], v[168:171]
    ds_read_b128 v[228:231], v1 offset:33792
    ds_read_b128 v[232:235], v1 offset:34816
    v_mfma_f32_16x16x32_bf16 v[164:167], v[244:247], v[88:91], v[164:167]
    s_add_u32 m0, s16, 2048
    s_add_u32 s19, s17, 106496
    ds_read_b128 v[236:239], v1 offset:35840
    v_mfma_f32_16x16x32_bf16 v[172:175], v[244:247], v[92:95], v[172:175]
    buffer_load_dwordx4 v5, s[4:7], s19 offen offset:0 sc1 lds
    v_mfma_f32_16x16x32_bf16 v[176:179], v[248:251], v[88:91], v[176:179]
    s_waitcnt lgkmcnt(4)
    v_swap_b32 v97, v100
    v_mfma_f32_16x16x32_bf16 v[184:187], v[248:251], v[92:95], v[184:187]
    v_swap_b32 v99, v102
    v_mfma_f32_16x16x32_bf16 v[180:183], v[252:255], v[88:91], v[180:183]
    v_mfma_f32_16x16x32_bf16 v[188:191], v[252:255], v[92:95], v[188:191]
    buffer_load_dwordx4 v6, s[4:7], s19 offen offset:1024 sc1 lds
    v_mfma_f32_16x16x32_bf16 v[216:219], v[96:99], v[96:99], v[216:219]
    s_waitcnt vmcnt(10)
    ds_read_b64 v[104:105], v7 offset:6144
    ds_read_b64 v[108:109], v7 offset:6656
    v_mfma_f32_16x16x32_bf16 v[220:223], v[100:103], v[100:103], v[220:223]
    ds_read_b64 v[106:107], v7 offset:7168
    ds_read_b64 v[110:111], v7 offset:7680
    s_waitcnt lgkmcnt(4)
    v_mfma_f32_16x16x32_bf16 v[160:163], v[224:227], v[96:99], v[160:163]
    s_add_u32 s20, s21, 4096
    buffer_load_dwordx4 a[16:19], v1, s[4:7], s20 offen offset:0 sc1
    ds_read_b128 v[240:243], v1 offset:36864
    v_mfma_f32_16x16x32_bf16 v[168:171], v[224:227], v[100:103], v[168:171]
    ds_read_b128 v[244:247], v1 offset:37888
    ds_read_b128 v[248:251], v1 offset:38912
    v_mfma_f32_16x16x32_bf16 v[164:167], v[228:231], v[96:99], v[164:167]
    s_add_u32 m0, s16, 4096
    s_add_u32 s19, s17, 114688
    ds_read_b128 v[252:255], v1 offset:39936
    v_mfma_f32_16x16x32_bf16 v[172:175], v[228:231], v[100:103], v[172:175]
    buffer_load_dwordx4 v5, s[4:7], s19 offen offset:0 sc1 lds
    v_mfma_f32_16x16x32_bf16 v[176:179], v[232:235], v[96:99], v[176:179]
    s_waitcnt lgkmcnt(4)
    v_swap_b32 v105, v108
    v_mfma_f32_16x16x32_bf16 v[184:187], v[232:235], v[100:103], v[184:187]
    v_swap_b32 v107, v110
    v_mfma_f32_16x16x32_bf16 v[180:183], v[236:239], v[96:99], v[180:183]
    v_mfma_f32_16x16x32_bf16 v[188:191], v[236:239], v[100:103], v[188:191]
    buffer_load_dwordx4 v6, s[4:7], s19 offen offset:1024 sc1 lds
    v_mfma_f32_16x16x32_bf16 v[216:219], v[104:107], v[104:107], v[216:219]
    s_waitcnt vmcnt(10)
    ds_read_b64 v[112:113], v7 offset:8192
    ds_read_b64 v[116:117], v7 offset:8704
    v_mfma_f32_16x16x32_bf16 v[220:223], v[108:111], v[108:111], v[220:223]
    ds_read_b64 v[114:115], v7 offset:9216
    ds_read_b64 v[118:119], v7 offset:9728
    s_waitcnt lgkmcnt(4)
    v_mfma_f32_16x16x32_bf16 v[160:163], v[240:243], v[104:107], v[160:163]
    ds_read_b128 v[224:227], v1 offset:40960
    v_mfma_f32_16x16x32_bf16 v[168:171], v[240:243], v[108:111], v[168:171]
    ds_read_b128 v[228:231], v1 offset:41984
    ds_read_b128 v[232:235], v1 offset:43008
    v_mfma_f32_16x16x32_bf16 v[164:167], v[244:247], v[104:107], v[164:167]
    s_add_u32 m0, s16, 6144
    s_add_u32 s19, s17, 122880
    ds_read_b128 v[236:239], v1 offset:44032
    v_mfma_f32_16x16x32_bf16 v[172:175], v[244:247], v[108:111], v[172:175]
    buffer_load_dwordx4 v5, s[4:7], s19 offen offset:0 sc1 lds
    v_mfma_f32_16x16x32_bf16 v[176:179], v[248:251], v[104:107], v[176:179]
    s_waitcnt lgkmcnt(4)
    v_swap_b32 v113, v116
    v_mfma_f32_16x16x32_bf16 v[184:187], v[248:251], v[108:111], v[184:187]
    v_swap_b32 v115, v118
    v_mfma_f32_16x16x32_bf16 v[180:183], v[252:255], v[104:107], v[180:183]
    v_mfma_f32_16x16x32_bf16 v[188:191], v[252:255], v[108:111], v[188:191]
    buffer_load_dwordx4 v6, s[4:7], s19 offen offset:1024 sc1 lds
    v_mfma_f32_16x16x32_bf16 v[216:219], v[112:115], v[112:115], v[216:219]
    s_waitcnt vmcnt(10)
    ds_read_b64 v[120:121], v7 offset:10240
    ds_read_b64 v[124:125], v7 offset:10752
    v_mfma_f32_16x16x32_bf16 v[220:223], v[116:119], v[116:119], v[220:223]
    ds_read_b64 v[122:123], v7 offset:11264
    ds_read_b64 v[126:127], v7 offset:11776
    s_waitcnt lgkmcnt(4)
    v_mfma_f32_16x16x32_bf16 v[160:163], v[224:227], v[112:115], v[160:163]
    ds_read_b128 v[240:243], v1 offset:45056
    v_mfma_f32_16x16x32_bf16 v[168:171], v[224:227], v[116:119], v[168:171]
    ds_read_b128 v[244:247], v1 offset:46080
    ds_read_b128 v[248:251], v1 offset:47104
    v_mfma_f32_16x16x32_bf16 v[164:167], v[228:231], v[112:115], v[164:167]
    s_add_u32 m0, s16, 8192
    ds_read_b128 v[252:255], v1 offset:48128
    v_mfma_f32_16x16x32_bf16 v[172:175], v[228:231], v[116:119], v[172:175]
    buffer_load_dwordx4 v1, s[4:7], s29 offen offset:0 sc1 lds
    v_mfma_f32_16x16x32_bf16 v[176:179], v[232:235], v[112:115], v[176:179]
    s_waitcnt lgkmcnt(4)
    v_swap_b32 v121, v124
    v_mfma_f32_16x16x32_bf16 v[184:187], v[232:235], v[116:119], v[184:187]
    v_swap_b32 v123, v126
    v_mfma_f32_16x16x32_bf16 v[180:183], v[236:239], v[112:115], v[180:183]
    v_mfma_f32_16x16x32_bf16 v[188:191], v[236:239], v[116:119], v[188:191]
    buffer_load_dwordx4 a[20:23], v1, s[4:7], s20 offen offset:1024 sc1
    v_mfma_f32_16x16x32_bf16 v[216:219], v[120:123], v[120:123], v[216:219]
    s_waitcnt vmcnt(9)
    ds_read_b64 v[128:129], v7 offset:0
    ds_read_b64 v[132:133], v7 offset:512
    v_mfma_f32_16x16x32_bf16 v[220:223], v[124:127], v[124:127], v[220:223]
    ds_read_b64 v[130:131], v7 offset:1024
    ds_read_b64 v[134:135], v7 offset:1536
    s_waitcnt lgkmcnt(4)
    v_mfma_f32_16x16x32_bf16 v[160:163], v[240:243], v[120:123], v[160:163]
    ds_read_b128 v[224:227], v1 offset:49152
    v_mfma_f32_16x16x32_bf16 v[168:171], v[240:243], v[124:127], v[168:171]
    ds_read_b128 v[228:231], v1 offset:50176
    ds_read_b128 v[232:235], v1 offset:51200
    v_mfma_f32_16x16x32_bf16 v[164:167], v[244:247], v[120:123], v[164:167]
    s_xor_b32 s20, s20, 0x800
    ds_read_b128 v[236:239], v1 offset:52224
    v_mfma_f32_16x16x32_bf16 v[172:175], v[244:247], v[124:127], v[172:175]
    buffer_load_dwordx4 a[24:27], v1, s[4:7], s20 offen offset:0 sc1
    v_mfma_f32_16x16x32_bf16 v[176:179], v[248:251], v[120:123], v[176:179]
    s_waitcnt lgkmcnt(4)
    v_swap_b32 v129, v132
    v_mfma_f32_16x16x32_bf16 v[184:187], v[248:251], v[124:127], v[184:187]
    v_swap_b32 v131, v134
    v_mfma_f32_16x16x32_bf16 v[180:183], v[252:255], v[120:123], v[180:183]
    v_mfma_f32_16x16x32_bf16 v[188:191], v[252:255], v[124:127], v[188:191]
    buffer_load_dwordx4 a[28:31], v1, s[4:7], s20 offen offset:1024 sc1
    v_mfma_f32_16x16x32_bf16 v[216:219], v[128:131], v[128:131], v[216:219]
    s_waitcnt vmcnt(9)
    ds_read_b64 v[136:137], v7 offset:2048
    ds_read_b64 v[140:141], v7 offset:2560
    v_mfma_f32_16x16x32_bf16 v[220:223], v[132:135], v[132:135], v[220:223]
    ds_read_b64 v[138:139], v7 offset:3072
    ds_read_b64 v[142:143], v7 offset:3584
    s_waitcnt lgkmcnt(4)
    v_mfma_f32_16x16x32_bf16 v[160:163], v[224:227], v[128:131], v[160:163]
    ds_read_b128 v[240:243], v1 offset:53248
    v_mfma_f32_16x16x32_bf16 v[168:171], v[224:227], v[132:135], v[168:171]
    ds_read_b128 v[244:247], v1 offset:54272
    ds_read_b128 v[248:251], v1 offset:55296
    v_mfma_f32_16x16x32_bf16 v[164:167], v[228:231], v[128:131], v[164:167]
    s_add_u32 s20, s21, 8192
    ds_read_b128 v[252:255], v1 offset:56320
    v_mfma_f32_16x16x32_bf16 v[172:175], v[228:231], v[132:135], v[172:175]
    buffer_load_dwordx4 a[32:35], v1, s[4:7], s20 offen offset:0 sc1
    v_mfma_f32_16x16x32_bf16 v[176:179], v[232:235], v[128:131], v[176:179]
    s_waitcnt lgkmcnt(4)
    v_swap_b32 v137, v140
    v_mfma_f32_16x16x32_bf16 v[184:187], v[232:235], v[132:135], v[184:187]
    v_swap_b32 v139, v142
    v_mfma_f32_16x16x32_bf16 v[180:183], v[236:239], v[128:131], v[180:183]
    v_mfma_f32_16x16x32_bf16 v[188:191], v[236:239], v[132:135], v[188:191]
    buffer_load_dwordx4 a[36:39], v1, s[4:7], s20 offen offset:1024 sc1
    v_mfma_f32_16x16x32_bf16 v[216:219], v[136:139], v[136:139], v[216:219]
    s_waitcnt vmcnt(8)
    ds_read_b64 v[144:145], v7 offset:4096
    ds_read_b64 v[148:149], v7 offset:4608
    v_mfma_f32_16x16x32_bf16 v[220:223], v[140:143], v[140:143], v[220:223]
    ds_read_b64 v[146:147], v7 offset:5120
    ds_read_b64 v[150:151], v7 offset:5632
    s_waitcnt lgkmcnt(4)
    v_mfma_f32_16x16x32_bf16 v[160:163], v[240:243], v[136:139], v[160:163]
    ds_read_b128 v[224:227], v1 offset:57344
    v_mfma_f32_16x16x32_bf16 v[168:171], v[240:243], v[140:143], v[168:171]
    ds_read_b128 v[228:231], v1 offset:58368
    ds_read_b128 v[232:235], v1 offset:59392
    v_mfma_f32_16x16x32_bf16 v[164:167], v[244:247], v[136:139], v[164:167]
    s_xor_b32 s20, s20, 0x800
    ds_read_b128 v[236:239], v1 offset:60416
    v_mfma_f32_16x16x32_bf16 v[172:175], v[244:247], v[140:143], v[172:175]
    buffer_load_dwordx4 a[40:43], v1, s[4:7], s20 offen offset:0 sc1
    v_mfma_f32_16x16x32_bf16 v[176:179], v[248:251], v[136:139], v[176:179]
    s_waitcnt lgkmcnt(4)
    v_swap_b32 v145, v148
    v_mfma_f32_16x16x32_bf16 v[184:187], v[248:251], v[140:143], v[184:187]
    v_swap_b32 v147, v150
    v_mfma_f32_16x16x32_bf16 v[180:183], v[252:255], v[136:139], v[180:183]
    v_mfma_f32_16x16x32_bf16 v[188:191], v[252:255], v[140:143], v[188:191]
    buffer_load_dwordx4 a[44:47], v1, s[4:7], s20 offen offset:1024 sc1
    v_mfma_f32_16x16x32_bf16 v[216:219], v[144:147], v[144:147], v[216:219]
    s_waitcnt vmcnt(8)
    ds_read_b64 v[152:153], v7 offset:6144
    ds_read_b64 v[156:157], v7 offset:6656
    v_mfma_f32_16x16x32_bf16 v[220:223], v[148:151], v[148:151], v[220:223]
    ds_read_b64 v[154:155], v7 offset:7168
    ds_read_b64 v[158:159], v7 offset:7680
    s_waitcnt lgkmcnt(4)
    v_mfma_f32_16x16x32_bf16 v[160:163], v[224:227], v[144:147], v[160:163]
    ds_read_b128 v[240:243], v1 offset:61440
    v_mfma_f32_16x16x32_bf16 v[168:171], v[224:227], v[148:151], v[168:171]
    ds_read_b128 v[244:247], v1 offset:62464
    ds_read_b128 v[248:251], v1 offset:63488
    v_mfma_f32_16x16x32_bf16 v[164:167], v[228:231], v[144:147], v[164:167]
    s_add_u32 s20, s21, 12288
    ds_read_b128 v[252:255], v1 offset:64512
    v_mfma_f32_16x16x32_bf16 v[172:175], v[228:231], v[148:151], v[172:175]
    buffer_load_dwordx4 a[48:51], v1, s[4:7], s20 offen offset:0 sc1
    v_mfma_f32_16x16x32_bf16 v[176:179], v[232:235], v[144:147], v[176:179]
    s_waitcnt lgkmcnt(4)
    v_swap_b32 v153, v156
    v_mfma_f32_16x16x32_bf16 v[184:187], v[232:235], v[148:151], v[184:187]
    v_swap_b32 v155, v158
    v_mfma_f32_16x16x32_bf16 v[180:183], v[236:239], v[144:147], v[180:183]
    v_mfma_f32_16x16x32_bf16 v[188:191], v[236:239], v[148:151], v[188:191]
    buffer_load_dwordx4 a[52:55], v1, s[4:7], s20 offen offset:1024 sc1
    s_waitcnt vmcnt(9)
    v_mfma_f32_16x16x32_bf16 v[216:219], v[152:155], v[152:155], v[216:219]
    ds_read_b128 v[224:227], v9 offset:8192
    ds_read_b128 v[228:231], v9 offset:8256
    v_mfma_f32_16x16x32_bf16 v[220:223], v[156:159], v[156:159], v[220:223]
    ds_read_b128 v[232:235], v9 offset:8320
    ds_read_b128 v[236:239], v9 offset:8384
    s_waitcnt lgkmcnt(7)
    v_mfma_f32_16x16x32_bf16 v[160:163], v[240:243], v[152:155], v[160:163]
    v_mfma_f32_16x16x32_bf16 v[168:171], v[240:243], v[156:159], v[168:171]
    s_waitcnt lgkmcnt(6)
    v_mfma_f32_16x16x32_bf16 v[164:167], v[244:247], v[152:155], v[164:167]
    v_cndmask_b32 v16, v216, v217, s[8:9]
    v_cndmask_b32 v16, v16, v218, s[10:11]
    v_cndmask_b32 v16, v16, v219, s[36:37]
    ds_bpermute_b32 v12, v18, v16
    v_mfma_f32_16x16x32_bf16 v[172:175], v[244:247], v[156:159], v[172:175]
    s_waitcnt lgkmcnt(6)
    v_mfma_f32_16x16x32_bf16 v[176:179], v[248:251], v[152:155], v[176:179]
    v_cndmask_b32 v17, v220, v221, s[8:9]
    v_cndmask_b32 v17, v17, v222, s[10:11]
    v_cndmask_b32 v17, v17, v223, s[36:37]
    ds_bpermute_b32 v13, v18, v17
    v_mfma_f32_16x16x32_bf16 v[184:187], v[248:251], v[156:159], v[184:187]
    s_waitcnt lgkmcnt(6)
    v_mfma_f32_16x16x32_bf16 v[180:183], v[252:255], v[152:155], v[180:183]
    v_mfma_f32_16x16x32_bf16 v[188:191], v[252:255], v[156:159], v[188:191]
    ds_read_b128 v[240:243], v10 offset:0
    ds_read_b128 v[244:247], v10 offset:1024
    ds_read_b128 v[248:251], v10 offset:2048
    ds_read_b128 v[252:255], v10 offset:3072
    s_waitcnt lgkmcnt(5)
    v_fmamk_f32 v12, v12, 0x3b000054, v19
    s_waitcnt lgkmcnt(4)
    v_fmamk_f32 v13, v13, 0x3b000054, v19
    v_rsq_f32 v12, v12
    v_rsq_f32_e64 v13, v13
    s_nop 0
    v_pk_fma_f32 v[160:161], v[160:161], v[12:13], v[224:225] op_sel:[0,0,0] op_sel_hi:[1,0,1]
    v_pk_fma_f32 v[162:163], v[162:163], v[12:13], v[226:227] op_sel:[0,0,0] op_sel_hi:[1,0,1]
    v_pk_fma_f32 v[164:165], v[164:165], v[12:13], v[228:229] op_sel:[0,0,0] op_sel_hi:[1,0,1]
    v_pk_fma_f32 v[166:167], v[166:167], v[12:13], v[230:231] op_sel:[0,0,0] op_sel_hi:[1,0,1]
    v_pk_mul_f32 v[16:17], v[160:161], v[160:161]
    v_pk_mul_f32 v[18:19], v[162:163], v[162:163]
    v_pk_mul_f32 v[20:21], v[164:165], v[164:165]
    v_pk_mul_f32 v[22:23], v[166:167], v[166:167]
    v_pk_fma_f32 v[16:17], v[16:17], v[14:15], v[14:15] op_sel:[0,0,1] op_sel_hi:[1,0,1]
    v_pk_fma_f32 v[18:19], v[18:19], v[14:15], v[14:15] op_sel:[0,0,1] op_sel_hi:[1,0,1]
    v_pk_fma_f32 v[20:21], v[20:21], v[14:15], v[14:15] op_sel:[0,0,1] op_sel_hi:[1,0,1]
    v_pk_fma_f32 v[22:23], v[22:23], v[14:15], v[14:15] op_sel:[0,0,1] op_sel_hi:[1,0,1]
    v_pk_mul_f32 v[16:17], v[160:161], v[16:17]
    v_pk_mul_f32 v[18:19], v[162:163], v[18:19]
    v_pk_mul_f32 v[20:21], v[164:165], v[20:21]
    v_pk_mul_f32 v[22:23], v[166:167], v[22:23]
    v_exp_f32 v16, v16
    v_exp_f32 v17, v17
    v_exp_f32 v18, v18
    v_exp_f32 v19, v19
    v_exp_f32 v20, v20
    v_exp_f32 v21, v21
    v_exp_f32 v22, v22
    v_exp_f32 v23, v23
    s_xor_b32 s20, s20, 0x800
    buffer_load_dwordx4 a[56:59], v1, s[4:7], s20 offen offset:0 sc1
    v_pk_add_f32 v[16:17], v[16:17], 1.0 op_sel_hi:[1,0]
    v_pk_add_f32 v[18:19], v[18:19], 1.0 op_sel_hi:[1,0]
    v_pk_add_f32 v[20:21], v[20:21], 1.0 op_sel_hi:[1,0]
    v_pk_add_f32 v[22:23], v[22:23], 1.0 op_sel_hi:[1,0]
    v_rcp_f32 v16, v16
    v_rcp_f32 v17, v17
    v_rcp_f32 v18, v18
    v_rcp_f32 v19, v19
    v_rcp_f32 v20, v20
    v_rcp_f32 v21, v21
    v_rcp_f32 v22, v22
    v_rcp_f32 v23, v23
    buffer_load_dwordx4 a[60:63], v1, s[4:7], s20 offen offset:1024 sc1
    v_pk_mul_f32 v[16:17], v[160:161], v[16:17]
    v_pk_mul_f32 v[18:19], v[162:163], v[18:19]
    v_pk_mul_f32 v[20:21], v[164:165], v[20:21]
    v_pk_mul_f32 v[22:23], v[166:167], v[22:23]
    v_cvt_pk_bf16_f32 v24, v16, v17
    v_cvt_pk_bf16_f32 v26, v20, v21
    v_cvt_pk_bf16_f32 v25, v18, v19
    v_cvt_pk_bf16_f32 v27, v22, v23
    buffer_store_dwordx4 v[24:27], v1, s[4:7], s26 offen offset:0 sc1
    v_pk_fma_f32 v[176:177], v[176:177], v[12:13], v[232:233] op_sel:[0,0,0] op_sel_hi:[1,0,1]
    v_pk_fma_f32 v[178:179], v[178:179], v[12:13], v[234:235] op_sel:[0,0,0] op_sel_hi:[1,0,1]
    v_pk_fma_f32 v[180:181], v[180:181], v[12:13], v[236:237] op_sel:[0,0,0] op_sel_hi:[1,0,1]
    v_pk_fma_f32 v[182:183], v[182:183], v[12:13], v[238:239] op_sel:[0,0,0] op_sel_hi:[1,0,1]
    v_pk_mul_f32 v[16:17], v[176:177], v[176:177]
    v_pk_mul_f32 v[18:19], v[178:179], v[178:179]
    v_pk_mul_f32 v[20:21], v[180:181], v[180:181]
    v_pk_mul_f32 v[22:23], v[182:183], v[182:183]
    v_pk_fma_f32 v[16:17], v[16:17], v[14:15], v[14:15] op_sel:[0,0,1] op_sel_hi:[1,0,1]
    v_pk_fma_f32 v[18:19], v[18:19], v[14:15], v[14:15] op_sel:[0,0,1] op_sel_hi:[1,0,1]
    v_pk_fma_f32 v[20:21], v[20:21], v[14:15], v[14:15] op_sel:[0,0,1] op_sel_hi:[1,0,1]
    v_pk_fma_f32 v[22:23], v[22:23], v[14:15], v[14:15] op_sel:[0,0,1] op_sel_hi:[1,0,1]
    v_pk_mul_f32 v[16:17], v[176:177], v[16:17]
    v_pk_mul_f32 v[18:19], v[178:179], v[18:19]
    v_pk_mul_f32 v[20:21], v[180:181], v[20:21]
    v_pk_mul_f32 v[22:23], v[182:183], v[22:23]
    v_exp_f32 v16, v16
    v_exp_f32 v17, v17
    v_exp_f32 v18, v18
    v_exp_f32 v19, v19
    v_exp_f32 v20, v20
    v_exp_f32 v21, v21
    v_exp_f32 v22, v22
    v_exp_f32 v23, v23
    s_add_u32 s20, s21, 16384
    buffer_load_dwordx4 a[64:67], v1, s[4:7], s20 offen offset:0 sc1
    v_pk_add_f32 v[16:17], v[16:17], 1.0 op_sel_hi:[1,0]
    v_pk_add_f32 v[18:19], v[18:19], 1.0 op_sel_hi:[1,0]
    v_pk_add_f32 v[20:21], v[20:21], 1.0 op_sel_hi:[1,0]
    v_pk_add_f32 v[22:23], v[22:23], 1.0 op_sel_hi:[1,0]
    v_rcp_f32 v16, v16
    v_rcp_f32 v17, v17
    v_rcp_f32 v18, v18
    v_rcp_f32 v19, v19
    v_rcp_f32 v20, v20
    v_rcp_f32 v21, v21
    v_rcp_f32 v22, v22
    v_rcp_f32 v23, v23
    buffer_load_dwordx4 a[68:71], v1, s[4:7], s20 offen offset:1024 sc1
    v_pk_mul_f32 v[16:17], v[176:177], v[16:17]
    v_pk_mul_f32 v[18:19], v[178:179], v[18:19]
    v_pk_mul_f32 v[20:21], v[180:181], v[20:21]
    v_pk_mul_f32 v[22:23], v[182:183], v[22:23]
    v_cvt_pk_bf16_f32 v28, v16, v17
    v_cvt_pk_bf16_f32 v30, v20, v21
    v_cvt_pk_bf16_f32 v29, v18, v19
    v_cvt_pk_bf16_f32 v31, v22, v23
    buffer_store_dwordx4 v[28:31], v1, s[4:7], s26 offen offset:1024 sc1
    s_add_u32 s26, s26, 57344
    v_pk_fma_f32 v[168:169], v[168:169], v[12:13], v[224:225] op_sel:[0,1,0] op_sel_hi:[1,1,1]
    v_pk_fma_f32 v[170:171], v[170:171], v[12:13], v[226:227] op_sel:[0,1,0] op_sel_hi:[1,1,1]
    v_pk_fma_f32 v[172:173], v[172:173], v[12:13], v[228:229] op_sel:[0,1,0] op_sel_hi:[1,1,1]
    v_pk_fma_f32 v[174:175], v[174:175], v[12:13], v[230:231] op_sel:[0,1,0] op_sel_hi:[1,1,1]
    v_pk_mul_f32 v[16:17], v[168:169], v[168:169]
    v_pk_mul_f32 v[18:19], v[170:171], v[170:171]
    v_pk_mul_f32 v[20:21], v[172:173], v[172:173]
    v_pk_mul_f32 v[22:23], v[174:175], v[174:175]
    v_pk_fma_f32 v[16:17], v[16:17], v[14:15], v[14:15] op_sel:[0,0,1] op_sel_hi:[1,0,1]
    v_pk_fma_f32 v[18:19], v[18:19], v[14:15], v[14:15] op_sel:[0,0,1] op_sel_hi:[1,0,1]
    v_pk_fma_f32 v[20:21], v[20:21], v[14:15], v[14:15] op_sel:[0,0,1] op_sel_hi:[1,0,1]
    v_pk_fma_f32 v[22:23], v[22:23], v[14:15], v[14:15] op_sel:[0,0,1] op_sel_hi:[1,0,1]
    v_pk_mul_f32 v[16:17], v[168:169], v[16:17]
    v_pk_mul_f32 v[18:19], v[170:171], v[18:19]
    v_pk_mul_f32 v[20:21], v[172:173], v[20:21]
    v_pk_mul_f32 v[22:23], v[174:175], v[22:23]
    v_exp_f32 v16, v16
    v_exp_f32 v17, v17
    v_exp_f32 v18, v18
    v_exp_f32 v19, v19
    v_exp_f32 v20, v20
    v_exp_f32 v21, v21
    v_exp_f32 v22, v22
    v_exp_f32 v23, v23
    s_xor_b32 s20, s20, 0x800
    buffer_load_dwordx4 a[72:75], v1, s[4:7], s20 offen offset:0 sc1
    v_pk_add_f32 v[16:17], v[16:17], 1.0 op_sel_hi:[1,0]
    v_pk_add_f32 v[18:19], v[18:19], 1.0 op_sel_hi:[1,0]
    v_pk_add_f32 v[20:21], v[20:21], 1.0 op_sel_hi:[1,0]
    v_pk_add_f32 v[22:23], v[22:23], 1.0 op_sel_hi:[1,0]
    v_rcp_f32 v16, v16
    v_rcp_f32 v17, v17
    v_rcp_f32 v18, v18
    v_rcp_f32 v19, v19
    v_rcp_f32 v20, v20
    v_rcp_f32 v21, v21
    v_rcp_f32 v22, v22
    v_rcp_f32 v23, v23
    buffer_load_dwordx4 a[76:79], v1, s[4:7], s20 offen offset:1024 sc1
    v_pk_mul_f32 v[16:17], v[168:169], v[16:17]
    v_pk_mul_f32 v[18:19], v[170:171], v[18:19]
    v_pk_mul_f32 v[20:21], v[172:173], v[20:21]
    v_pk_mul_f32 v[22:23], v[174:175], v[22:23]
    v_cvt_pk_bf16_f32 v24, v16, v17
    v_cvt_pk_bf16_f32 v26, v20, v21
    v_cvt_pk_bf16_f32 v25, v18, v19
    v_cvt_pk_bf16_f32 v27, v22, v23
    buffer_store_dwordx4 v[24:27], v1, s[4:7], s26 offen offset:0 sc1
    v_pk_fma_f32 v[184:185], v[184:185], v[12:13], v[232:233] op_sel:[0,1,0] op_sel_hi:[1,1,1]
    v_pk_fma_f32 v[186:187], v[186:187], v[12:13], v[234:235] op_sel:[0,1,0] op_sel_hi:[1,1,1]
    v_pk_fma_f32 v[188:189], v[188:189], v[12:13], v[236:237] op_sel:[0,1,0] op_sel_hi:[1,1,1]
    v_pk_fma_f32 v[190:191], v[190:191], v[12:13], v[238:239] op_sel:[0,1,0] op_sel_hi:[1,1,1]
    v_pk_mul_f32 v[16:17], v[184:185], v[184:185]
    v_pk_mul_f32 v[18:19], v[186:187], v[186:187]
    v_pk_mul_f32 v[20:21], v[188:189], v[188:189]
    v_pk_mul_f32 v[22:23], v[190:191], v[190:191]
    v_pk_fma_f32 v[16:17], v[16:17], v[14:15], v[14:15] op_sel:[0,0,1] op_sel_hi:[1,0,1]
    v_pk_fma_f32 v[18:19], v[18:19], v[14:15], v[14:15] op_sel:[0,0,1] op_sel_hi:[1,0,1]
    v_pk_fma_f32 v[20:21], v[20:21], v[14:15], v[14:15] op_sel:[0,0,1] op_sel_hi:[1,0,1]
    v_pk_fma_f32 v[22:23], v[22:23], v[14:15], v[14:15] op_sel:[0,0,1] op_sel_hi:[1,0,1]
    v_pk_mul_f32 v[16:17], v[184:185], v[16:17]
    v_pk_mul_f32 v[18:19], v[186:187], v[18:19]
    v_pk_mul_f32 v[20:21], v[188:189], v[20:21]
    v_pk_mul_f32 v[22:23], v[190:191], v[22:23]
    v_exp_f32 v16, v16
    v_exp_f32 v17, v17
    v_exp_f32 v18, v18
    v_exp_f32 v19, v19
    v_exp_f32 v20, v20
    v_exp_f32 v21, v21
    v_exp_f32 v22, v22
    v_exp_f32 v23, v23
    s_add_u32 s20, s21, 20480
    buffer_load_dwordx4 a[80:83], v1, s[4:7], s20 offen offset:0 sc1
    v_pk_add_f32 v[16:17], v[16:17], 1.0 op_sel_hi:[1,0]
    v_pk_add_f32 v[18:19], v[18:19], 1.0 op_sel_hi:[1,0]
    v_pk_add_f32 v[20:21], v[20:21], 1.0 op_sel_hi:[1,0]
    v_pk_add_f32 v[22:23], v[22:23], 1.0 op_sel_hi:[1,0]
    v_rcp_f32 v16, v16
    v_rcp_f32 v17, v17
    v_rcp_f32 v18, v18
    v_rcp_f32 v19, v19
    v_rcp_f32 v20, v20
    v_rcp_f32 v21, v21
    v_rcp_f32 v22, v22
    v_rcp_f32 v23, v23
    buffer_load_dwordx4 a[84:87], v1, s[4:7], s20 offen offset:1024 sc1
    v_pk_mul_f32 v[16:17], v[184:185], v[16:17]
    v_pk_mul_f32 v[18:19], v[186:187], v[18:19]
    v_pk_mul_f32 v[20:21], v[188:189], v[20:21]
    v_pk_mul_f32 v[22:23], v[190:191], v[22:23]
    v_cvt_pk_bf16_f32 v28, v16, v17
    v_cvt_pk_bf16_f32 v30, v20, v21
    v_cvt_pk_bf16_f32 v29, v18, v19
    v_cvt_pk_bf16_f32 v31, v22, v23
    buffer_store_dwordx4 v[28:31], v1, s[4:7], s26 offen offset:1024 sc1
    ds_read_b128 v[224:227], v10 offset:4096
    ds_read_b128 v[228:231], v10 offset:5120
    ds_read_b128 v[232:235], v10 offset:6144
    s_waitcnt lgkmcnt(6)
    v_mfma_f32_16x16x32_bf16 v[192:195], v[240:243], v[32:35], 0
    ds_read_b128 v[236:239], v10 offset:7168
    v_mfma_f32_16x16x32_bf16 v[200:203], v[240:243], v[36:39], 0
    s_waitcnt lgkmcnt(6)
    v_mfma_f32_16x16x32_bf16 v[196:199], v[244:247], v[32:35], 0
    ds_read_b128 v[240:243], v10 offset:8192
    s_xor_b32 s20, s20, 0x800
    v_mfma_f32_16x16x32_bf16 v[204:207], v[244:247], v[36:39], 0
    buffer_load_dwordx4 a[88:91], v1, s[4:7], s20 offen offset:0 sc1
    s_waitcnt lgkmcnt(6)
    v_mfma_f32_16x16x32_bf16 v[208:211], v[248:251], v[32:35], 0
    ds_read_b128 v[244:247], v10 offset:9216
    v_mfma_f32_16x16x32_bf16 v[212:215], v[248:251], v[36:39], 0
    s_waitcnt lgkmcnt(6)
    v_mfma_f32_16x16x32_bf16 v[192:195], v[252:255], v[40:43], v[192:195]
    ds_read_b128 v[248:251], v10 offset:10240
    v_mfma_f32_16x16x32_bf16 v[200:203], v[252:255], v[44:47], v[200:203]
    buffer_load_dwordx4 a[92:95], v1, s[4:7], s20 offen offset:1024 sc1
    s_waitcnt lgkmcnt(6)
    v_mfma_f32_16x16x32_bf16 v[196:199], v[224:227], v[40:43], v[196:199]
    ds_read_b128 v[252:255], v10 offset:11264
    v_mfma_f32_16x16x32_bf16 v[204:207], v[224:227], v[44:47], v[204:207]
    s_waitcnt lgkmcnt(6)
    v_mfma_f32_16x16x32_bf16 v[208:211], v[228:231], v[40:43], v[208:211]
    ds_read_b128 v[224:227], v10 offset:12288
    s_add_u32 s20, s21, 24576
    v_mfma_f32_16x16x32_bf16 v[212:215], v[228:231], v[44:47], v[212:215]
    buffer_load_dwordx4 a[96:99], v1, s[4:7], s20 offen offset:0 sc1
    s_waitcnt lgkmcnt(6)
    v_mfma_f32_16x16x32_bf16 v[192:195], v[232:235], v[48:51], v[192:195]
    ds_read_b128 v[228:231], v10 offset:13312
    v_mfma_f32_16x16x32_bf16 v[200:203], v[232:235], v[52:55], v[200:203]
    s_waitcnt lgkmcnt(6)
    v_mfma_f32_16x16x32_bf16 v[196:199], v[236:239], v[48:51], v[196:199]
    ds_read_b128 v[232:235], v10 offset:14336
    v_mfma_f32_16x16x32_bf16 v[204:207], v[236:239], v[52:55], v[204:207]
    buffer_load_dwordx4 a[100:103], v1, s[4:7], s20 offen offset:1024 sc1
    s_waitcnt lgkmcnt(6)
    v_mfma_f32_16x16x32_bf16 v[208:211], v[240:243], v[48:51], v[208:211]
    ds_read_b128 v[236:239], v10 offset:15360
    v_mfma_f32_16x16x32_bf16 v[212:215], v[240:243], v[52:55], v[212:215]
    s_waitcnt lgkmcnt(6)
    v_mfma_f32_16x16x32_bf16 v[192:195], v[244:247], v[56:59], v[192:195]
    ds_read_b128 v[240:243], v10 offset:16384
    s_xor_b32 s20, s20, 0x800
    v_mfma_f32_16x16x32_bf16 v[200:203], v[244:247], v[60:63], v[200:203]
    buffer_load_dwordx4 a[104:107], v1, s[4:7], s20 offen offset:0 sc1
    s_waitcnt lgkmcnt(6)
    v_mfma_f32_16x16x32_bf16 v[196:199], v[248:251], v[56:59], v[196:199]
    ds_read_b128 v[244:247], v10 offset:17408
    v_mfma_f32_16x16x32_bf16 v[204:207], v[248:251], v[60:63], v[204:207]
    s_waitcnt lgkmcnt(6)
    v_mfma_f32_16x16x32_bf16 v[208:211], v[252:255], v[56:59], v[208:211]
    ds_read_b128 v[248:251], v10 offset:18432
    v_mfma_f32_16x16x32_bf16 v[212:215], v[252:255], v[60:63], v[212:215]
    buffer_load_dwordx4 a[108:111], v1, s[4:7], s20 offen offset:1024 sc1
    s_waitcnt lgkmcnt(6)
    v_mfma_f32_16x16x32_bf16 v[192:195], v[224:227], v[64:67], v[192:195]
    ds_read_b128 v[252:255], v10 offset:19456
    v_mfma_f32_16x16x32_bf16 v[200:203], v[224:227], v[68:71], v[200:203]
    s_waitcnt lgkmcnt(6)
    v_mfma_f32_16x16x32_bf16 v[196:199], v[228:231], v[64:67], v[196:199]
    ds_read_b128 v[224:227], v10 offset:20480
    s_add_u32 s20, s21, 28672
    v_mfma_f32_16x16x32_bf16 v[204:207], v[228:231], v[68:71], v[204:207]
    buffer_load_dwordx4 a[112:115], v1, s[4:7], s20 offen offset:0 sc1
    s_waitcnt lgkmcnt(6)
    v_mfma_f32_16x16x32_bf16 v[208:211], v[232:235], v[64:67], v[208:211]
    ds_read_b128 v[228:231], v10 offset:21504
    v_mfma_f32_16x16x32_bf16 v[212:215], v[232:235], v[68:71], v[212:215]
    s_waitcnt lgkmcnt(6)
    v_mfma_f32_16x16x32_bf16 v[192:195], v[236:239], v[72:75], v[192:195]
    ds_read_b128 v[232:235], v10 offset:22528
    v_mfma_f32_16x16x32_bf16 v[200:203], v[236:239], v[76:79], v[200:203]
    buffer_load_dwordx4 a[116:119], v1, s[4:7], s20 offen offset:1024 sc1
    s_waitcnt lgkmcnt(6)
    v_mfma_f32_16x16x32_bf16 v[196:199], v[240:243], v[72:75], v[196:199]
    ds_read_b128 v[236:239], v10 offset:23552
    v_mfma_f32_16x16x32_bf16 v[204:207], v[240:243], v[76:79], v[204:207]
    s_waitcnt lgkmcnt(6)
    v_mfma_f32_16x16x32_bf16 v[208:211], v[244:247], v[72:75], v[208:211]
    ds_read_b128 v[240:243], v10 offset:24576
    s_xor_b32 s20, s20, 0x800
    v_mfma_f32_16x16x32_bf16 v[212:215], v[244:247], v[76:79], v[212:215]
    buffer_load_dwordx4 a[120:123], v1, s[4:7], s20 offen offset:0 sc1
    s_waitcnt lgkmcnt(6)
    v_mfma_f32_16x16x32_bf16 v[192:195], v[248:251], v[80:83], v[192:195]
    ds_read_b128 v[244:247], v10 offset:25600
    v_mfma_f32_16x16x32_bf16 v[200:203], v[248:251], v[84:87], v[200:203]
    s_waitcnt lgkmcnt(6)
    v_mfma_f32_16x16x32_bf16 v[196:199], v[252:255], v[80:83], v[196:199]
    ds_read_b128 v[248:251], v10 offset:26624
    v_mfma_f32_16x16x32_bf16 v[204:207], v[252:255], v[84:87], v[204:207]
    buffer_load_dwordx4 a[124:127], v1, s[4:7], s20 offen offset:1024 sc1
    s_waitcnt lgkmcnt(6)
    v_mfma_f32_16x16x32_bf16 v[208:211], v[224:227], v[80:83], v[208:211]
    ds_read_b128 v[252:255], v10 offset:27648
    v_mfma_f32_16x16x32_bf16 v[212:215], v[224:227], v[84:87], v[212:215]
    s_waitcnt lgkmcnt(6)
    v_mfma_f32_16x16x32_bf16 v[192:195], v[228:231], v[88:91], v[192:195]
    ds_read_b128 v[224:227], v10 offset:28672
    s_add_u32 s20, s21, 32768
    v_mfma_f32_16x16x32_bf16 v[200:203], v[228:231], v[92:95], v[200:203]
    buffer_load_dwordx4 a[128:131], v1, s[4:7], s20 offen offset:0 sc1
    s_waitcnt lgkmcnt(6)
    v_mfma_f32_16x16x32_bf16 v[196:199], v[232:235], v[88:91], v[196:199]
    ds_read_b128 v[228:231], v10 offset:29696
    v_mfma_f32_16x16x32_bf16 v[204:207], v[232:235], v[92:95], v[204:207]
    s_waitcnt lgkmcnt(6)
    v_mfma_f32_16x16x32_bf16 v[208:211], v[236:239], v[88:91], v[208:211]
    ds_read_b128 v[232:235], v10 offset:30720
    v_mfma_f32_16x16x32_bf16 v[212:215], v[236:239], v[92:95], v[212:215]
    buffer_load_dwordx4 a[132:135], v1, s[4:7], s20 offen offset:1024 sc1
    s_waitcnt lgkmcnt(6)
    v_mfma_f32_16x16x32_bf16 v[192:195], v[240:243], v[96:99], v[192:195]
    ds_read_b128 v[236:239], v10 offset:31744
    v_mfma_f32_16x16x32_bf16 v[200:203], v[240:243], v[100:103], v[200:203]
    s_waitcnt lgkmcnt(6)
    v_mfma_f32_16x16x32_bf16 v[196:199], v[244:247], v[96:99], v[196:199]
    ds_read_b128 v[240:243], v10 offset:32768
    s_xor_b32 s20, s20, 0x800
    s_waitcnt vmcnt(12)
    s_mov_b32 exec_hi, 0
    buffer_store_dword v3, v4, s[4:7], s23 offen sc1
    s_mov_b64 exec, -1
    s_add_u32 s23, s23, 131072
    v_mfma_f32_16x16x32_bf16 v[204:207], v[244:247], v[100:103], v[204:207]
    buffer_load_dwordx4 a[136:139], v1, s[4:7], s20 offen offset:0 sc1
    s_waitcnt lgkmcnt(6)
    v_mfma_f32_16x16x32_bf16 v[208:211], v[248:251], v[96:99], v[208:211]
    ds_read_b128 v[244:247], v10 offset:33792
    v_mfma_f32_16x16x32_bf16 v[212:215], v[248:251], v[100:103], v[212:215]
    s_waitcnt lgkmcnt(6)
    v_mfma_f32_16x16x32_bf16 v[192:195], v[252:255], v[104:107], v[192:195]
    ds_read_b128 v[248:251], v10 offset:34816
    v_mfma_f32_16x16x32_bf16 v[200:203], v[252:255], v[108:111], v[200:203]
    buffer_load_dwordx4 a[140:143], v1, s[4:7], s20 offen offset:1024 sc1
    s_waitcnt lgkmcnt(6)
    v_mfma_f32_16x16x32_bf16 v[196:199], v[224:227], v[104:107], v[196:199]
    ds_read_b128 v[252:255], v10 offset:35840
    v_mfma_f32_16x16x32_bf16 v[204:207], v[224:227], v[108:111], v[204:207]
    s_waitcnt lgkmcnt(6)
    v_mfma_f32_16x16x32_bf16 v[208:211], v[228:231], v[104:107], v[208:211]
    ds_read_b128 v[224:227], v10 offset:36864
    s_add_u32 s20, s21, 36864
    v_mfma_f32_16x16x32_bf16 v[212:215], v[228:231], v[108:111], v[212:215]
    buffer_load_dwordx4 a[144:147], v1, s[4:7], s20 offen offset:0 sc1
    s_waitcnt lgkmcnt(6)
    v_mfma_f32_16x16x32_bf16 v[192:195], v[232:235], v[112:115], v[192:195]
    ds_read_b128 v[228:231], v10 offset:37888
    v_mfma_f32_16x16x32_bf16 v[200:203], v[232:235], v[116:119], v[200:203]
    s_waitcnt lgkmcnt(6)
    v_mfma_f32_16x16x32_bf16 v[196:199], v[236:239], v[112:115], v[196:199]
    ds_read_b128 v[232:235], v10 offset:38912
    v_mfma_f32_16x16x32_bf16 v[204:207], v[236:239], v[116:119], v[204:207]
    buffer_load_dwordx4 a[148:151], v1, s[4:7], s20 offen offset:1024 sc1
    s_waitcnt lgkmcnt(6)
    v_mfma_f32_16x16x32_bf16 v[208:211], v[240:243], v[112:115], v[208:211]
    ds_read_b128 v[236:239], v10 offset:39936
    v_mfma_f32_16x16x32_bf16 v[212:215], v[240:243], v[116:119], v[212:215]
    s_waitcnt lgkmcnt(6)
    v_mfma_f32_16x16x32_bf16 v[192:195], v[244:247], v[120:123], v[192:195]
    ds_read_b128 v[240:243], v10 offset:40960
    s_xor_b32 s20, s20, 0x800
    v_mfma_f32_16x16x32_bf16 v[200:203], v[244:247], v[124:127], v[200:203]
    buffer_load_dwordx4 a[152:155], v1, s[4:7], s20 offen offset:0 sc1
    s_waitcnt lgkmcnt(6)
    v_mfma_f32_16x16x32_bf16 v[196:199], v[248:251], v[120:123], v[196:199]
    ds_read_b128 v[244:247], v10 offset:41984
    v_mfma_f32_16x16x32_bf16 v[204:207], v[248:251], v[124:127], v[204:207]
    s_waitcnt lgkmcnt(6)
    v_mfma_f32_16x16x32_bf16 v[208:211], v[252:255], v[120:123], v[208:211]
    ds_read_b128 v[248:251], v10 offset:43008
    v_mfma_f32_16x16x32_bf16 v[212:215], v[252:255], v[124:127], v[212:215]
    buffer_load_dwordx4 a[156:159], v1, s[4:7], s20 offen offset:1024 sc1
    s_waitcnt lgkmcnt(6)
    v_mfma_f32_16x16x32_bf16 v[192:195], v[224:227], v[128:131], v[192:195]
    ds_read_b128 v[252:255], v10 offset:44032
    v_mfma_f32_16x16x32_bf16 v[200:203], v[224:227], v[132:135], v[200:203]
    s_waitcnt lgkmcnt(6)
    v_mfma_f32_16x16x32_bf16 v[196:199], v[228:231], v[128:131], v[196:199]
    ds_read_b128 v[224:227], v10 offset:45056
    s_add_u32 s20, s21, 40960
    v_mfma_f32_16x16x32_bf16 v[204:207], v[228:231], v[132:135], v[204:207]
    buffer_load_dwordx4 a[160:163], v1, s[4:7], s20 offen offset:0 sc1
    s_waitcnt lgkmcnt(6)
    v_mfma_f32_16x16x32_bf16 v[208:211], v[232:235], v[128:131], v[208:211]
    ds_read_b128 v[228:231], v10 offset:46080
    v_mfma_f32_16x16x32_bf16 v[212:215], v[232:235], v[132:135], v[212:215]
    s_waitcnt lgkmcnt(6)
    v_mfma_f32_16x16x32_bf16 v[192:195], v[236:239], v[136:139], v[192:195]
    ds_read_b128 v[232:235], v10 offset:47104
    v_mfma_f32_16x16x32_bf16 v[200:203], v[236:239], v[140:143], v[200:203]
    buffer_load_dwordx4 a[164:167], v1, s[4:7], s20 offen offset:1024 sc1
    s_waitcnt lgkmcnt(6)
    v_mfma_f32_16x16x32_bf16 v[196:199], v[240:243], v[136:139], v[196:199]
    ds_read_b128 v[236:239], v10 offset:48128
    v_mfma_f32_16x16x32_bf16 v[204:207], v[240:243], v[140:143], v[204:207]
    s_waitcnt lgkmcnt(6)
    v_mfma_f32_16x16x32_bf16 v[208:211], v[244:247], v[136:139], v[208:211]
    ds_read_b128 v[240:243], v9 offset:8448
    s_xor_b32 s20, s20, 0x800
    v_mfma_f32_16x16x32_bf16 v[212:215], v[244:247], v[140:143], v[212:215]
    buffer_load_dwordx4 a[168:171], v1, s[4:7], s20 offen offset:0 sc1
    s_waitcnt lgkmcnt(6)
    v_mfma_f32_16x16x32_bf16 v[192:195], v[248:251], v[144:147], v[192:195]
    ds_read_b128 v[244:247], v9 offset:8512
    v_mfma_f32_16x16x32_bf16 v[200:203], v[248:251], v[148:151], v[200:203]
    s_waitcnt lgkmcnt(6)
    v_mfma_f32_16x16x32_bf16 v[196:199], v[252:255], v[144:147], v[196:199]
    ds_read_b128 v[248:251], v9 offset:8576
    v_mfma_f32_16x16x32_bf16 v[204:207], v[252:255], v[148:151], v[204:207]
    buffer_load_dwordx4 a[172:175], v1, s[4:7], s20 offen offset:1024 sc1
    s_waitcnt lgkmcnt(6)
    v_mfma_f32_16x16x32_bf16 v[208:211], v[224:227], v[144:147], v[208:211]
    v_mfma_f32_16x16x32_bf16 v[212:215], v[224:227], v[148:151], v[212:215]
    s_waitcnt lgkmcnt(5)
    v_mfma_f32_16x16x32_bf16 v[192:195], v[228:231], v[152:155], v[192:195]
    s_add_u32 s20, s21, 45056
    v_mfma_f32_16x16x32_bf16 v[200:203], v[228:231], v[156:159], v[200:203]
    buffer_load_dwordx4 a[176:179], v1, s[4:7], s20 offen offset:0 sc1
    s_waitcnt lgkmcnt(4)
    v_mfma_f32_16x16x32_bf16 v[196:199], v[232:235], v[152:155], v[196:199]
    v_mfma_f32_16x16x32_bf16 v[204:207], v[232:235], v[156:159], v[204:207]
    s_waitcnt lgkmcnt(3)
    v_mfma_f32_16x16x32_bf16 v[208:211], v[236:239], v[152:155], v[208:211]
    v_mfma_f32_16x16x32_bf16 v[212:215], v[236:239], v[156:159], v[212:215]
    buffer_load_dwordx4 a[180:183], v1, s[4:7], s20 offen offset:1024 sc1
    v_bfe_u32 v6, v0, 4, 2
    v_lshrrev_b32 v5, 4, v11
    v_lshl_add_u32 v5, v6, 15, v5
    v_lshlrev_b32 v6, 4, v6
    s_lshl_b32 s35, s15, 1
    s_and_b32 s25, s3, 1
    s_add_u32 s35, s35, s25
    s_lshl_b32 s25, s35, 17
    s_add_u32 s17, s17, s25
    s_lshl_b32 s35, s35, 6
    s_add_u32 s35, s35, 0xbc4000
    s_lshl_b32 s19, s14, 1
    s_lshr_b32 s25, s3, 1
    s_add_u32 s19, s19, s25
    s_lshl_b32 s26, s19, 7
    s_add_u32 s17, s17, s26
    s_waitcnt lgkmcnt(2)
    v_pk_fma_f32 v[192:193], v[192:193], v[12:13], v[240:241] op_sel:[0,0,0] op_sel_hi:[1,0,1]
    v_pk_fma_f32 v[194:195], v[194:195], v[12:13], v[242:243] op_sel:[0,0,0] op_sel_hi:[1,0,1]
    s_waitcnt lgkmcnt(1)
    v_pk_fma_f32 v[196:197], v[196:197], v[12:13], v[244:245] op_sel:[0,0,0] op_sel_hi:[1,0,1]
    v_pk_fma_f32 v[198:199], v[198:199], v[12:13], v[246:247] op_sel:[0,0,0] op_sel_hi:[1,0,1]
    v_pk_mul_f32 v[16:17], v[192:193], v[192:193]
    v_pk_mul_f32 v[18:19], v[194:195], v[194:195]
    v_pk_mul_f32 v[20:21], v[196:197], v[196:197]
    v_pk_mul_f32 v[22:23], v[198:199], v[198:199]
    v_pk_fma_f32 v[16:17], v[16:17], v[14:15], v[14:15] op_sel:[0,0,1] op_sel_hi:[1,0,1]
    v_pk_fma_f32 v[18:19], v[18:19], v[14:15], v[14:15] op_sel:[0,0,1] op_sel_hi:[1,0,1]
    v_pk_fma_f32 v[20:21], v[20:21], v[14:15], v[14:15] op_sel:[0,0,1] op_sel_hi:[1,0,1]
    v_pk_fma_f32 v[22:23], v[22:23], v[14:15], v[14:15] op_sel:[0,0,1] op_sel_hi:[1,0,1]
    v_pk_mul_f32 v[16:17], v[192:193], v[16:17]
    v_pk_mul_f32 v[18:19], v[194:195], v[18:19]
    v_pk_mul_f32 v[20:21], v[196:197], v[20:21]
    v_pk_mul_f32 v[22:23], v[198:199], v[22:23]
    v_exp_f32 v16, v16
    v_exp_f32 v17, v17
    v_exp_f32 v18, v18
    v_exp_f32 v19, v19
    v_exp_f32 v20, v20
    v_exp_f32 v21, v21
    v_exp_f32 v22, v22
    v_exp_f32 v23, v23
    s_xor_b32 s20, s20, 0x800
    buffer_load_dwordx4 a[184:187], v1, s[4:7], s20 offen offset:0 sc1
    v_pk_add_f32 v[16:17], v[16:17], 1.0 op_sel_hi:[1,0]
    v_pk_add_f32 v[18:19], v[18:19], 1.0 op_sel_hi:[1,0]
    v_pk_add_f32 v[20:21], v[20:21], 1.0 op_sel_hi:[1,0]
    v_pk_add_f32 v[22:23], v[22:23], 1.0 op_sel_hi:[1,0]
    v_rcp_f32 v16, v16
    v_rcp_f32 v17, v17
    v_rcp_f32 v18, v18
    v_rcp_f32 v19, v19
    v_rcp_f32 v20, v20
    v_rcp_f32 v21, v21
    v_rcp_f32 v22, v22
    v_rcp_f32 v23, v23
    buffer_load_dwordx4 a[188:191], v1, s[4:7], s20 offen offset:1024 sc1
    v_pk_mul_f32 v[16:17], v[192:193], v[16:17]
    v_pk_mul_f32 v[18:19], v[194:195], v[18:19]
    v_pk_mul_f32 v[20:21], v[196:197], v[20:21]
    v_pk_mul_f32 v[22:23], v[198:199], v[22:23]
    v_cvt_pk_bf16_f32 v24, v16, v17
    v_cvt_pk_bf16_f32 v26, v20, v21
    v_cvt_pk_bf16_f32 v25, v18, v19
    v_cvt_pk_bf16_f32 v27, v22, v23
    buffer_store_dwordx4 v[24:27], v1, s[4:7], s27 offen offset:0 sc1
    s_add_u32 s27, s27, 57344
    buffer_load_dword v2, v11, s[4:7], s24 offen sc1
    v_pk_fma_f32 v[200:201], v[200:201], v[12:13], v[240:241] op_sel:[0,1,0] op_sel_hi:[1,1,1]
    v_pk_fma_f32 v[202:203], v[202:203], v[12:13], v[242:243] op_sel:[0,1,0] op_sel_hi:[1,1,1]
    v_pk_fma_f32 v[204:205], v[204:205], v[12:13], v[244:245] op_sel:[0,1,0] op_sel_hi:[1,1,1]
    v_pk_fma_f32 v[206:207], v[206:207], v[12:13], v[246:247] op_sel:[0,1,0] op_sel_hi:[1,1,1]
    v_pk_mul_f32 v[16:17], v[200:201], v[200:201]
    v_pk_mul_f32 v[18:19], v[202:203], v[202:203]
    v_pk_mul_f32 v[20:21], v[204:205], v[204:205]
    v_pk_mul_f32 v[22:23], v[206:207], v[206:207]
    v_pk_fma_f32 v[16:17], v[16:17], v[14:15], v[14:15] op_sel:[0,0,1] op_sel_hi:[1,0,1]
    v_pk_fma_f32 v[18:19], v[18:19], v[14:15], v[14:15] op_sel:[0,0,1] op_sel_hi:[1,0,1]
    v_pk_fma_f32 v[20:21], v[20:21], v[14:15], v[14:15] op_sel:[0,0,1] op_sel_hi:[1,0,1]
    v_pk_fma_f32 v[22:23], v[22:23], v[14:15], v[14:15] op_sel:[0,0,1] op_sel_hi:[1,0,1]
    v_pk_mul_f32 v[16:17], v[200:201], v[16:17]
    v_pk_mul_f32 v[18:19], v[202:203], v[18:19]
    v_pk_mul_f32 v[20:21], v[204:205], v[20:21]
    v_pk_mul_f32 v[22:23], v[206:207], v[22:23]
    v_exp_f32 v16, v16
    v_exp_f32 v17, v17
    v_exp_f32 v18, v18
    v_exp_f32 v19, v19
    v_exp_f32 v20, v20
    v_exp_f32 v21, v21
    v_exp_f32 v22, v22
    v_exp_f32 v23, v23
    s_add_u32 s20, s21, 49152
    buffer_load_dwordx4 a[192:195], v1, s[4:7], s20 offen offset:0 sc1
    v_pk_add_f32 v[16:17], v[16:17], 1.0 op_sel_hi:[1,0]
    v_pk_add_f32 v[18:19], v[18:19], 1.0 op_sel_hi:[1,0]
    v_pk_add_f32 v[20:21], v[20:21], 1.0 op_sel_hi:[1,0]
    v_pk_add_f32 v[22:23], v[22:23], 1.0 op_sel_hi:[1,0]
    v_rcp_f32 v16, v16
    v_rcp_f32 v17, v17
    v_rcp_f32 v18, v18
    v_rcp_f32 v19, v19
    v_rcp_f32 v20, v20
    v_rcp_f32 v21, v21
    v_rcp_f32 v22, v22
    v_rcp_f32 v23, v23
    buffer_load_dwordx4 a[196:199], v1, s[4:7], s20 offen offset:1024 sc1
    v_pk_mul_f32 v[16:17], v[200:201], v[16:17]
    v_pk_mul_f32 v[18:19], v[202:203], v[18:19]
    v_pk_mul_f32 v[20:21], v[204:205], v[20:21]
    v_pk_mul_f32 v[22:23], v[206:207], v[22:23]
    v_cvt_pk_bf16_f32 v28, v16, v17
    v_cvt_pk_bf16_f32 v30, v20, v21
    v_cvt_pk_bf16_f32 v29, v18, v19
    v_cvt_pk_bf16_f32 v31, v22, v23
    buffer_store_dwordx4 v[28:31], v1, s[4:7], s27 offen offset:0 sc1
    s_waitcnt lgkmcnt(0)
    v_pk_fma_f32 v[208:209], v[208:209], v[12:13], v[248:249] op_sel:[0,0,0] op_sel_hi:[1,0,1]
    v_pk_fma_f32 v[210:211], v[210:211], v[12:13], v[250:251] op_sel:[0,0,0] op_sel_hi:[1,0,1]
    v_pk_fma_f32 v[212:213], v[212:213], v[12:13], v[248:249] op_sel:[0,1,0] op_sel_hi:[1,1,1]
    v_pk_fma_f32 v[214:215], v[214:215], v[12:13], v[250:251] op_sel:[0,1,0] op_sel_hi:[1,1,1]
    v_pk_mul_f32 v[16:17], v[208:209], v[208:209]
    v_pk_mul_f32 v[18:19], v[210:211], v[210:211]
    v_pk_mul_f32 v[20:21], v[212:213], v[212:213]
    v_pk_mul_f32 v[22:23], v[214:215], v[214:215]
    v_pk_fma_f32 v[16:17], v[16:17], v[14:15], v[14:15] op_sel:[0,0,1] op_sel_hi:[1,0,1]
    v_pk_fma_f32 v[18:19], v[18:19], v[14:15], v[14:15] op_sel:[0,0,1] op_sel_hi:[1,0,1]
    v_pk_fma_f32 v[20:21], v[20:21], v[14:15], v[14:15] op_sel:[0,0,1] op_sel_hi:[1,0,1]
    v_pk_fma_f32 v[22:23], v[22:23], v[14:15], v[14:15] op_sel:[0,0,1] op_sel_hi:[1,0,1]
    v_pk_mul_f32 v[16:17], v[208:209], v[16:17]
    v_pk_mul_f32 v[18:19], v[210:211], v[18:19]
    v_pk_mul_f32 v[20:21], v[212:213], v[20:21]
    v_pk_mul_f32 v[22:23], v[214:215], v[22:23]
    v_exp_f32 v16, v16
    v_exp_f32 v17, v17
    v_exp_f32 v18, v18
    v_exp_f32 v19, v19
    v_exp_f32 v20, v20
    v_exp_f32 v21, v21
    v_exp_f32 v22, v22
    v_exp_f32_e64 v23, v23
    s_xor_b32 s20, s20, 0x800
    buffer_load_dwordx4 a[200:203], v1, s[4:7], s20 offen offset:0 sc1
    v_pk_add_f32 v[16:17], v[16:17], 1.0 op_sel_hi:[1,0]
    v_pk_add_f32 v[18:19], v[18:19], 1.0 op_sel_hi:[1,0]
    v_pk_add_f32 v[20:21], v[20:21], 1.0 op_sel_hi:[1,0]
    v_pk_add_f32 v[22:23], v[22:23], 1.0 op_sel_hi:[1,0]
    v_rcp_f32 v16, v16
    v_rcp_f32 v17, v17
    v_rcp_f32 v18, v18
    v_rcp_f32 v19, v19
    v_rcp_f32 v20, v20
    v_rcp_f32 v21, v21
    v_rcp_f32 v22, v22
    v_rcp_f32 v23, v23
    buffer_load_dwordx4 a[204:207], v1, s[4:7], s20 offen offset:1024 sc1
    v_pk_mul_f32 v[16:17], v[208:209], v[16:17]
    v_pk_mul_f32 v[18:19], v[210:211], v[18:19]
    v_pk_mul_f32 v[20:21], v[212:213], v[20:21]
    v_pk_mul_f32 v[22:23], v[214:215], v[22:23]
    v_cvt_pk_bf16_f32 v24, v16, v17
    v_cvt_pk_bf16_f32 v26, v20, v21
    v_cvt_pk_bf16_f32 v25, v18, v19
    v_cvt_pk_bf16_f32 v27, v22, v23
    v_permlane16_swap_b32 v24, v26
    s_nop 0
    v_permlane16_swap_b32 v25, v27
    buffer_store_dwordx4 v[24:27], v8, s[4:7], s28 offen sc1
    s_add_u32 s20, s21, 53248
    buffer_load_dwordx4 a[208:211], v1, s[4:7], s20 offen offset:0 sc1
    buffer_load_dwordx4 a[212:215], v1, s[4:7], s20 offen offset:1024 sc1
    s_xor_b32 s20, s20, 0x800
    buffer_load_dwordx4 a[216:219], v1, s[4:7], s20 offen offset:0 sc1
    buffer_load_dwordx4 a[220:223], v1, s[4:7], s20 offen offset:1024 sc1
    s_add_u32 s19, s17, 0
    buffer_load_dwordx2 v[224:225], v5, s[4:7], s19 offen sc1
    s_add_u32 s19, s17, 8192
    buffer_load_dwordx2 v[226:227], v5, s[4:7], s19 offen sc1
    s_add_u32 s19, s17, 16384
    buffer_load_dwordx2 v[228:229], v5, s[4:7], s19 offen sc1
    s_add_u32 s19, s17, 24576
    buffer_load_dwordx2 v[230:231], v5, s[4:7], s19 offen sc1
    buffer_load_dwordx4 v[232:235], v6, s[4:7], s35 offen offset:0 sc1
    buffer_load_dwordx4 v[236:239], v6, s[4:7], s35 offen offset:1024 sc1
    s_waitcnt vmcnt(16)
    v_cmp_ne_u32 vcc, s48, v2
    s_cbranch_vccz GO6
    s_mov_b32 s25, 0
POLL6:
    s_mov_b64 exec, vcc
    buffer_load_dword v2, v11, s[4:7], s24 offen sc1
    s_add_u32 s25, s25, 1
    s_waitcnt vmcnt(0)
    v_cmp_ne_u32 vcc, s48, v2
    s_cmp_lt_u32 s25, 0x8000
    s_cselect_b64 vcc, vcc, 0
    s_cbranch_vccnz POLL6
    s_mov_b64 exec, -1
GO6:
    s_add_u32 s22, s30, 0
    buffer_load_dwordx4 v[32:35], v1, s[4:7], s22 offen offset:0 sc1
    buffer_load_dwordx4 v[36:39], v1, s[4:7], s22 offen offset:1024 sc1
    buffer_load_dwordx4 v[40:43], v1, s[4:7], s22 offen offset:2048 sc1
    buffer_load_dwordx4 v[44:47], v1, s[4:7], s22 offen offset:3072 sc1
    s_add_u32 s22, s30, 4096
    buffer_load_dwordx4 v[48:51], v1, s[4:7], s22 offen offset:0 sc1
    buffer_load_dwordx4 v[52:55], v1, s[4:7], s22 offen offset:1024 sc1
    buffer_load_dwordx4 v[56:59], v1, s[4:7], s22 offen offset:2048 sc1
    buffer_load_dwordx4 v[60:63], v1, s[4:7], s22 offen offset:3072 sc1
    s_add_u32 s22, s31, 0
    buffer_load_dwordx4 v[64:67], v1, s[4:7], s22 offen offset:0 sc1
    buffer_load_dwordx4 v[68:71], v1, s[4:7], s22 offen offset:1024 sc1
    buffer_load_dwordx4 v[72:75], v1, s[4:7], s22 offen offset:2048 sc1
    s_waitcnt vmcnt(21)
    s_mov_b32 exec_hi, 0
    buffer_store_dword v3, v4, s[4:7], s23 offen sc1
    s_mov_b64 exec, -1
    buffer_load_dwordx4 v[76:79], v1, s[4:7], s22 offen offset:3072 sc1
    s_add_u32 s22, s31, 4096
    buffer_load_dwordx4 v[80:83], v1, s[4:7], s22 offen offset:0 sc1
    buffer_load_dwordx4 v[84:87], v1, s[4:7], s22 offen offset:1024 sc1
    s_waitcnt vmcnt(20)
    v_lshlrev_b32 v200, 16, v224
    v_and_b32 v204, 0xffff0000, v224
    s_waitcnt vmcnt(19)
    v_lshlrev_b32 v201, 16, v226
    v_and_b32 v205, 0xffff0000, v226
    s_waitcnt vmcnt(18)
    v_lshlrev_b32 v202, 16, v228
    v_and_b32 v206, 0xffff0000, v228
    s_waitcnt vmcnt(17)
    v_lshlrev_b32 v203, 16, v230
    v_and_b32 v207, 0xffff0000, v230
    v_lshlrev_b32 v216, 16, v225
    v_and_b32 v220, 0xffff0000, v225
    v_lshlrev_b32 v217, 16, v227
    v_and_b32 v221, 0xffff0000, v227
    v_lshlrev_b32 v218, 16, v229
    v_and_b32 v222, 0xffff0000, v229
    v_lshlrev_b32 v219, 16, v231
    v_and_b32 v223, 0xffff0000, v231
    s_waitcnt vmcnt(16)
    v_pk_add_f32 v[200:201], v[200:201], v[232:233]
    v_pk_add_f32 v[202:203], v[202:203], v[234:235]
    s_waitcnt vmcnt(15)
    v_pk_add_f32 v[204:205], v[204:205], v[236:237]
    v_pk_add_f32 v[206:207], v[206:207], v[238:239]
    v_pk_add_f32 v[216:217], v[216:217], v[232:233]
    v_pk_add_f32 v[218:219], v[218:219], v[234:235]
    v_pk_add_f32 v[220:221], v[220:221], v[236:237]
    v_pk_add_f32 v[222:223], v[222:223], v[238:239]
    s_add_u32 s24, s24, 131072
    s_waitcnt vmcnt(14)
    v_mfma_f32_16x16x32_bf16 v[160:163], a[0:3], v[32:35], 0
    s_waitcnt vmcnt(13)
    v_mfma_f32_16x16x32_bf16 v[160:163], a[16:19], v[36:39], v[160:163]
    buffer_load_dwordx4 v[88:91], v1, s[4:7], s22 offen offset:2048 sc1
    v_mfma_f32_16x16x32_bf16 v[164:167], a[4:7], v[32:35], 0
    v_mfma_f32_16x16x32_bf16 v[164:167], a[20:23], v[36:39], v[164:167]
    v_mfma_f32_16x16x32_bf16 v[168:171], a[8:11], v[32:35], 0
    v_mfma_f32_16x16x32_bf16 v[168:171], a[24:27], v[36:39], v[168:171]
    buffer_load_dwordx4 v[92:95], v1, s[4:7], s22 offen offset:3072 sc1
    v_mfma_f32_16x16x32_bf16 v[172:175], a[12:15], v[32:35], 0
    v_mfma_f32_16x16x32_bf16 v[172:175], a[28:31], v[36:39], v[172:175]
    s_waitcnt vmcnt(14)
    v_mfma_f32_16x16x32_bf16 v[160:163], a[32:35], v[40:43], v[160:163]
    s_waitcnt vmcnt(13)
    v_mfma_f32_16x16x32_bf16 v[160:163], a[48:51], v[44:47], v[160:163]
    s_add_u32 s22, s32, 0
    buffer_load_dwordx4 v[96:99], v1, s[4:7], s22 offen offset:0 sc1
    v_mfma_f32_16x16x32_bf16 v[164:167], a[36:39], v[40:43], v[164:167]
    v_mfma_f32_16x16x32_bf16 v[164:167], a[52:55], v[44:47], v[164:167]
    v_mfma_f32_16x16x32_bf16 v[168:171], a[40:43], v[40:43], v[168:171]
    v_mfma_f32_16x16x32_bf16 v[168:171], a[56:59], v[44:47], v[168:171]
    buffer_load_dwordx4 v[100:103], v1, s[4:7], s22 offen offset:1024 sc1
    v_mfma_f32_16x16x32_bf16 v[172:175], a[44:47], v[40:43], v[172:175]
    v_mfma_f32_16x16x32_bf16 v[172:175], a[60:63], v[44:47], v[172:175]
    s_waitcnt vmcnt(14)
    v_mfma_f32_16x16x32_bf16 v[160:163], a[64:67], v[48:51], v[160:163]
    s_waitcnt vmcnt(13)
    v_mfma_f32_16x16x32_bf16 v[160:163], a[80:83], v[52:55], v[160:163]
    buffer_load_dwordx4 v[104:107], v1, s[4:7], s22 offen offset:2048 sc1
    v_mfma_f32_16x16x32_bf16 v[164:167], a[68:71], v[48:51], v[164:167]
    v_mfma_f32_16x16x32_bf16 v[164:167], a[84:87], v[52:55], v[164:167]
    v_mfma_f32_16x16x32_bf16 v[168:171], a[72:75], v[48:51], v[168:171]
    v_mfma_f32_16x16x32_bf16 v[168:171], a[88:91], v[52:55], v[168:171]
    buffer_load_dwordx4 v[108:111], v1, s[4:7], s22 offen offset:3072 sc1
    v_mfma_f32_16x16x32_bf16 v[172:175], a[76:79], v[48:51], v[172:175]
    v_mfma_f32_16x16x32_bf16 v[172:175], a[92:95], v[52:55], v[172:175]
    s_waitcnt vmcnt(14)
    v_mfma_f32_16x16x32_bf16 v[160:163], a[96:99], v[56:59], v[160:163]
    s_waitcnt vmcnt(13)
    v_mfma_f32_16x16x32_bf16 v[160:163], a[112:115], v[60:63], v[160:163]
    s_add_u32 s22, s32, 4096
    buffer_load_dwordx4 v[112:115], v1, s[4:7], s22 offen offset:0 sc1
    v_mfma_f32_16x16x32_bf16 v[164:167], a[100:103], v[56:59], v[164:167]
    v_mfma_f32_16x16x32_bf16 v[164:167], a[116:119], v[60:63], v[164:167]
    v_mfma_f32_16x16x32_bf16 v[168:171], a[104:107], v[56:59], v[168:171]
    v_mfma_f32_16x16x32_bf16 v[168:171], a[120:123], v[60:63], v[168:171]
    buffer_load_dwordx4 v[116:119], v1, s[4:7], s22 offen offset:1024 sc1
    v_mfma_f32_16x16x32_bf16 v[172:175], a[108:111], v[56:59], v[172:175]
    v_mfma_f32_16x16x32_bf16 v[172:175], a[124:127], v[60:63], v[172:175]
    s_waitcnt vmcnt(14)
    v_mfma_f32_16x16x32_bf16 v[176:179], a[0:3], v[64:67], 0
    s_waitcnt vmcnt(13)
    v_mfma_f32_16x16x32_bf16 v[176:179], a[16:19], v[68:71], v[176:179]
    buffer_load_dwordx4 v[120:123], v1, s[4:7], s22 offen offset:2048 sc1
    v_mfma_f32_16x16x32_bf16 v[180:183], a[4:7], v[64:67], 0
    v_mfma_f32_16x16x32_bf16 v[180:183], a[20:23], v[68:71], v[180:183]
    v_mfma_f32_16x16x32_bf16 v[184:187], a[8:11], v[64:67], 0
    v_mfma_f32_16x16x32_bf16 v[184:187], a[24:27], v[68:71], v[184:187]
    buffer_load_dwordx4 v[124:127], v1, s[4:7], s22 offen offset:3072 sc1
    v_mfma_f32_16x16x32_bf16 v[188:191], a[12:15], v[64:67], 0
    v_mfma_f32_16x16x32_bf16 v[188:191], a[28:31], v[68:71], v[188:191]
    s_waitcnt vmcnt(14)
    v_mfma_f32_16x16x32_bf16 v[176:179], a[32:35], v[72:75], v[176:179]
    s_waitcnt vmcnt(12)
    v_mfma_f32_16x16x32_bf16 v[176:179], a[48:51], v[76:79], v[176:179]
    s_add_u32 s22, s33, 0
    buffer_load_dwordx4 v[128:131], v1, s[4:7], s22 offen offset:0 sc1
    v_mfma_f32_16x16x32_bf16 v[180:183], a[36:39], v[72:75], v[180:183]
    v_mfma_f32_16x16x32_bf16 v[180:183], a[52:55], v[76:79], v[180:183]
    buffer_load_dword v2, v11, s[4:7], s24 offen sc1
    v_mfma_f32_16x16x32_bf16 v[184:187], a[40:43], v[72:75], v[184:187]
    v_mfma_f32_16x16x32_bf16 v[184:187], a[56:59], v[76:79], v[184:187]
    buffer_load_dwordx4 v[132:135], v1, s[4:7], s22 offen offset:1024 sc1
    v_mfma_f32_16x16x32_bf16 v[188:191], a[44:47], v[72:75], v[188:191]
    v_mfma_f32_16x16x32_bf16 v[188:191], a[60:63], v[76:79], v[188:191]
    s_waitcnt vmcnt(14)
    v_mfma_f32_16x16x32_bf16 v[176:179], a[64:67], v[80:83], v[176:179]
    s_waitcnt vmcnt(13)
    v_mfma_f32_16x16x32_bf16 v[176:179], a[80:83], v[84:87], v[176:179]
    buffer_load_dwordx4 v[136:139], v1, s[4:7], s22 offen offset:2048 sc1
    v_mfma_f32_16x16x32_bf16 v[180:183], a[68:71], v[80:83], v[180:183]
    v_mfma_f32_16x16x32_bf16 v[180:183], a[84:87], v[84:87], v[180:183]
    v_mfma_f32_16x16x32_bf16 v[184:187], a[72:75], v[80:83], v[184:187]
    v_mfma_f32_16x16x32_bf16 v[184:187], a[88:91], v[84:87], v[184:187]
    buffer_load_dwordx4 v[140:143], v1, s[4:7], s22 offen offset:3072 sc1
    v_mfma_f32_16x16x32_bf16 v[188:191], a[76:79], v[80:83], v[188:191]
    v_mfma_f32_16x16x32_bf16 v[188:191], a[92:95], v[84:87], v[188:191]
    s_waitcnt vmcnt(14)
    v_mfma_f32_16x16x32_bf16 v[176:179], a[96:99], v[88:91], v[176:179]
    s_waitcnt vmcnt(13)
    v_mfma_f32_16x16x32_bf16 v[176:179], a[112:115], v[92:95], v[176:179]
    s_add_u32 s22, s33, 4096
    buffer_load_dwordx4 v[144:147], v1, s[4:7], s22 offen offset:0 sc1
    v_mfma_f32_16x16x32_bf16 v[180:183], a[100:103], v[88:91], v[180:183]
    v_mfma_f32_16x16x32_bf16 v[180:183], a[116:119], v[92:95], v[180:183]
    v_mfma_f32_16x16x32_bf16 v[184:187], a[104:107], v[88:91], v[184:187]
    v_mfma_f32_16x16x32_bf16 v[184:187], a[120:123], v[92:95], v[184:187]
    buffer_load_dwordx4 v[148:151], v1, s[4:7], s22 offen offset:1024 sc1
    v_mfma_f32_16x16x32_bf16 v[188:191], a[108:111], v[88:91], v[188:191]
    v_mfma_f32_16x16x32_bf16 v[188:191], a[124:127], v[92:95], v[188:191]
    s_waitcnt vmcnt(14)
    v_mfma_f32_16x16x32_bf16 v[192:195], a[0:3], v[96:99], 0
    s_waitcnt vmcnt(13)
    v_mfma_f32_16x16x32_bf16 v[192:195], a[16:19], v[100:103], v[192:195]
    buffer_load_dwordx4 v[152:155], v1, s[4:7], s22 offen offset:2048 sc1
    v_mfma_f32_16x16x32_bf16 v[196:199], a[4:7], v[96:99], 0
    v_mfma_f32_16x16x32_bf16 v[196:199], a[20:23], v[100:103], v[196:199]
    v_mfma_f32_16x16x32_bf16 v[200:203], a[8:11], v[96:99], v[200:203]
    v_mfma_f32_16x16x32_bf16 v[200:203], a[24:27], v[100:103], v[200:203]
    buffer_load_dwordx4 v[156:159], v1, s[4:7], s22 offen offset:3072 sc1
    v_mfma_f32_16x16x32_bf16 v[204:207], a[12:15], v[96:99], v[204:207]
    v_mfma_f32_16x16x32_bf16 v[204:207], a[28:31], v[100:103], v[204:207]
    s_waitcnt vmcnt(14)
    v_mfma_f32_16x16x32_bf16 v[192:195], a[32:35], v[104:107], v[192:195]
    s_waitcnt vmcnt(13)
    v_mfma_f32_16x16x32_bf16 v[192:195], a[48:51], v[108:111], v[192:195]
    s_waitcnt vmcnt(7)
    v_cmp_ne_u32 vcc, s48, v2
    s_cbranch_vccz GO7
    s_mov_b32 s25, 0
POLL7:
    s_mov_b64 exec, vcc
    buffer_load_dword v2, v11, s[4:7], s24 offen sc1
    s_add_u32 s25, s25, 1
    s_waitcnt vmcnt(0)
    v_cmp_ne_u32 vcc, s48, v2
    s_cmp_lt_u32 s25, 0x8000
    s_cselect_b64 vcc, vcc, 0
    s_cbranch_vccnz POLL7
    s_mov_b64 exec, -1
GO7:
    s_add_u32 s22, s30, 8192
    buffer_load_dwordx4 v[32:35], v1, s[4:7], s22 offen offset:0 sc1
    v_mfma_f32_16x16x32_bf16 v[196:199], a[36:39], v[104:107], v[196:199]
    v_mfma_f32_16x16x32_bf16 v[196:199], a[52:55], v[108:111], v[196:199]
    v_mfma_f32_16x16x32_bf16 v[200:203], a[40:43], v[104:107], v[200:203]
    v_mfma_f32_16x16x32_bf16 v[200:203], a[56:59], v[108:111], v[200:203]
    buffer_load_dwordx4 v[36:39], v1, s[4:7], s22 offen offset:1024 sc1
    v_mfma_f32_16x16x32_bf16 v[204:207], a[44:47], v[104:107], v[204:207]
    v_add_u32_e64 v7, s16, v1
    v_mfma_f32_16x16x32_bf16 v[204:207], a[60:63], v[108:111], v[204:207]
    v_mfma_f32_16x16x32_bf16 v[192:195], a[64:67], v[112:115], v[192:195]
    s_xor_b32 s25, s3, 1
    s_mul_i32 s25, s25, 12288
    v_mfma_f32_16x16x32_bf16 v[192:195], a[80:83], v[116:119], v[192:195]
    buffer_load_dwordx4 v[40:43], v1, s[4:7], s22 offen offset:2048 sc1
    v_mfma_f32_16x16x32_bf16 v[196:199], a[68:71], v[112:115], v[196:199]
    s_add_u32 s25, s25, 122880
    v_add_u32 v240, s25, v1
    v_mfma_f32_16x16x32_bf16 v[196:199], a[84:87], v[116:119], v[196:199]
    v_mfma_f32_16x16x32_bf16 v[200:203], a[72:75], v[112:115], v[200:203]
    s_xor_b32 s25, s3, 2
    s_mul_i32 s25, s25, 12288
    v_mfma_f32_16x16x32_bf16 v[200:203], a[88:91], v[116:119], v[200:203]
    buffer_load_dwordx4 v[44:47], v1, s[4:7], s22 offen offset:3072 sc1
    v_mfma_f32_16x16x32_bf16 v[204:207], a[76:79], v[112:115], v[204:207]
    s_add_u32 s25, s25, 118784
    v_add_u32 v241, s25, v1
    v_mfma_f32_16x16x32_bf16 v[204:207], a[92:95], v[116:119], v[204:207]
    v_mfma_f32_16x16x32_bf16 v[192:195], a[96:99], v[120:123], v[192:195]
    s_xor_b32 s25, s3, 3
    s_mul_i32 s25, s25, 12288
    v_mfma_f32_16x16x32_bf16 v[192:195], a[112:115], v[124:127], v[192:195]
    s_add_u32 s22, s30, 12288
    buffer_load_dwordx4 v[48:51], v1, s[4:7], s22 offen offset:0 sc1
    v_mfma_f32_16x16x32_bf16 v[196:199], a[100:103], v[120:123], v[196:199]
    s_add_u32 s25, s25, 114688
    v_add_u32_e64 v242, s25, v1
    v_mfma_f32_16x16x32_bf16 v[196:199], a[116:119], v[124:127], v[196:199]
    v_mfma_f32_16x16x32_bf16 v[200:203], a[104:107], v[120:123], v[200:203]
    s_add_u32 s17, s17, 0x200000
    s_cmp_eq_u32 s35, 0xbc4000
    s_cselect_b32 s8, 0xffff, 0
    v_mfma_f32_16x16x32_bf16 v[200:203], a[120:123], v[124:127], v[200:203]
    buffer_load_dwordx4 v[52:55], v1, s[4:7], s22 offen offset:1024 sc1
    v_mfma_f32_16x16x32_bf16 v[204:207], a[108:111], v[120:123], v[204:207]
    s_mov_b32 s9, 0
    v_bfe_u32 v16, v0, 5, 1
    v_and_b32 v243, 0x7c, v4
    v_mfma_f32_16x16x32_bf16 v[204:207], a[124:127], v[124:127], v[204:207]
    v_mfma_f32_16x16x32_bf16 v[208:211], a[0:3], v[128:131], 0
    v_lshl_add_u32 v243, v16, 13, v243
    v_bfe_u32 v17, v0, 2, 3
    s_waitcnt vmcnt(12)
    v_mfma_f32_16x16x32_bf16 v[208:211], a[16:19], v[132:135], v[208:211]
    s_add_u32 s22, s31, 8192
    buffer_load_dwordx4 v[56:59], v1, s[4:7], s22 offen offset:0 sc1
    v_mfma_f32_16x16x32_bf16 v[212:215], a[4:7], v[128:131], 0
    v_lshl_add_u32 v16, v17, 1, v16
    v_bfe_u32 v17, v0, 1, 1
    v_mfma_f32_16x16x32_bf16 v[212:215], a[20:23], v[132:135], v[212:215]
    v_mfma_f32_16x16x32_bf16 v[216:219], a[8:11], v[128:131], v[216:219]
    v_lshl_add_u32 v16, v17, 4, v16
    v_lshlrev_b32_e64 v244, 2, v16
    v_mfma_f32_16x16x32_bf16 v[216:219], a[24:27], v[132:135], v[216:219]
    buffer_load_dwordx4 v[60:63], v1, s[4:7], s22 offen offset:1024 sc1
    v_mfma_f32_16x16x32_bf16 v[220:223], a[12:15], v[128:131], v[220:223]
    s_mov_b32 s10, 0xaaaaaaaa
    s_mov_b32 s11, s10
    s_lshl_b32 s25, s12, 9
    v_mfma_f32_16x16x32_bf16 v[220:223], a[28:31], v[132:135], v[220:223]
    s_waitcnt vmcnt(13)
    v_mfma_f32_16x16x32_bf16 v[208:211], a[32:35], v[136:139], v[208:211]
    s_add_u32 s26, s26, s25
    s_add_u32 s26, s26, 0xbcc000
    s_waitcnt vmcnt(12)
    v_mfma_f32_16x16x32_bf16 v[208:211], a[48:51], v[140:143], v[208:211]
    buffer_load_dwordx4 v[64:67], v1, s[4:7], s22 offen offset:2048 sc1
    v_mfma_f32_16x16x32_bf16 v[212:215], a[36:39], v[136:139], v[212:215]
    v_mfma_f32_16x16x32_bf16 v[212:215], a[52:55], v[140:143], v[212:215]
    v_mfma_f32_16x16x32_bf16 v[216:219], a[40:43], v[136:139], v[216:219]
    v_mfma_f32_16x16x32_bf16 v[216:219], a[56:59], v[140:143], v[216:219]
    buffer_load_dwordx4 v[68:71], v1, s[4:7], s22 offen offset:3072 sc1
    v_mfma_f32_16x16x32_bf16 v[220:223], a[44:47], v[136:139], v[220:223]
    v_mfma_f32_16x16x32_bf16 v[220:223], a[60:63], v[140:143], v[220:223]
    s_waitcnt vmcnt(13)
    v_mfma_f32_16x16x32_bf16 v[208:211], a[64:67], v[144:147], v[208:211]
    s_waitcnt vmcnt(12)
    v_mfma_f32_16x16x32_bf16 v[208:211], a[80:83], v[148:151], v[208:211]
    s_add_u32 s22, s31, 12288
    buffer_load_dwordx4 v[72:75], v1, s[4:7], s22 offen offset:0 sc1
    v_mfma_f32_16x16x32_bf16 v[212:215], a[68:71], v[144:147], v[212:215]
    v_mfma_f32_16x16x32_bf16 v[212:215], a[84:87], v[148:151], v[212:215]
    v_mfma_f32_16x16x32_bf16 v[216:219], a[72:75], v[144:147], v[216:219]
    v_mfma_f32_16x16x32_bf16 v[216:219], a[88:91], v[148:151], v[216:219]
    buffer_load_dwordx4 v[76:79], v1, s[4:7], s22 offen offset:1024 sc1
    v_mfma_f32_16x16x32_bf16 v[220:223], a[76:79], v[144:147], v[220:223]
    v_mfma_f32_16x16x32_bf16 v[220:223], a[92:95], v[148:151], v[220:223]
    s_waitcnt vmcnt(13)
    v_mfma_f32_16x16x32_bf16 v[208:211], a[96:99], v[152:155], v[208:211]
    s_waitcnt vmcnt(12)
    v_mfma_f32_16x16x32_bf16 v[208:211], a[112:115], v[156:159], v[208:211]
    s_add_u32 s22, s32, 8192
    buffer_load_dwordx4 v[80:83], v1, s[4:7], s22 offen offset:0 sc1
    v_mfma_f32_16x16x32_bf16 v[212:215], a[100:103], v[152:155], v[212:215]
    v_mfma_f32_16x16x32_bf16 v[212:215], a[116:119], v[156:159], v[212:215]
    v_mfma_f32_16x16x32_bf16 v[216:219], a[104:107], v[152:155], v[216:219]
    v_mfma_f32_16x16x32_bf16 v[216:219], a[120:123], v[156:159], v[216:219]
    buffer_load_dwordx4 v[84:87], v1, s[4:7], s22 offen offset:1024 sc1
    v_mfma_f32_16x16x32_bf16 v[220:223], a[108:111], v[152:155], v[220:223]
    v_mfma_f32_16x16x32_bf16 v[220:223], a[124:127], v[156:159], v[220:223]
    s_waitcnt vmcnt(13)
    v_mfma_f32_16x16x32_bf16 v[160:163], a[128:131], v[32:35], v[160:163]
    s_waitcnt vmcnt(12)
    v_mfma_f32_16x16x32_bf16 v[160:163], a[144:147], v[36:39], v[160:163]
    buffer_load_dwordx4 v[88:91], v1, s[4:7], s22 offen offset:2048 sc1
    v_mfma_f32_16x16x32_bf16 v[164:167], a[132:135], v[32:35], v[164:167]
    v_mfma_f32_16x16x32_bf16 v[164:167], a[148:151], v[36:39], v[164:167]
    v_mfma_f32_16x16x32_bf16 v[168:171], a[136:139], v[32:35], v[168:171]
    v_mfma_f32_16x16x32_bf16 v[168:171], a[152:155], v[36:39], v[168:171]
    buffer_load_dwordx4 v[92:95], v1, s[4:7], s22 offen offset:3072 sc1
    v_mfma_f32_16x16x32_bf16 v[172:175], a[140:143], v[32:35], v[172:175]
    v_mfma_f32_16x16x32_bf16 v[172:175], a[156:159], v[36:39], v[172:175]
    s_waitcnt vmcnt(13)
    v_mfma_f32_16x16x32_bf16 v[160:163], a[160:163], v[40:43], v[160:163]
    s_waitcnt vmcnt(12)
    v_mfma_f32_16x16x32_bf16 v[160:163], a[176:179], v[44:47], v[160:163]
    s_add_u32 s22, s32, 12288
    buffer_load_dwordx4 v[96:99], v1, s[4:7], s22 offen offset:0 sc1
    v_mfma_f32_16x16x32_bf16 v[164:167], a[164:167], v[40:43], v[164:167]
    v_mfma_f32_16x16x32_bf16 v[164:167], a[180:183], v[44:47], v[164:167]
    v_mfma_f32_16x16x32_bf16 v[168:171], a[168:171], v[40:43], v[168:171]
    v_mfma_f32_16x16x32_bf16 v[168:171], a[184:187], v[44:47], v[168:171]
    buffer_load_dwordx4 v[100:103], v1, s[4:7], s22 offen offset:1024 sc1
    v_mfma_f32_16x16x32_bf16 v[172:175], a[172:175], v[40:43], v[172:175]
    v_mfma_f32_16x16x32_bf16 v[172:175], a[188:191], v[44:47], v[172:175]
    s_waitcnt vmcnt(13)
    v_mfma_f32_16x16x32_bf16 v[160:163], a[192:195], v[48:51], v[160:163]
    s_waitcnt vmcnt(12)
    v_mfma_f32_16x16x32_bf16 v[160:163], a[208:211], v[52:55], v[160:163]
    s_add_u32 s22, s33, 8192
    buffer_load_dwordx4 v[104:107], v1, s[4:7], s22 offen offset:0 sc1
    v_mfma_f32_16x16x32_bf16 v[164:167], a[196:199], v[48:51], v[164:167]
    v_mfma_f32_16x16x32_bf16 v[164:167], a[212:215], v[52:55], v[164:167]
    v_mfma_f32_16x16x32_bf16 v[168:171], a[200:203], v[48:51], v[168:171]
    v_mfma_f32_16x16x32_bf16 v[168:171], a[216:219], v[52:55], v[168:171]
    buffer_load_dwordx4 v[108:111], v1, s[4:7], s22 offen offset:1024 sc1
    v_mfma_f32_16x16x32_bf16 v[172:175], a[204:207], v[48:51], v[172:175]
    v_mfma_f32_16x16x32_bf16 v[172:175], a[220:223], v[52:55], v[172:175]
    s_waitcnt vmcnt(13)
    v_mfma_f32_16x16x32_bf16 v[176:179], a[128:131], v[56:59], v[176:179]
    s_waitcnt vmcnt(12)
    v_mfma_f32_16x16x32_bf16 v[176:179], a[144:147], v[60:63], v[176:179]
    buffer_load_dwordx4 v[112:115], v1, s[4:7], s22 offen offset:2048 sc1
    v_mfma_f32_16x16x32_bf16 v[180:183], a[132:135], v[56:59], v[180:183]
    v_mfma_f32_16x16x32_bf16 v[180:183], a[148:151], v[60:63], v[180:183]
    v_mfma_f32_16x16x32_bf16 v[184:187], a[136:139], v[56:59], v[184:187]
    v_mfma_f32_16x16x32_bf16 v[184:187], a[152:155], v[60:63], v[184:187]
    buffer_load_dwordx4 v[116:119], v1, s[4:7], s22 offen offset:3072 sc1
    v_mfma_f32_16x16x32_bf16 v[188:191], a[140:143], v[56:59], v[188:191]
    v_mfma_f32_16x16x32_bf16 v[188:191], a[156:159], v[60:63], v[188:191]
    s_waitcnt vmcnt(13)
    v_mfma_f32_16x16x32_bf16 v[176:179], a[160:163], v[64:67], v[176:179]
    s_waitcnt vmcnt(12)
    v_mfma_f32_16x16x32_bf16 v[176:179], a[176:179], v[68:71], v[176:179]
    s_add_u32 s22, s33, 12288
    buffer_load_dwordx4 v[120:123], v1, s[4:7], s22 offen offset:0 sc1
    v_mfma_f32_16x16x32_bf16 v[180:183], a[164:167], v[64:67], v[180:183]
    v_mfma_f32_16x16x32_bf16 v[180:183], a[180:183], v[68:71], v[180:183]
    v_mfma_f32_16x16x32_bf16 v[184:187], a[168:171], v[64:67], v[184:187]
    v_mfma_f32_16x16x32_bf16 v[184:187], a[184:187], v[68:71], v[184:187]
    buffer_load_dwordx4 v[124:127], v1, s[4:7], s22 offen offset:1024 sc1
    v_mfma_f32_16x16x32_bf16 v[188:191], a[172:175], v[64:67], v[188:191]
    v_mfma_f32_16x16x32_bf16 v[188:191], a[188:191], v[68:71], v[188:191]
    s_waitcnt vmcnt(13)
    v_mfma_f32_16x16x32_bf16 v[176:179], a[192:195], v[72:75], v[176:179]
    s_waitcnt vmcnt(12)
    v_mfma_f32_16x16x32_bf16 v[176:179], a[208:211], v[76:79], v[176:179]
    s_add_u32 s21, s39, 0xdc0000
    s_add_u32 s20, s21, 0
    buffer_load_dwordx4 a[0:3], v1, s[4:7], s20 offen offset:0 sc1
    v_mfma_f32_16x16x32_bf16 v[180:183], a[196:199], v[72:75], v[180:183]
    v_mfma_f32_16x16x32_bf16 v[180:183], a[212:215], v[76:79], v[180:183]
    v_mfma_f32_16x16x32_bf16 v[184:187], a[200:203], v[72:75], v[184:187]
    v_mfma_f32_16x16x32_bf16 v[184:187], a[216:219], v[76:79], v[184:187]
    buffer_load_dwordx4 a[4:7], v1, s[4:7], s20 offen offset:1024 sc1
    v_mfma_f32_16x16x32_bf16 v[188:191], a[204:207], v[72:75], v[188:191]
    v_mfma_f32_16x16x32_bf16 v[188:191], a[220:223], v[76:79], v[188:191]
    s_waitcnt vmcnt(13)
    v_mfma_f32_16x16x32_bf16 v[192:195], a[128:131], v[80:83], v[192:195]
    s_waitcnt vmcnt(12)
    v_mfma_f32_16x16x32_bf16 v[192:195], a[144:147], v[84:87], v[192:195]
    s_xor_b32 s20, s20, 0x800
    buffer_load_dwordx4 a[8:11], v1, s[4:7], s20 offen offset:0 sc1
    v_mfma_f32_16x16x32_bf16 v[196:199], a[132:135], v[80:83], v[196:199]
    v_mfma_f32_16x16x32_bf16 v[196:199], a[148:151], v[84:87], v[196:199]
    s_waitcnt vmcnt(12)
    v_mfma_f32_16x16x32_bf16 v[192:195], a[160:163], v[88:91], v[192:195]
    s_waitcnt vmcnt(11)
    v_mfma_f32_16x16x32_bf16 v[192:195], a[176:179], v[92:95], v[192:195]
    buffer_load_dwordx4 a[12:15], v1, s[4:7], s20 offen offset:1024 sc1
    v_mfma_f32_16x16x32_bf16 v[196:199], a[164:167], v[88:91], v[196:199]
    ds_write_b128 v7, v[160:163] offset:0
    v_mfma_f32_16x16x32_bf16 v[196:199], a[180:183], v[92:95], v[196:199]
    s_waitcnt vmcnt(11)
    v_mfma_f32_16x16x32_bf16 v[192:195], a[192:195], v[96:99], v[192:195]
    ds_write_b128 v7, v[164:167] offset:1024
    s_waitcnt vmcnt(10)
    v_mfma_f32_16x16x32_bf16 v[192:195], a[208:211], v[100:103], v[192:195]
    s_add_u32 s20, s21, 4096
    buffer_load_dwordx4 a[16:19], v1, s[4:7], s20 offen offset:0 sc1
    v_mfma_f32_16x16x32_bf16 v[196:199], a[196:199], v[96:99], v[196:199]
    ds_write_b128 v7, v[176:179] offset:2048
    v_mfma_f32_16x16x32_bf16 v[196:199], a[212:215], v[100:103], v[196:199]
    s_waitcnt vmcnt(10)
    v_mfma_f32_16x16x32_bf16 v[208:211], a[128:131], v[104:107], v[208:211]
    ds_write_b128 v7, v[180:183] offset:3072
    s_waitcnt vmcnt(9)
    v_mfma_f32_16x16x32_bf16 v[208:211], a[144:147], v[108:111], v[208:211]
    buffer_load_dwordx4 a[20:23], v1, s[4:7], s20 offen offset:1024 sc1
    v_mfma_f32_16x16x32_bf16 v[212:215], a[132:135], v[104:107], v[212:215]
    ds_write_b128 v7, v[168:171] offset:4096
    v_mfma_f32_16x16x32_bf16 v[212:215], a[148:151], v[108:111], v[212:215]
    s_waitcnt vmcnt(9)
    v_mfma_f32_16x16x32_bf16 v[208:211], a[160:163], v[112:115], v[208:211]
    ds_write_b128 v7, v[172:175] offset:5120
    s_waitcnt vmcnt(8)
    v_mfma_f32_16x16x32_bf16 v[208:211], a[176:179], v[116:119], v[208:211]
    s_xor_b32 s20, s20, 0x800
    buffer_load_dwordx4 a[24:27], v1, s[4:7], s20 offen offset:0 sc1
    v_mfma_f32_16x16x32_bf16 v[212:215], a[164:167], v[112:115], v[212:215]
    ds_write_b128 v7, v[184:187] offset:6144
    v_mfma_f32_16x16x32_bf16 v[212:215], a[180:183], v[116:119], v[212:215]
    s_waitcnt vmcnt(8)
    v_mfma_f32_16x16x32_bf16 v[208:211], a[192:195], v[120:123], v[208:211]
    ds_write_b128 v7, v[188:191] offset:7168
    s_waitcnt vmcnt(7)
    v_mfma_f32_16x16x32_bf16 v[208:211], a[208:211], v[124:127], v[208:211]
    buffer_load_dwordx4 a[28:31], v1, s[4:7], s20 offen offset:1024 sc1
    v_mfma_f32_16x16x32_bf16 v[212:215], a[196:199], v[120:123], v[212:215]
    v_mfma_f32_16x16x32_bf16 v[212:215], a[212:215], v[124:127], v[212:215]
    v_mfma_f32_16x16x32_bf16 v[200:203], a[136:139], v[80:83], v[200:203]
    v_mfma_f32_16x16x32_bf16 v[200:203], a[152:155], v[84:87], v[200:203]
    s_add_u32 s20, s21, 8192
    buffer_load_dwordx4 a[32:35], v1, s[4:7], s20 offen offset:0 sc1
    v_mfma_f32_16x16x32_bf16 v[204:207], a[140:143], v[80:83], v[204:207]
    v_mfma_f32_16x16x32_bf16 v[204:207], a[156:159], v[84:87], v[204:207]
    v_mfma_f32_16x16x32_bf16 v[200:203], a[168:171], v[88:91], v[200:203]
    v_mfma_f32_16x16x32_bf16 v[200:203], a[184:187], v[92:95], v[200:203]
    buffer_load_dwordx4 a[36:39], v1, s[4:7], s20 offen offset:1024 sc1
    ds_write_b128 v7, v[192:195] offset:8192
    v_mfma_f32_16x16x32_bf16 v[204:207], a[172:175], v[88:91], v[204:207]
    ds_write_b128 v7, v[196:199] offset:9216
    v_mfma_f32_16x16x32_bf16 v[204:207], a[188:191], v[92:95], v[204:207]
    ds_write_b128 v7, v[208:211] offset:10240
    v_mfma_f32_16x16x32_bf16 v[200:203], a[200:203], v[96:99], v[200:203]
    ds_write_b128 v7, v[212:215] offset:11264
    v_mfma_f32_16x16x32_bf16 v[200:203], a[216:219], v[100:103], v[200:203]
    s_xor_b32 s20, s20, 0x800
    buffer_load_dwordx4 a[40:43], v1, s[4:7], s20 offen offset:0 sc1
    v_mfma_f32_16x16x32_bf16 v[204:207], a[204:207], v[96:99], v[204:207]
    v_mfma_f32_16x16x32_bf16 v[204:207], a[220:223], v[100:103], v[204:207]
    v_mfma_f32_16x16x32_bf16 v[216:219], a[136:139], v[104:107], v[216:219]
    v_mfma_f32_16x16x32_bf16 v[216:219], a[152:155], v[108:111], v[216:219]
    buffer_load_dwordx4 a[44:47], v1, s[4:7], s20 offen offset:1024 sc1
    v_mfma_f32_16x16x32_bf16 v[220:223], a[140:143], v[104:107], v[220:223]
    v_mfma_f32_16x16x32_bf16 v[220:223], a[156:159], v[108:111], v[220:223]
    v_mfma_f32_16x16x32_bf16 v[216:219], a[168:171], v[112:115], v[216:219]
    s_waitcnt lgkmcnt(0)
    s_barrier
    ds_read_b128 v[32:35], v240 offset:0
    ds_read_b128 v[36:39], v240 offset:1024
    v_mfma_f32_16x16x32_bf16 v[216:219], a[184:187], v[116:119], v[216:219]
    s_add_u32 s20, s21, 12288
    buffer_load_dwordx4 a[48:51], v1, s[4:7], s20 offen offset:0 sc1
    ds_read_b128 v[40:43], v240 offset:2048
    ds_read_b128 v[44:47], v240 offset:3072
    v_mfma_f32_16x16x32_bf16 v[220:223], a[172:175], v[112:115], v[220:223]
    ds_read_b128 v[48:51], v241 offset:0
    ds_read_b128 v[52:55], v241 offset:1024
    v_mfma_f32_16x16x32_bf16 v[220:223], a[188:191], v[116:119], v[220:223]
    ds_read_b128 v[56:59], v241 offset:2048
    ds_read_b128 v[60:63], v241 offset:3072
    v_mfma_f32_16x16x32_bf16 v[216:219], a[200:203], v[120:123], v[216:219]
    ds_read_b128 v[64:67], v242 offset:0
    ds_read_b128 v[68:71], v242 offset:1024
    v_mfma_f32_16x16x32_bf16 v[216:219], a[216:219], v[124:127], v[216:219]
    ds_read_b128 v[72:75], v242 offset:2048
    ds_read_b128 v[76:79], v242 offset:3072
    v_mfma_f32_16x16x32_bf16 v[220:223], a[204:207], v[120:123], v[220:223]
    v_mfma_f32_16x16x32_bf16 v[220:223], a[220:223], v[124:127], v[220:223]
    s_waitcnt lgkmcnt(7)
    v_pk_add_f32 v[32:33], v[32:33], v[48:49]
    v_pk_add_f32 v[34:35], v[34:35], v[50:51]
    s_waitcnt lgkmcnt(6)
    v_pk_add_f32 v[36:37], v[36:37], v[52:53]
    v_pk_add_f32 v[38:39], v[38:39], v[54:55]
    s_waitcnt lgkmcnt(5)
    v_pk_add_f32 v[40:41], v[40:41], v[56:57]
    v_pk_add_f32 v[42:43], v[42:43], v[58:59]
    s_waitcnt lgkmcnt(4)
    v_pk_add_f32 v[44:45], v[44:45], v[60:61]
    v_pk_add_f32 v[46:47], v[46:47], v[62:63]
    s_waitcnt lgkmcnt(3)
    v_pk_add_f32 v[32:33], v[32:33], v[64:65]
    v_pk_add_f32 v[34:35], v[34:35], v[66:67]
    s_waitcnt lgkmcnt(2)
    v_pk_add_f32 v[36:37], v[36:37], v[68:69]
    v_pk_add_f32 v[38:39], v[38:39], v[70:71]
    s_waitcnt lgkmcnt(1)
    v_pk_add_f32 v[40:41], v[40:41], v[72:73]
    v_pk_add_f32 v[42:43], v[42:43], v[74:75]
    s_waitcnt lgkmcnt(0)
    v_pk_add_f32 v[44:45], v[44:45], v[76:77]
    v_pk_add_f32 v[46:47], v[46:47], v[78:79]
    v_pk_add_f32 v[200:201], v[200:201], v[32:33]
    v_pk_add_f32 v[202:203], v[202:203], v[34:35]
    v_pk_add_f32 v[204:205], v[204:205], v[36:37]
    v_pk_add_f32 v[206:207], v[206:207], v[38:39]
    v_pk_add_f32 v[216:217], v[216:217], v[40:41]
    v_pk_add_f32 v[218:219], v[218:219], v[42:43]
    v_pk_add_f32 v[220:221], v[220:221], v[44:45]
    v_pk_add_f32 v[222:223], v[222:223], v[46:47]
    v_cvt_pk_bf16_f32 v16, v200, v204
    v_cvt_pk_bf16_f32 v17, v216, v220
    s_add_u32 s19, s17, 0
    buffer_store_dwordx2 v[16:17], v5, s[4:7], s19 offen sc1
    v_cvt_pk_bf16_f32 v18, v201, v205
    v_cvt_pk_bf16_f32 v19, v217, v221
    s_add_u32 s19, s17, 8192
    buffer_store_dwordx2 v[18:19], v5, s[4:7], s19 offen sc1
    v_cvt_pk_bf16_f32 v20, v202, v206
    v_cvt_pk_bf16_f32 v21, v218, v222
    v_cvt_pk_bf16_f32 v22, v203, v207
    v_cvt_pk_bf16_f32 v23, v219, v223
    v_cndmask_b32 v204, v204, 0, s[8:9]
    v_cndmask_b32 v220, v220, 0, s[8:9]
    v_pk_mul_f32 v[24:25], v[200:201], v[200:201]
    v_pk_mul_f32 v[26:27], v[216:217], v[216:217]
    v_pk_fma_f32 v[24:25], v[202:203], v[202:203], v[24:25]
    v_pk_fma_f32 v[26:27], v[218:219], v[218:219], v[26:27]
    v_pk_fma_f32 v[24:25], v[204:205], v[204:205], v[24:25]
    v_pk_fma_f32 v[26:27], v[220:221], v[220:221], v[26:27]
    v_pk_fma_f32 v[24:25], v[206:207], v[206:207], v[24:25]
    v_pk_fma_f32 v[26:27], v[222:223], v[222:223], v[26:27]
    v_add_f32 v24, v24, v25
    v_add_f32 v26, v26, v27
    s_nop 1
    v_permlane16_swap_b32 v24, v26
    v_add_f32 v24, v24, v26
    v_mov_b32 v25, v24
    s_nop 1
    v_permlane32_swap_b32 v24, v25
    v_add_f32 v24, v24, v25
    ds_bpermute_b32 v25, v244, v24
    s_add_u32 s19, s17, 16384
    buffer_store_dwordx2 v[20:21], v5, s[4:7], s19 offen sc1
    s_add_u32 s19, s17, 24576
    buffer_store_dwordx2 v[22:23], v5, s[4:7], s19 offen sc1
    s_waitcnt lgkmcnt(0)
    v_cndmask_b32 v25, v25, 1.0, s[10:11]
    buffer_atomic_add_f32 v25, v243, s[4:7], s26 offen
    v_lshrrev_b32 v14, 6, v0
    v_lshl_add_u32 v6, v14, 11, v1
    v_accvgpr_read_b32 v36, a224
    v_accvgpr_read_b32 v37, a225
    v_accvgpr_read_b32 v38, a226
    v_accvgpr_read_b32 v39, a227
    v_accvgpr_read_b32 v40, a228
    v_accvgpr_read_b32 v41, a229
    v_accvgpr_read_b32 v42, a230
    v_accvgpr_read_b32 v43, a231
    s_cmp_ge_u32 s2, 16
    s_cbranch_scc1 NO_CP8
    s_getpc_b64 s[52:53]
CP_PC8:
    v_lshlrev_b32 v172, 7, v0
    v_min_u32 v172, CODE_END-CP_PC8-4, v172
    v_mov_b32 v173, s53
    v_add_co_u32 v172, vcc, s52, v172
    s_nop 1
    v_addc_co_u32 v173, vcc, 0, v173, vcc
    global_load_dword v5, v[172:173], off
NO_CP8:
    v_add_u32 v7, s16, v1
    v_and_b32 v19, 1, v14
    v_lshl_add_u32 v8, v19, 10, v1
    v_add_u32 v8, 114688, v8
    v_bfe_u32 v15, v0, 4, 2
    v_lshlrev_b32 v15, 2, v15
    v_cvt_f32_u32 v9, v15
    v_and_b32 v16, 15, v0
    v_cvt_f32_u32 v11, v16
    buffer_load_dwordx4 a[52:55], v1, s[4:7], s20 offen offset:1024 sc1
    v_lshrrev_b32_e64 v17, 1, v14
    v_lshl_add_u32 v19, v17, 5, v19
    v_lshl_add_u32 v17, v17, 4, v16
    v_lshl_add_u32 v16, v16, 1, v19
    v_cvt_f32_u32 v10, v16
    v_lshl_add_u32 v16, v15, 1, v19
    v_cvt_f32_u32 v16, v16
    v_cvt_f32_u32 v19, v17
    v_and_b32 v12, 1, v0
    v_mul_u32_u24 v12, 0x8000, v12
    v_lshl_or_b32 v12, v12, 16, v12
    v_mov_b32 v13, 0x4227c5ac
    v_mul_f32 v17, 0x3c800000, v10
    v_mul_f32_e64 v18, v17, v9
    s_xor_b32 s20, s20, 0x800
    buffer_load_dwordx4 a[56:59], v1, s[4:7], s20 offen offset:0 sc1
    v_fmamk_f32 v124, v17, 0x00000000, v18
    v_fmamk_f32 v125, v17, 0x3f800000, v18
    v_fmamk_f32 v126, v17, 0x40000000, v18
    v_fmamk_f32 v127, v17, 0x40400000, v18
    v_fmamk_f32 v128, v17, 0x41800000, v18
    v_fmamk_f32 v129, v17, 0x41880000, v18
    v_fmamk_f32 v130, v17, 0x41900000, v18
    v_fmamk_f32 v131, v17, 0x41980000, v18
    v_sin_f32 v244, v124
    v_cos_f32 v236, v124
    v_sin_f32 v245, v125
    v_cos_f32 v237, v125
    v_sin_f32 v246, v126
    v_cos_f32 v238, v126
    buffer_load_dwordx4 a[60:63], v1, s[4:7], s20 offen offset:1024 sc1
    v_sin_f32 v247, v127
    v_cos_f32 v239, v127
    v_sin_f32 v248, v128
    v_cos_f32 v240, v128
    v_sin_f32 v249, v129
    v_cos_f32 v241, v129
    v_sin_f32 v250, v130
    v_cos_f32 v242, v130
    v_sin_f32 v251, v131
    v_cos_f32 v243, v131
    v_cvt_pk_bf16_f32 v44, v236, v244
    v_cvt_pk_bf16_f32 v48, -v244, v236
    v_cvt_pk_bf16_f32 v45, v237, v245
    v_cvt_pk_bf16_f32 v49, -v245, v237
    s_add_u32 s20, s21, 16384
    buffer_load_dwordx4 a[64:67], v1, s[4:7], s20 offen offset:0 sc1
    v_cvt_pk_bf16_f32 v46, v238, v246
    v_cvt_pk_bf16_f32 v50, -v246, v238
    v_cvt_pk_bf16_f32 v47, v239, v247
    v_cvt_pk_bf16_f32 v51, -v247, v239
    v_cvt_pk_bf16_f32 v52, v240, v248
    v_cvt_pk_bf16_f32 v56, -v248, v240
    v_cvt_pk_bf16_f32 v53, v241, v249
    v_cvt_pk_bf16_f32 v57, -v249, v241
    v_cvt_pk_bf16_f32 v54, v242, v250
    v_cvt_pk_bf16_f32 v58, -v250, v242
    v_cvt_pk_bf16_f32 v55, v243, v251
    v_cvt_pk_bf16_f32 v59, -v251, v243
    v_mul_f32 v124, 0x3d000000, v124
    v_mul_f32 v125, 0x3d000000, v125
    buffer_load_dwordx4 a[68:71], v1, s[4:7], s20 offen offset:1024 sc1
    v_mul_f32 v126, 0x3d000000, v126
    v_mul_f32 v127, 0x3d000000, v127
    v_mul_f32 v128, 0x3d000000, v128
    v_mul_f32 v129, 0x3d000000, v129
    v_mul_f32 v130, 0x3d000000, v130
    v_mul_f32 v131, 0x3d000000, v131
    v_sin_f32 v132, v124
    v_cos_f32 v124, v124
    v_sin_f32 v133, v125
    v_cos_f32 v125, v125
    v_sin_f32 v134, v126
    v_cos_f32 v126, v126
    v_sin_f32 v135, v127
    v_cos_f32 v127, v127
    s_xor_b32 s20, s20, 0x800
    buffer_load_dwordx4 a[72:75], v1, s[4:7], s20 offen offset:0 sc1
    v_sin_f32 v136, v128
    v_cos_f32 v128, v128
    v_sin_f32 v137, v129
    v_cos_f32 v129, v129
    v_sin_f32 v138, v130
    v_cos_f32 v130, v130
    v_sin_f32 v139, v131
    v_cos_f32 v131, v131
    v_mul_f32 v17, 0x3d000000, v11
    v_mul_f32_e64 v18, v17, v9
    v_fmamk_f32 v140, v17, 0x00000000, v18
    v_fmamk_f32 v141, v17, 0x3f800000, v18
    v_fmamk_f32 v142, v17, 0x40000000, v18
    v_fmamk_f32 v143, v17, 0x40400000, v18
    buffer_load_dwordx4 a[76:79], v1, s[4:7], s20 offen offset:1024 sc1
    v_sin_f32 v148, v140
    v_cos_f32 v140, v140
    v_sin_f32 v149, v141
    v_cos_f32 v141, v141
    v_sin_f32 v150, v142
    v_cos_f32 v142, v142
    v_sin_f32 v151, v143
    v_cos_f32 v143, v143
    v_cvt_pk_bf16_f32 v92, v140, v148
    v_cvt_pk_bf16_f32 v96, -v148, v140
    v_cvt_pk_bf16_f32 v93, v141, v149
    v_cvt_pk_bf16_f32 v97, -v149, v141
    v_cvt_pk_bf16_f32 v94, v142, v150
    v_cvt_pk_bf16_f32 v98, -v150, v142
    s_add_u32 s20, s21, 20480
    buffer_load_dwordx4 a[80:83], v1, s[4:7], s20 offen offset:0 sc1
    v_cvt_pk_bf16_f32 v95, v143, v151
    v_cvt_pk_bf16_f32 v99, -v151, v143
    v_xor_b32 v100, v12, v92
    v_xor_b32 v101, v12, v93
    v_xor_b32 v102, v12, v94
    v_xor_b32 v103, v12, v95
    v_xor_b32 v104, v12, v96
    v_xor_b32 v105, v12, v97
    v_xor_b32 v106, v12, v98
    v_xor_b32 v107, v12, v99
    v_mov_b32 v108, v92
    v_xor_b32 v109, 0x80008000, v93
    v_mov_b32 v110, v94
    s_barrier
    buffer_load_dwordx4 a[84:87], v1, s[4:7], s20 offen offset:1024 sc1
    v_xor_b32 v111, 0x80008000, v95
    v_mov_b32 v112, v96
    v_xor_b32 v113, 0x80008000, v97
    v_mov_b32 v114, v98
    v_xor_b32 v115, 0x80008000, v99
    v_mov_b32 v116, v100
    v_xor_b32 v117, 0x80008000, v101
    v_mov_b32 v118, v102
    v_xor_b32 v119, 0x80008000, v103
    v_mov_b32 v120, v104
    v_xor_b32 v121, 0x80008000, v105
    v_mov_b32 v122, v106
    v_xor_b32 v123, 0x80008000, v107
    v_mul_f32 v17, 0x3a000000, v11
    v_mul_f32 v18, v17, v16
    v_fmamk_f32 v140, v17, 0x00000000, v18
    v_fmamk_f32 v141, v17, 0x40000000, v18
    v_fmamk_f32 v142, v17, 0x40800000, v18
    v_fmamk_f32 v143, v17, 0x40c00000, v18
    v_add_f32 v17, 0x3c000000, v17
    v_mul_f32_e64 v18, v17, v16
    v_fmamk_f32 v144, v17, 0x00000000, v18
    v_fmamk_f32 v145, v17, 0x40000000, v18
    v_fmamk_f32 v146, v17, 0x40800000, v18
    v_fmamk_f32 v147, v17, 0x40c00000, v18
    v_sin_f32 v148, v140
    v_cos_f32 v140, v140
    v_sin_f32 v149, v141
    v_cos_f32 v141, v141
    s_xor_b32 s20, s20, 0x800
    buffer_load_dwordx4 a[88:91], v1, s[4:7], s20 offen offset:0 sc1
    v_sin_f32 v150, v142
    v_cos_f32 v142, v142
    v_sin_f32 v151, v143
    v_cos_f32 v143, v143
    v_sin_f32 v152, v144
    v_cos_f32 v144, v144
    v_sin_f32 v153, v145
    v_cos_f32 v145, v145
    v_sin_f32 v154, v146
    v_cos_f32 v146, v146
    v_sin_f32 v155, v147
    v_cos_f32 v147, v147
    v_mul_f32 v17, 0x3c800000, v19
    v_mul_f32 v18, v17, v9
    v_add_f32 v18, v18, v18
    v_fmamk_f32 v76, v17, 0x00000000, v18
    v_fmamk_f32 v77, v17, 0x40000000, v18
    v_fmamk_f32 v78, v17, 0x40800000, v18
    v_fmamk_f32 v79, v17, 0x40c00000, v18
    v_fmamk_f32 v80, v17, 0x3f800000, v18
    v_fmamk_f32 v81, v17, 0x40400000, v18
    v_fmamk_f32 v82, v17, 0x40a00000, v18
    v_fmamk_f32 v83, v17, 0x40e00000, v18
    v_sin_f32 v84, v76
    v_cos_f32 v76, v76
    v_sin_f32 v85, v77
    v_cos_f32 v77, v77
    v_sin_f32 v86, v78
    v_cos_f32 v78, v78
    buffer_load_dwordx4 a[92:95], v1, s[4:7], s20 offen offset:1024 sc1
    v_sin_f32 v87, v79
    v_cos_f32 v79, v79
    v_sin_f32 v88, v80
    v_cos_f32 v80, v80
    v_sin_f32 v89, v81
    v_cos_f32 v81, v81
    v_sin_f32 v90, v82
    v_cos_f32 v82, v82
    v_sin_f32 v91, v83
    v_cos_f32 v83, v83
    v_cvt_pk_bf16_f32 v60, v76, v84
    v_cvt_pk_bf16_f32 v64, -v84, v76
    v_cvt_pk_bf16_f32 v61, v77, v85
    v_cvt_pk_bf16_f32 v65, -v85, v77
    v_cvt_pk_bf16_f32 v62, v78, v86
    v_cvt_pk_bf16_f32 v66, -v86, v78
    v_cvt_pk_bf16_f32 v63, v79, v87
    v_cvt_pk_bf16_f32 v67, -v87, v79
    v_cvt_pk_bf16_f32 v68, v80, v88
    v_cvt_pk_bf16_f32 v72, -v88, v80
    v_cvt_pk_bf16_f32 v69, v81, v89
    v_cvt_pk_bf16_f32 v73, -v89, v81
    v_cvt_pk_bf16_f32 v70, v82, v90
    v_cvt_pk_bf16_f32 v74, -v90, v82
    v_cvt_pk_bf16_f32 v71, v83, v91
    v_cvt_pk_bf16_f32 v75, -v91, v83
    v_xor_b32 v76, v12, v60
    v_xor_b32 v77, v12, v61
    v_xor_b32 v78, v12, v62
    s_add_u32 s20, s21, 24576
    buffer_load_dwordx4 a[96:99], v1, s[4:7], s20 offen offset:0 sc1
    v_xor_b32 v79, v12, v63
    v_xor_b32 v80, v12, v64
    v_xor_b32 v81, v12, v65
    v_xor_b32 v82, v12, v66
    v_xor_b32 v83, v12, v67
    v_xor_b32 v84, v12, v68
    v_xor_b32 v85, v12, v69
    v_xor_b32 v86, v12, v70
    v_xor_b32 v87, v12, v71
    v_xor_b32 v88, v12, v72
    v_xor_b32 v89, v12, v73
    v_xor_b32 v90, v12, v74
    v_xor_b32 v91, v12, v75
    v_lshlrev_b32 v156, 16, v36
    v_and_b32 v164, 0xffff0000, v36
    v_lshlrev_b32 v157, 16, v37
    v_and_b32 v165, 0xffff0000, v37
    v_lshlrev_b32 v158, 16, v38
    v_and_b32 v166, 0xffff0000, v38
    v_lshlrev_b32 v159, 16, v39
    v_and_b32 v167, 0xffff0000, v39
    v_lshlrev_b32 v160, 16, v40
    v_and_b32 v168, 0xffff0000, v40
    v_lshlrev_b32 v161, 16, v41
    v_and_b32 v169, 0xffff0000, v41
    v_lshlrev_b32 v162, 16, v42
    v_and_b32 v170, 0xffff0000, v42
    v_lshlrev_b32_e64 v163, 16, v43
    v_and_b32 v171, 0xffff0000, v43
    s_waitcnt vmcnt(12)
    v_add_u32 v5, 0x2000, v6
    s_mov_b32 s26, 0xbcc000
    s_add_u32 s19, s34, 0x400000
    buffer_load_dwordx4 v[20:23], v6, s[4:7], s19 offen offset:0 sc1
    buffer_load_dwordx4 v[24:27], v6, s[4:7], s19 offen offset:1024 sc1
    buffer_load_dwordx4 v[188:191], v6, s[4:7], s26 offen offset:0 sc1
    buffer_load_dwordx4 v[192:195], v5, s[4:7], s26 offen offset:0 sc1
    buffer_load_dwordx4 v[196:199], v6, s[4:7], s26 offen offset:1024 sc1
    buffer_load_dwordx4 v[200:203], v5, s[4:7], s26 offen offset:1024 sc1
    buffer_load_dwordx4 a[100:103], v1, s[4:7], s20 offen offset:1024 sc1
    s_xor_b32 s20, s20, 0x800
    buffer_load_dwordx4 a[104:107], v1, s[4:7], s20 offen offset:0 sc1
    s_waitcnt vmcnt(7)
    v_max3_u32 v212, v20, v21, v22
    s_waitcnt vmcnt(6)
    v_max3_u32 v213, v23, v24, v25
    v_max3_u32 v212, v212, v26, v27
    v_max_u32 v212, v212, v213
    v_cmp_eq_u32 s[8:9], -1, v212
    v_lshlrev_b32 v172, 16, v20
    v_and_b32 v176, 0xffff0000, v20
    v_lshlrev_b32 v173, 16, v21
    v_and_b32 v177, 0xffff0000, v21
    v_lshlrev_b32 v174, 16, v22
    v_and_b32 v178, 0xffff0000, v22
    v_lshlrev_b32 v175, 16, v23
    v_and_b32 v179, 0xffff0000, v23
    v_lshlrev_b32 v180, 16, v24
    v_and_b32 v184, 0xffff0000, v24
    v_lshlrev_b32 v181, 16, v25
    v_and_b32 v185, 0xffff0000, v25
    v_lshlrev_b32 v182, 16, v26
    v_and_b32 v186, 0xffff0000, v26
    v_lshlrev_b32 v183, 16, v27
    v_and_b32 v187, 0xffff0000, v27
    s_waitcnt vmcnt(4)
    v_min3_f32 v212, v189, v191, v193
    s_waitcnt vmcnt(3)
    v_min3_f32 v213, v195, v197, v199
    s_waitcnt vmcnt(2)
    v_min3_f32 v212, v212, v201, v203
    v_min_f32_e64 v212, v212, v213
    v_cmp_gt_f32 vcc, 0x41780000, v212
    s_or_b64 vcc, vcc, s[8:9]
    s_cbranch_vccz GATE_GO
    s_mov_b32 s25, 0
GATE_AGAIN:
    s_mov_b64 exec, vcc
    s_mov_b32 s26, 0xbcc000
    s_add_u32 s19, s34, 0x400000
    buffer_load_dwordx4 v[20:23], v6, s[4:7], s19 offen offset:0 sc1
    buffer_load_dwordx4 v[24:27], v6, s[4:7], s19 offen offset:1024 sc1
    buffer_load_dwordx4 v[188:191], v6, s[4:7], s26 offen offset:0 sc1
    buffer_load_dwordx4 v[192:195], v5, s[4:7], s26 offen offset:0 sc1
    buffer_load_dwordx4 v[196:199], v6, s[4:7], s26 offen offset:1024 sc1
    buffer_load_dwordx4 v[200:203], v5, s[4:7], s26 offen offset:1024 sc1
    s_add_u32 s25, s25, 1
    s_waitcnt vmcnt(0)
    v_max3_u32 v212, v20, v21, v22
    v_max3_u32 v213, v23, v24, v25
    v_max3_u32 v212, v212, v26, v27
    v_max_u32 v212, v212, v213
    v_cmp_eq_u32 s[8:9], -1, v212
    v_lshlrev_b32 v172, 16, v20
    v_and_b32 v176, 0xffff0000, v20
    v_lshlrev_b32 v173, 16, v21
    v_and_b32 v177, 0xffff0000, v21
    v_lshlrev_b32 v174, 16, v22
    v_and_b32 v178, 0xffff0000, v22
    v_lshlrev_b32 v175, 16, v23
    v_and_b32 v179, 0xffff0000, v23
    v_lshlrev_b32 v180, 16, v24
    v_and_b32 v184, 0xffff0000, v24
    v_lshlrev_b32 v181, 16, v25
    v_and_b32 v185, 0xffff0000, v25
    v_lshlrev_b32 v182, 16, v26
    v_and_b32 v186, 0xffff0000, v26
    v_lshlrev_b32_e64 v183, 16, v27
    v_and_b32 v187, 0xffff0000, v27
    v_min3_f32 v212, v189, v191, v193
    v_min3_f32 v213, v195, v197, v199
    v_min3_f32 v212, v212, v201, v203
    v_min_f32_e64 v212, v212, v213
    v_cmp_gt_f32 vcc, 0x41780000, v212
    s_or_b64 vcc, vcc, s[8:9]
    s_cmp_lt_u32 s25, 0x8000
    s_cselect_b64 vcc, vcc, 0
    s_cbranch_vccnz GATE_AGAIN
    s_mov_b64 exec, -1
GATE_GO:
    v_fmamk_f32 v28, v188, 0x46000000, v13
    v_fmamk_f32 v29, v190, 0x46000000, v13
    v_fmamk_f32 v30, v192, 0x46000000, v13
    v_fmamk_f32 v31, v194, 0x46000000, v13
    v_rsq_f32 v28, v28
    v_rsq_f32 v29, v29
    v_rsq_f32 v30, v30
    v_rsq_f32 v31, v31
    v_pk_mul_f32 v[236:237], v[172:173], v[28:29]
    v_pk_mul_f32 v[238:239], v[174:175], v[30:31]
    v_pk_mul_f32 v[240:241], v[176:177], v[28:29]
    v_pk_mul_f32 v[242:243], v[178:179], v[30:31]
    v_fmamk_f32 v32, v196, 0x46000000, v13
    v_fmamk_f32 v33, v198, 0x46000000, v13
    v_fmamk_f32 v34, v200, 0x46000000, v13
    v_fmamk_f32 v35, v202, 0x46000000, v13
    v_rsq_f32 v32, v32
    v_rsq_f32 v33, v33
    v_rsq_f32 v34, v34
    v_rsq_f32 v35, v35
    v_pk_fma_f32 v[244:245], v[180:181], v[32:33], v[236:237]
    v_pk_fma_f32 v[246:247], v[182:183], v[34:35], v[238:239]
    v_pk_fma_f32 v[248:249], v[184:185], v[32:33], v[240:241]
    v_pk_fma_f32 v[250:251], v[186:187], v[34:35], v[242:243]
    v_cvt_pk_bf16_f32 v228, v244, v248
    v_cvt_pk_bf16_f32 v229, v245, v249
    v_cvt_pk_bf16_f32 v230, v246, v250
    v_cvt_pk_bf16_f32 v231, v247, v251
    v_pk_fma_f32 v[244:245], v[180:181], v[32:33], v[236:237] neg_lo:[1,0,0] neg_hi:[1,0,0]
    v_pk_fma_f32 v[246:247], v[182:183], v[34:35], v[238:239] neg_lo:[1,0,0] neg_hi:[1,0,0]
    v_pk_fma_f32 v[248:249], v[184:185], v[32:33], v[240:241] neg_lo:[1,0,0] neg_hi:[1,0,0]
    v_pk_fma_f32 v[250:251], v[186:187], v[34:35], v[242:243] neg_lo:[1,0,0] neg_hi:[1,0,0]
    v_cvt_pk_bf16_f32 v232, v244, v248
    v_cvt_pk_bf16_f32 v233, v245, v249
    v_cvt_pk_bf16_f32 v234, v246, v250
    v_cvt_pk_bf16_f32 v235, v247, v251
    s_cmp_lg_u32 s2, 0
    s_cbranch_scc1 COL_A1
    v_and_b32 v228, 0xffff, v228
    v_and_b32 v229, 0xffff, v229
    v_and_b32 v230, 0xffff, v230
    v_and_b32 v231, 0xffff, v231
    v_and_b32 v232, 0xffff, v232
    v_and_b32 v233, 0xffff, v233
    v_and_b32 v234, 0xffff, v234
    v_and_b32 v235, 0xffff, v235
COL_A1:
    ds_write_b128 v7, v[228:231] offset:0
    ds_write_b128 v7, v[232:235] offset:1024
    s_waitcnt lgkmcnt(0)
    s_barrier
    ds_read_b128 v[188:191], v8 offset:0
    ds_read_b128 v[192:195], v8 offset:24576
    ds_read_b128 v[196:199], v8 offset:12288
    ds_read_b128 v[200:203], v8 offset:36864
    v_pk_mul_f32 v[236:237], v[172:173], 0.5 op_sel_hi:[1,0]
    v_pk_mul_f32 v[238:239], v[174:175], 0.5 op_sel_hi:[1,0]
    v_pk_mul_f32 v[240:241], v[176:177], 0.5 op_sel_hi:[1,0]
    v_pk_mul_f32 v[242:243], v[178:179], 0.5 op_sel_hi:[1,0]
    v_pk_fma_f32 v[172:173], v[180:181], 0.5, v[236:237] op_sel_hi:[1,0,1]
    v_pk_fma_f32 v[180:181], v[180:181], -0.5, v[236:237] op_sel_hi:[1,0,1]
    v_pk_fma_f32 v[174:175], v[182:183], 0.5, v[238:239] op_sel_hi:[1,0,1]
    v_pk_fma_f32 v[182:183], v[182:183], -0.5, v[238:239] op_sel_hi:[1,0,1]
    v_pk_fma_f32 v[176:177], v[184:185], 0.5, v[240:241] op_sel_hi:[1,0,1]
    v_pk_fma_f32 v[184:185], v[184:185], -0.5, v[240:241] op_sel_hi:[1,0,1]
    v_pk_fma_f32 v[178:179], v[186:187], 0.5, v[242:243] op_sel_hi:[1,0,1]
    v_pk_fma_f32 v[186:187], v[186:187], -0.5, v[242:243] op_sel_hi:[1,0,1]
    s_waitcnt lgkmcnt(3)
    v_mfma_f32_16x16x32_bf16 v[212:215], v[188:191], v[44:47], 0
    s_waitcnt lgkmcnt(2)
    v_mfma_f32_16x16x32_bf16 v[212:215], v[192:195], v[52:55], v[212:215]
    buffer_load_dwordx4 a[108:111], v1, s[4:7], s20 offen offset:1024 sc1
    v_mfma_f32_16x16x32_bf16 v[216:219], v[188:191], v[48:51], 0
    v_mfma_f32_16x16x32_bf16 v[216:219], v[192:195], v[56:59], v[216:219]
    s_waitcnt lgkmcnt(1)
    v_mfma_f32_16x16x32_bf16 v[220:223], v[196:199], v[44:47], 0
    s_waitcnt lgkmcnt(0)
    v_mfma_f32_16x16x32_bf16 v[220:223], v[200:203], v[52:55], v[220:223]
    s_add_u32 s20, s21, 28672
    buffer_load_dwordx4 a[112:115], v1, s[4:7], s20 offen offset:0 sc1
    v_mfma_f32_16x16x32_bf16 v[224:227], v[196:199], v[48:51], 0
    v_mfma_f32_16x16x32_bf16 v[224:227], v[200:203], v[56:59], v[224:227]
    v_pk_mul_f32 v[236:237], v[216:217], v[132:133]
    v_pk_mul_f32 v[240:241], v[212:213], v[132:133]
    v_pk_mul_f32 v[238:239], v[218:219], v[134:135]
    v_pk_mul_f32 v[242:243], v[214:215], v[134:135]
    v_pk_fma_f32 v[236:237], v[212:213], v[124:125], v[236:237]
    v_pk_fma_f32 v[240:241], v[216:217], v[124:125], v[240:241] neg_lo:[0,0,1] neg_hi:[0,0,1]
    v_pk_fma_f32 v[238:239], v[214:215], v[126:127], v[238:239]
    v_pk_fma_f32 v[242:243], v[218:219], v[126:127], v[242:243] neg_lo:[0,0,1] neg_hi:[0,0,1]
    v_cvt_pk_bf16_f32 v228, v236, v240
    v_cvt_pk_bf16_f32 v229, v237, v241
    v_cvt_pk_bf16_f32 v230, v238, v242
    v_cvt_pk_bf16_f32 v231, v239, v243
    v_pk_mul_f32 v[236:237], v[224:225], v[136:137]
    v_pk_mul_f32 v[240:241], v[220:221], v[136:137]
    v_pk_mul_f32 v[238:239], v[226:227], v[138:139]
    v_pk_mul_f32 v[242:243], v[222:223], v[138:139]
    v_pk_fma_f32 v[236:237], v[220:221], v[128:129], v[236:237]
    v_pk_fma_f32 v[240:241], v[224:225], v[128:129], v[240:241] neg_lo:[0,0,1] neg_hi:[0,0,1]
    v_pk_fma_f32 v[238:239], v[222:223], v[130:131], v[238:239]
    v_pk_fma_f32 v[242:243], v[226:227], v[130:131], v[242:243] neg_lo:[0,0,1] neg_hi:[0,0,1]
    v_cvt_pk_bf16_f32 v232, v236, v240
    v_cvt_pk_bf16_f32 v233, v237, v241
    v_cvt_pk_bf16_f32 v234, v238, v242
    v_cvt_pk_bf16_f32 v235, v239, v243
    v_mfma_f32_16x16x32_bf16 v[188:191], v[92:95], v[228:231], 0
    s_nop 0
    v_mfma_f32_16x16x32_bf16 v[188:191], v[100:103], v[232:235], v[188:191]
    buffer_load_dwordx4 a[116:119], v1, s[4:7], s20 offen offset:1024 sc1
    v_mfma_f32_16x16x32_bf16 v[192:195], v[96:99], v[228:231], 0
    v_mfma_f32_16x16x32_bf16 v[192:195], v[104:107], v[232:235], v[192:195]
    v_mfma_f32_16x16x32_bf16 v[196:199], v[108:111], v[228:231], 0
    v_mfma_f32_16x16x32_bf16 v[196:199], v[116:119], v[232:235], v[196:199]
    s_xor_b32 s20, s20, 0x800
    buffer_load_dwordx4 a[120:123], v1, s[4:7], s20 offen offset:0 sc1
    v_mfma_f32_16x16x32_bf16 v[200:203], v[112:115], v[228:231], 0
    v_mfma_f32_16x16x32_bf16 v[200:203], v[120:123], v[232:235], v[200:203]
    s_nop 1
    v_pk_mul_f32 v[236:237], v[192:193], v[164:165]
    v_pk_mul_f32 v[240:241], v[188:189], v[164:165]
    v_pk_mul_f32 v[238:239], v[194:195], v[166:167]
    v_pk_mul_f32 v[242:243], v[190:191], v[166:167]
    v_pk_fma_f32 v[236:237], v[188:189], v[156:157], v[236:237] neg_lo:[0,0,1] neg_hi:[0,0,1]
    v_pk_fma_f32 v[240:241], v[192:193], v[156:157], v[240:241]
    v_pk_fma_f32 v[238:239], v[190:191], v[158:159], v[238:239] neg_lo:[0,0,1] neg_hi:[0,0,1]
    v_pk_fma_f32 v[242:243], v[194:195], v[158:159], v[242:243]
    v_cvt_pk_bf16_f32 v204, v240, v236
    v_cvt_pk_bf16_f32 v205, v241, v237
    v_cvt_pk_bf16_f32 v206, v242, v238
    v_cvt_pk_bf16_f32 v207, v243, v239
    v_pk_mul_f32 v[236:237], v[200:201], v[168:169]
    v_pk_mul_f32 v[240:241], v[196:197], v[168:169]
    v_pk_mul_f32 v[238:239], v[202:203], v[170:171]
    v_pk_mul_f32 v[242:243], v[198:199], v[170:171]
    v_pk_fma_f32 v[236:237], v[196:197], v[160:161], v[236:237] neg_lo:[0,0,1] neg_hi:[0,0,1]
    v_pk_fma_f32 v[240:241], v[200:201], v[160:161], v[240:241]
    v_pk_fma_f32 v[238:239], v[198:199], v[162:163], v[238:239] neg_lo:[0,0,1] neg_hi:[0,0,1]
    v_pk_fma_f32 v[242:243], v[202:203], v[162:163], v[242:243]
    v_cvt_pk_bf16_f32 v208, v240, v236
    v_cvt_pk_bf16_f32 v209, v241, v237
    v_cvt_pk_bf16_f32 v210, v242, v238
    v_cvt_pk_bf16_f32 v211, v243, v239
    v_mfma_f32_16x16x32_bf16 v[216:219], v[204:207], v[92:95], 0
    s_nop 0
    v_mfma_f32_16x16x32_bf16 v[216:219], v[208:211], v[100:103], v[216:219]
    buffer_load_dwordx4 a[124:127], v1, s[4:7], s20 offen offset:1024 sc1
    v_mfma_f32_16x16x32_bf16 v[212:215], v[204:207], v[96:99], 0
    v_mfma_f32_16x16x32_bf16 v[212:215], v[208:211], v[104:107], v[212:215]
    v_mfma_f32_16x16x32_bf16 v[224:227], v[204:207], v[108:111], 0
    v_mfma_f32_16x16x32_bf16 v[224:227], v[208:211], v[116:119], v[224:227]
    s_add_u32 s20, s21, 32768
    buffer_load_dwordx4 a[128:131], v1, s[4:7], s20 offen offset:0 sc1
    v_mfma_f32_16x16x32_bf16 v[220:223], v[204:207], v[112:115], 0
    v_mfma_f32_16x16x32_bf16 v[220:223], v[208:211], v[120:123], v[220:223]
    v_pk_mul_f32 v[236:237], v[216:217], v[148:149]
    s_nop 0
    v_pk_mul_f32 v[240:241], v[212:213], v[148:149]
    v_pk_mul_f32 v[238:239], v[218:219], v[150:151]
    v_pk_mul_f32 v[242:243], v[214:215], v[150:151]
    v_pk_fma_f32 v[236:237], v[212:213], v[140:141], v[236:237] neg_lo:[0,0,1] neg_hi:[0,0,1]
    v_pk_fma_f32 v[240:241], v[216:217], v[140:141], v[240:241]
    v_pk_fma_f32 v[238:239], v[214:215], v[142:143], v[238:239] neg_lo:[0,0,1] neg_hi:[0,0,1]
    v_pk_fma_f32 v[242:243], v[218:219], v[142:143], v[242:243]
    v_cvt_pk_bf16_f32 v228, v240, v236
    v_cvt_pk_bf16_f32 v229, v241, v237
    v_cvt_pk_bf16_f32 v230, v242, v238
    v_cvt_pk_bf16_f32 v231, v243, v239
    ds_write_b128 v7, v[228:231] offset:2048
    v_pk_mul_f32 v[236:237], v[224:225], v[152:153]
    v_pk_mul_f32 v[240:241], v[220:221], v[152:153]
    v_pk_mul_f32 v[238:239], v[226:227], v[154:155]
    v_pk_mul_f32 v[242:243], v[222:223], v[154:155]
    v_pk_fma_f32 v[236:237], v[220:221], v[144:145], v[236:237] neg_lo:[0,0,1] neg_hi:[0,0,1]
    v_pk_fma_f32 v[240:241], v[224:225], v[144:145], v[240:241]
    v_pk_fma_f32 v[238:239], v[222:223], v[146:147], v[238:239] neg_lo:[0,0,1] neg_hi:[0,0,1]
    v_pk_fma_f32 v[242:243], v[226:227], v[146:147], v[242:243]
    v_cvt_pk_bf16_f32 v232, v240, v236
    v_cvt_pk_bf16_f32 v233, v241, v237
    v_cvt_pk_bf16_f32 v234, v242, v238
    v_cvt_pk_bf16_f32 v235, v243, v239
    ds_write_b128 v7, v[232:235] offset:3072
    s_add_u32 s19, s34, 0x600000
    buffer_load_dwordx4 a[132:135], v1, s[4:7], s20 offen offset:1024 sc1
    s_xor_b32 s20, s20, 0x800
    buffer_load_dwordx4 a[136:139], v1, s[4:7], s20 offen offset:0 sc1
    s_waitcnt lgkmcnt(0)
    s_barrier
    ds_read_b128 v[188:191], v8 offset:2048
    ds_read_b128 v[196:199], v8 offset:26624
    ds_read_b128 v[192:195], v8 offset:14336
    ds_read_b128 v[200:203], v8 offset:38912
    s_waitcnt lgkmcnt(3)
    v_mfma_f32_16x16x32_bf16 v[176:179], v[60:63], v[188:191], v[176:179]
    s_waitcnt lgkmcnt(2)
    v_mfma_f32_16x16x32_bf16 v[176:179], v[76:79], v[196:199], v[176:179]
    v_mfma_f32_16x16x32_bf16 v[172:175], v[64:67], v[188:191], v[172:175]
    v_mfma_f32_16x16x32_bf16 v[172:175], v[80:83], v[196:199], v[172:175]
    s_waitcnt lgkmcnt(1)
    v_mfma_f32_16x16x32_bf16 v[184:187], v[68:71], v[192:195], v[184:187]
    s_waitcnt lgkmcnt(0)
    v_mfma_f32_16x16x32_bf16 v[184:187], v[84:87], v[200:203], v[184:187]
    v_mfma_f32_16x16x32_bf16 v[180:183], v[72:75], v[192:195], v[180:183]
    v_mfma_f32_16x16x32_bf16 v[180:183], v[88:91], v[200:203], v[180:183]
    s_cmp_lg_u32 s2, 0
    s_nop 6
    v_pk_add_f32 v[236:237], v[172:173], v[180:181]
    v_pk_add_f32 v[238:239], v[174:175], v[182:183]
    v_pk_add_f32 v[240:241], v[176:177], v[184:185]
    v_pk_add_f32 v[242:243], v[178:179], v[186:187]
    v_cvt_pk_bf16_f32 v228, v236, v240
    v_cvt_pk_bf16_f32 v229, v237, v241
    v_cvt_pk_bf16_f32 v230, v238, v242
    v_cvt_pk_bf16_f32 v231, v239, v243
    s_cbranch_scc1 COL_B10
    s_mov_b32 s25, 0xffff
    v_bfi_b32 v228, s25, v228, v20
    v_bfi_b32 v229, s25, v229, v21
    v_bfi_b32 v230, s25, v230, v22
    v_bfi_b32 v231, s25, v231, v23
COL_B10:
    buffer_store_dwordx4 v[228:231], v6, s[4:7], s19 offen offset:0 sc1
    v_pk_add_f32 v[236:237], v[172:173], v[180:181] neg_lo:[0,1] neg_hi:[0,1]
    v_pk_add_f32 v[238:239], v[174:175], v[182:183] neg_lo:[0,1] neg_hi:[0,1]
    v_pk_add_f32 v[240:241], v[176:177], v[184:185] neg_lo:[0,1] neg_hi:[0,1]
    v_pk_add_f32 v[242:243], v[178:179], v[186:187] neg_lo:[0,1] neg_hi:[0,1]
    v_cvt_pk_bf16_f32 v232, v236, v240
    v_cvt_pk_bf16_f32 v233, v237, v241
    v_cvt_pk_bf16_f32 v234, v238, v242
    v_cvt_pk_bf16_f32 v235, v239, v243
    s_cbranch_scc1 COL_B11
    s_mov_b32 s25, 0xffff
    v_bfi_b32 v232, s25, v232, v24
    v_bfi_b32 v233, s25, v233, v25
    v_bfi_b32 v234, s25, v234, v26
    v_bfi_b32 v235, s25, v235, v27
COL_B11:
    buffer_store_dwordx4 v[232:235], v6, s[4:7], s19 offen offset:1024 sc1
    buffer_load_dwordx4 a[140:143], v1, s[4:7], s20 offen offset:1024 sc1
    v_mov_b32 v14, 0xbdd2d3e8
    v_mov_b32 v15, 0xc0135761
    v_lshrrev_b32 v16, 6, v0
    v_bfe_u32 v17, v0, 3, 2
    v_lshlrev_b32 v5, 19, v17
    v_bfe_u32 v17, v0, 5, 1
    v_lshl_add_u32 v5, v17, 17, v5
    v_and_b32_e64 v17, 7, v0
    v_lshl_add_u32 v5, v17, 4, v5
    v_lshl_add_u32 v5, v16, 7, v5
    v_add_u32 v6, 261120, v5
    v_lshrrev_b32 v17, 1, v1
    v_add_u32 v7, s16, v17
    s_add_u32 s20, s21, 36864
    buffer_load_dwordx4 a[144:147], v1, s[4:7], s20 offen offset:0 sc1
    v_and_b32 v17, 48, v0
    v_add_u32 v9, s16, v17
    v_add_u32 v10, 65536, v1
    v_bfe_u32 v17, v0, 4, 1
    v_mul_u32_u24 v8, 229376, v17
    v_bfe_u32 v17, v0, 5, 1
    v_lshl_add_u32 v8, v17, 8, v8
    v_and_b32_e64 v17, 15, v0
    v_lshl_add_u32 v8, v17, 4, v8
    v_mul_u32_u24 v11, 8192, v0
    s_lshl_b32 s17, s12, 9
    s_add_u32 s17, s17, 0x600000
    s_mov_b32 s35, 3
    buffer_load_dwordx4 a[148:151], v1, s[4:7], s20 offen offset:1024 sc1
    s_lshl_b32 s35, s35, 7
    s_add_u32 s35, s35, s17
    s_mul_i32 s22, s12, 458752
    s_add_u32 s22, s22, 0x1a00000
    s_mul_i32 s26, s3, 57344
    s_add_u32 s26, s26, s22
    s_lshr_b32 s25, s13, 2
    s_mul_i32 s25, s25, 14336
    s_add_u32 s26, s26, s25
    s_and_b32 s25, s13, 3
    s_lshl_b32 s25, s25, 9
    s_add_u32 s28, s26, s25
    s_add_u32 s27, s28, s25
    s_xor_b32 s20, s20, 0x800
    buffer_load_dwordx4 a[152:155], v1, s[4:7], s20 offen offset:0 sc1
    s_lshl_b32 s25, s25, 2
    s_add_u32 s26, s26, s25
    s_add_u32 s28, s28, 12288
    s_add_u32 s27, s27, 8192
    s_mul_i32 s25, s14, 229376
    s_add_u32 s22, s22, s25
    s_mul_i32 s25, s3, 14336
    s_add_u32 s22, s22, s25
    s_and_b32 s24, s3, 3
    s_xor_b32 s25, s24, 3
    s_mul_i32 s25, s25, 57344
    s_add_u32 s30, s22, s25
    s_xor_b32 s25, s24, 2
    buffer_load_dwordx4 a[156:159], v1, s[4:7], s20 offen offset:1024 sc1
    s_mul_i32 s25, s25, 57344
    s_add_u32 s31, s22, s25
    s_xor_b32 s25, s24, 1
    s_mul_i32 s25, s25, 57344
    s_add_u32 s32, s22, s25
    s_xor_b32 s25, s24, 0
    s_mul_i32 s25, s25, 57344
    s_add_u32 s33, s22, s25
    s_lshl_b32 s24, s12, 4
    s_add_u32 s23, s24, s13
    s_lshl_b32 s23, s23, 2
    s_add_u32 s23, s23, s3
    s_lshl_b32 s23, s23, 7
    s_add_u32 s20, s21, 40960
    buffer_load_dwordx4 a[160:163], v1, s[4:7], s20 offen offset:0 sc1
    s_add_u32 s23, s23, 0x1120000
    s_lshl_b32 s24, s24, 9
    s_lshl_b32 s25, s3, 11
    s_add_u32 s24, s24, s25
    s_add_u32 s24, s24, 0x1120000
    s_mov_b32 s8, 0x22222222
    s_mov_b32 s9, 0x22222222
    s_mov_b32 s10, 0x44444444
    s_mov_b32 s11, 0x44444444
    s_mov_b32 s36, 0x88888888
    s_mov_b32 s37, 0x88888888
    buffer_load_dword v2, v11, s[4:7], s35 offen sc1
    s_mul_i32 s29, s13, 448
    s_add_u32 s29, s29, 0xbc5000
    buffer_load_dwordx4 a[164:167], v1, s[4:7], s20 offen offset:1024 sc1
    s_xor_b32 s20, s20, 0x800
    buffer_load_dwordx4 a[168:171], v1, s[4:7], s20 offen offset:0 sc1
    buffer_load_dwordx4 a[172:175], v1, s[4:7], s20 offen offset:1024 sc1
    s_waitcnt vmcnt(3)
    v_cmp_eq_u32 vcc, -1, v2
    s_cbranch_vccz GO9
    s_mov_b32 s25, 0
POLL9:
    s_mov_b64 exec, vcc
    buffer_load_dword v2, v11, s[4:7], s35 offen sc1
    s_add_u32 s25, s25, 1
    s_waitcnt vmcnt(0)
    v_cmp_eq_u32 vcc, -1, v2
    s_cmp_lt_u32 s25, 0x8000
    s_cselect_b64 vcc, vcc, 0
    s_cbranch_vccnz POLL9
    s_mov_b64 exec, -1
GO9:
    s_barrier
    s_mov_b32 s35, 0
PASS_A1:
    s_add_u32 m0, s16, 0
    s_add_u32 s19, s17, 0
    buffer_load_dwordx4 v5, s[4:7], s19 offen offset:0 sc1 lds
    buffer_load_dwordx4 v6, s[4:7], s19 offen offset:1024 sc1 lds
    s_add_u32 m0, s16, 2048
    s_add_u32 s19, s17, 8192
    buffer_load_dwordx4 v5, s[4:7], s19 offen offset:0 sc1 lds
    buffer_load_dwordx4 v6, s[4:7], s19 offen offset:1024 sc1 lds
    s_add_u32 m0, s16, 4096
    s_add_u32 s19, s17, 16384
    buffer_load_dwordx4 v5, s[4:7], s19 offen offset:0 sc1 lds
    buffer_load_dwordx4 v6, s[4:7], s19 offen offset:1024 sc1 lds
    s_add_u32 m0, s16, 6144
    s_add_u32 s19, s17, 24576
    buffer_load_dwordx4 v5, s[4:7], s19 offen offset:0 sc1 lds
    buffer_load_dwordx4 v6, s[4:7], s19 offen offset:1024 sc1 lds
    s_add_u32 m0, s16, 8192
    s_add_u32 s19, s17, 32768
    buffer_load_dwordx4 v5, s[4:7], s19 offen offset:0 sc1 lds
    buffer_load_dwordx4 v6, s[4:7], s19 offen offset:1024 sc1 lds
    s_add_u32 m0, s16, 10240
    s_add_u32 s19, s17, 40960
    buffer_load_dwordx4 v5, s[4:7], s19 offen offset:0 sc1 lds
    buffer_load_dwordx4 v6, s[4:7], s19 offen offset:1024 sc1 lds
    ds_read_b128 v[224:227], v1 offset:0
    ds_read_b128 v[228:231], v1 offset:1024
    ds_read_b128 v[232:235], v1 offset:2048
    ds_read_b128 v[236:239], v1 offset:3072
    v_mov_b32 v20, 0xffff
    v_cmp_gt_u32 vcc, 256, v1
    s_nop 1
    v_cndmask_b32 v12, -1, v20, vcc
    v_and_b32 v18, 12, v0
    v_and_b32 v19, 15, v0
    v_lshlrev_b32 v11, 7, v19
    v_lshl_add_u32 v18, v18, 2, v19
    v_lshlrev_b32 v18, 2, v18
    v_mov_b32 v19, 0x2edbe6ff
    s_waitcnt vmcnt(10)
    ds_read_b64 v[32:33], v7 offset:0
    ds_read_b64 v[36:37], v7 offset:512
    ds_read_b64 v[34:35], v7 offset:1024
    ds_read_b64 v[38:39], v7 offset:1536
    s_waitcnt lgkmcnt(2)
    v_swap_b32 v33, v36
    s_waitcnt lgkmcnt(0)
    v_swap_b32 v35, v38
    s_nop 1
    v_mfma_f32_16x16x32_bf16 v[160:163], v[224:227], v[32:35], 0
    s_waitcnt vmcnt(8)
    ds_read_b64 v[40:41], v7 offset:2048
    ds_read_b64 v[44:45], v7 offset:2560
    v_mfma_f32_16x16x32_bf16 v[168:171], v[224:227], v[36:39], 0
    ds_read_b64 v[42:43], v7 offset:3072
    ds_read_b64 v[46:47], v7 offset:3584
    v_mfma_f32_16x16x32_bf16 v[164:167], v[228:231], v[32:35], 0
    ds_read_b128 v[240:243], v1 offset:4096
    v_and_b32 v24, v12, v32
    v_mov_b32 v25, v33
    v_mfma_f32_16x16x32_bf16 v[172:175], v[228:231], v[36:39], 0
    ds_read_b128 v[244:247], v1 offset:5120
    ds_read_b128 v[248:251], v1 offset:6144
    v_mfma_f32_16x16x32_bf16 v[176:179], v[232:235], v[32:35], 0
    s_add_u32 m0, s16, 0
    s_add_u32 s19, s17, 49152
    ds_read_b128 v[252:255], v1 offset:7168
    v_mov_b32 v26, v34
    v_mov_b32 v27, v35
    v_mfma_f32_16x16x32_bf16 v[184:187], v[232:235], v[36:39], 0
    buffer_load_dwordx4 v5, s[4:7], s19 offen offset:0 sc1 lds
    v_and_b32 v28, v12, v36
    v_mov_b32 v29, v37
    v_mfma_f32_16x16x32_bf16 v[180:183], v[236:239], v[32:35], 0
    s_waitcnt lgkmcnt(4)
    v_swap_b32 v41, v44
    v_mov_b32 v30, v38
    v_mov_b32 v31, v39
    v_mfma_f32_16x16x32_bf16 v[188:191], v[236:239], v[36:39], 0
    v_swap_b32 v43, v46
    v_mfma_f32_16x16x32_bf16 v[216:219], v[24:27], v[32:35], 0
    v_mfma_f32_16x16x32_bf16 v[220:223], v[28:31], v[36:39], 0
    buffer_load_dwordx4 v6, s[4:7], s19 offen offset:1024 sc1 lds
    v_mfma_f32_16x16x32_bf16 v[216:219], v[40:43], v[40:43], v[216:219]
    s_waitcnt vmcnt(8)
    ds_read_b64 v[48:49], v7 offset:4096
    ds_read_b64 v[52:53], v7 offset:4608
    v_mfma_f32_16x16x32_bf16 v[220:223], v[44:47], v[44:47], v[220:223]
    ds_read_b64 v[50:51], v7 offset:5120
    ds_read_b64 v[54:55], v7 offset:5632
    s_waitcnt lgkmcnt(4)
    v_mfma_f32_16x16x32_bf16 v[160:163], v[240:243], v[40:43], v[160:163]
    ds_read_b128 v[224:227], v1 offset:8192
    v_mfma_f32_16x16x32_bf16 v[168:171], v[240:243], v[44:47], v[168:171]
    ds_read_b128 v[228:231], v1 offset:9216
    ds_read_b128 v[232:235], v1 offset:10240
    v_mfma_f32_16x16x32_bf16 v[164:167], v[244:247], v[40:43], v[164:167]
    s_add_u32 m0, s16, 2048
    s_add_u32 s19, s17, 57344
    ds_read_b128 v[236:239], v1 offset:11264
    v_mfma_f32_16x16x32_bf16 v[172:175], v[244:247], v[44:47], v[172:175]
    buffer_load_dwordx4 v5, s[4:7], s19 offen offset:0 sc1 lds
    v_mfma_f32_16x16x32_bf16 v[176:179], v[248:251], v[40:43], v[176:179]
    s_waitcnt lgkmcnt(4)
    v_swap_b32 v49, v52
    v_mfma_f32_16x16x32_bf16 v[184:187], v[248:251], v[44:47], v[184:187]
    v_swap_b32 v51, v54
    v_mfma_f32_16x16x32_bf16 v[180:183], v[252:255], v[40:43], v[180:183]
    v_mfma_f32_16x16x32_bf16 v[188:191], v[252:255], v[44:47], v[188:191]
    buffer_load_dwordx4 v6, s[4:7], s19 offen offset:1024 sc1 lds
    v_mfma_f32_16x16x32_bf16 v[216:219], v[48:51], v[48:51], v[216:219]
    s_waitcnt vmcnt(8)
    ds_read_b64 v[56:57], v7 offset:6144
    ds_read_b64 v[60:61], v7 offset:6656
    v_mfma_f32_16x16x32_bf16 v[220:223], v[52:55], v[52:55], v[220:223]
    ds_read_b64 v[58:59], v7 offset:7168
    ds_read_b64 v[62:63], v7 offset:7680
    s_waitcnt lgkmcnt(4)
    v_mfma_f32_16x16x32_bf16 v[160:163], v[224:227], v[48:51], v[160:163]
    ds_read_b128 v[240:243], v1 offset:12288
    v_mfma_f32_16x16x32_bf16 v[168:171], v[224:227], v[52:55], v[168:171]
    ds_read_b128 v[244:247], v1 offset:13312
    ds_read_b128 v[248:251], v1 offset:14336
    v_mfma_f32_16x16x32_bf16 v[164:167], v[228:231], v[48:51], v[164:167]
    s_add_u32 m0, s16, 4096
    s_add_u32 s19, s17, 65536
    ds_read_b128 v[252:255], v1 offset:15360
    v_mfma_f32_16x16x32_bf16 v[172:175], v[228:231], v[52:55], v[172:175]
    buffer_load_dwordx4 v5, s[4:7], s19 offen offset:0 sc1 lds
    v_mfma_f32_16x16x32_bf16 v[176:179], v[232:235], v[48:51], v[176:179]
    s_waitcnt lgkmcnt(4)
    v_swap_b32 v57, v60
    v_mfma_f32_16x16x32_bf16 v[184:187], v[232:235], v[52:55], v[184:187]
    v_swap_b32 v59, v62
    v_mfma_f32_16x16x32_bf16 v[180:183], v[236:239], v[48:51], v[180:183]
    v_mfma_f32_16x16x32_bf16 v[188:191], v[236:239], v[52:55], v[188:191]
    buffer_load_dwordx4 v6, s[4:7], s19 offen offset:1024 sc1 lds
    v_mfma_f32_16x16x32_bf16 v[216:219], v[56:59], v[56:59], v[216:219]
    s_waitcnt vmcnt(8)
    ds_read_b64 v[64:65], v7 offset:8192
    ds_read_b64 v[68:69], v7 offset:8704
    v_mfma_f32_16x16x32_bf16 v[220:223], v[60:63], v[60:63], v[220:223]
    ds_read_b64 v[66:67], v7 offset:9216
    ds_read_b64 v[70:71], v7 offset:9728
    s_waitcnt lgkmcnt(4)
    v_mfma_f32_16x16x32_bf16 v[160:163], v[240:243], v[56:59], v[160:163]
    ds_read_b128 v[224:227], v1 offset:16384
    v_mfma_f32_16x16x32_bf16 v[168:171], v[240:243], v[60:63], v[168:171]
    ds_read_b128 v[228:231], v1 offset:17408
    ds_read_b128 v[232:235], v1 offset:18432
    v_mfma_f32_16x16x32_bf16 v[164:167], v[244:247], v[56:59], v[164:167]
    s_add_u32 m0, s16, 6144
    s_add_u32 s19, s17, 73728
    ds_read_b128 v[236:239], v1 offset:19456
    v_mfma_f32_16x16x32_bf16 v[172:175], v[244:247], v[60:63], v[172:175]
    buffer_load_dwordx4 v5, s[4:7], s19 offen offset:0 sc1 lds
    v_mfma_f32_16x16x32_bf16 v[176:179], v[248:251], v[56:59], v[176:179]
    s_waitcnt lgkmcnt(4)
    v_swap_b32 v65, v68
    v_mfma_f32_16x16x32_bf16 v[184:187], v[248:251], v[60:63], v[184:187]
    v_swap_b32 v67, v70
    v_mfma_f32_16x16x32_bf16 v[180:183], v[252:255], v[56:59], v[180:183]
    v_mfma_f32_16x16x32_bf16 v[188:191], v[252:255], v[60:63], v[188:191]
    buffer_load_dwordx4 v6, s[4:7], s19 offen offset:1024 sc1 lds
    v_mfma_f32_16x16x32_bf16 v[216:219], v[64:67], v[64:67], v[216:219]
    s_waitcnt vmcnt(8)
    ds_read_b64 v[72:73], v7 offset:10240
    ds_read_b64 v[76:77], v7 offset:10752
    v_mfma_f32_16x16x32_bf16 v[220:223], v[68:71], v[68:71], v[220:223]
    ds_read_b64 v[74:75], v7 offset:11264
    ds_read_b64 v[78:79], v7 offset:11776
    s_waitcnt lgkmcnt(4)
    v_mfma_f32_16x16x32_bf16 v[160:163], v[224:227], v[64:67], v[160:163]
    ds_read_b128 v[240:243], v1 offset:20480
    v_mfma_f32_16x16x32_bf16 v[168:171], v[224:227], v[68:71], v[168:171]
    ds_read_b128 v[244:247], v1 offset:21504
    ds_read_b128 v[248:251], v1 offset:22528
    v_mfma_f32_16x16x32_bf16 v[164:167], v[228:231], v[64:67], v[164:167]
    s_add_u32 m0, s16, 8192
    s_add_u32 s19, s17, 81920
    ds_read_b128 v[252:255], v1 offset:23552
    v_mfma_f32_16x16x32_bf16 v[172:175], v[228:231], v[68:71], v[172:175]
    buffer_load_dwordx4 v5, s[4:7], s19 offen offset:0 sc1 lds
    v_mfma_f32_16x16x32_bf16 v[176:179], v[232:235], v[64:67], v[176:179]
    s_waitcnt lgkmcnt(4)
    v_swap_b32 v73, v76
    v_mfma_f32_16x16x32_bf16 v[184:187], v[232:235], v[68:71], v[184:187]
    v_swap_b32 v75, v78
    v_mfma_f32_16x16x32_bf16 v[180:183], v[236:239], v[64:67], v[180:183]
    v_mfma_f32_16x16x32_bf16 v[188:191], v[236:239], v[68:71], v[188:191]
    buffer_load_dwordx4 v6, s[4:7], s19 offen offset:1024 sc1 lds
    v_mfma_f32_16x16x32_bf16 v[216:219], v[72:75], v[72:75], v[216:219]
    s_waitcnt vmcnt(8)
    ds_read_b64 v[80:81], v7 offset:0
    ds_read_b64 v[84:85], v7 offset:512
    v_mfma_f32_16x16x32_bf16 v[220:223], v[76:79], v[76:79], v[220:223]
    ds_read_b64 v[82:83], v7 offset:1024
    ds_read_b64 v[86:87], v7 offset:1536
    s_waitcnt lgkmcnt(4)
    v_mfma_f32_16x16x32_bf16 v[160:163], v[240:243], v[72:75], v[160:163]
    ds_read_b128 v[224:227], v1 offset:24576
    v_mfma_f32_16x16x32_bf16 v[168:171], v[240:243], v[76:79], v[168:171]
    ds_read_b128 v[228:231], v1 offset:25600
    ds_read_b128 v[232:235], v1 offset:26624
    v_mfma_f32_16x16x32_bf16 v[164:167], v[244:247], v[72:75], v[164:167]
    s_add_u32 m0, s16, 10240
    s_add_u32 s19, s17, 90112
    ds_read_b128 v[236:239], v1 offset:27648
    v_mfma_f32_16x16x32_bf16 v[172:175], v[244:247], v[76:79], v[172:175]
    buffer_load_dwordx4 v5, s[4:7], s19 offen offset:0 sc1 lds
    v_mfma_f32_16x16x32_bf16 v[176:179], v[248:251], v[72:75], v[176:179]
    s_waitcnt lgkmcnt(4)
    v_swap_b32 v81, v84
    v_mfma_f32_16x16x32_bf16 v[184:187], v[248:251], v[76:79], v[184:187]
    v_swap_b32 v83, v86
    v_mfma_f32_16x16x32_bf16 v[180:183], v[252:255], v[72:75], v[180:183]
    v_mfma_f32_16x16x32_bf16 v[188:191], v[252:255], v[76:79], v[188:191]
    buffer_load_dwordx4 v6, s[4:7], s19 offen offset:1024 sc1 lds
    v_mfma_f32_16x16x32_bf16 v[216:219], v[80:83], v[80:83], v[216:219]
    s_waitcnt vmcnt(8)
    ds_read_b64 v[88:89], v7 offset:2048
    ds_read_b64 v[92:93], v7 offset:2560
    v_mfma_f32_16x16x32_bf16 v[220:223], v[84:87], v[84:87], v[220:223]
    ds_read_b64 v[90:91], v7 offset:3072
    ds_read_b64 v[94:95], v7 offset:3584
    s_waitcnt lgkmcnt(4)
    v_mfma_f32_16x16x32_bf16 v[160:163], v[224:227], v[80:83], v[160:163]
    ds_read_b128 v[240:243], v1 offset:28672
    v_mfma_f32_16x16x32_bf16 v[168:171], v[224:227], v[84:87], v[168:171]
    ds_read_b128 v[244:247], v1 offset:29696
    ds_read_b128 v[248:251], v1 offset:30720
    v_mfma_f32_16x16x32_bf16 v[164:167], v[228:231], v[80:83], v[164:167]
    s_add_u32 m0, s16, 0
    s_add_u32 s19, s17, 98304
    ds_read_b128 v[252:255], v1 offset:31744
    v_mfma_f32_16x16x32_bf16 v[172:175], v[228:231], v[84:87], v[172:175]
    buffer_load_dwordx4 v5, s[4:7], s19 offen offset:0 sc1 lds
    v_mfma_f32_16x16x32_bf16 v[176:179], v[232:235], v[80:83], v[176:179]
    s_waitcnt lgkmcnt(4)
    v_swap_b32 v89, v92
    v_mfma_f32_16x16x32_bf16 v[184:187], v[232:235], v[84:87], v[184:187]
    v_swap_b32 v91, v94
    v_mfma_f32_16x16x32_bf16 v[180:183], v[236:239], v[80:83], v[180:183]
    v_mfma_f32_16x16x32_bf16 v[188:191], v[236:239], v[84:87], v[188:191]
    buffer_load_dwordx4 v6, s[4:7], s19 offen offset:1024 sc1 lds
    v_mfma_f32_16x16x32_bf16 v[216:219], v[88:91], v[88:91], v[216:219]
    s_waitcnt vmcnt(8)
    ds_read_b64 v[96:97], v7 offset:4096
    ds_read_b64 v[100:101], v7 offset:4608
    v_mfma_f32_16x16x32_bf16 v[220:223], v[92:95], v[92:95], v[220:223]
    ds_read_b64 v[98:99], v7 offset:5120
    ds_read_b64 v[102:103], v7 offset:5632
    s_waitcnt lgkmcnt(4)
    v_mfma_f32_16x16x32_bf16 v[160:163], v[240:243], v[88:91], v[160:163]
    ds_read_b128 v[224:227], v1 offset:32768
    v_mfma_f32_16x16x32_bf16 v[168:171], v[240:243], v[92:95], v[168:171]
    ds_read_b128 v[228:231], v1 offset:33792
    ds_read_b128 v[232:235], v1 offset:34816
    v_mfma_f32_16x16x32_bf16 v[164:167], v[244:247], v[88:91], v[164:167]
    s_add_u32 m0, s16, 2048
    s_add_u32 s19, s17, 106496
    ds_read_b128 v[236:239], v1 offset:35840
    v_mfma_f32_16x16x32_bf16 v[172:175], v[244:247], v[92:95], v[172:175]
    buffer_load_dwordx4 v5, s[4:7], s19 offen offset:0 sc1 lds
    v_mfma_f32_16x16x32_bf16 v[176:179], v[248:251], v[88:91], v[176:179]
    s_waitcnt lgkmcnt(4)
    v_swap_b32 v97, v100
    v_mfma_f32_16x16x32_bf16 v[184:187], v[248:251], v[92:95], v[184:187]
    v_swap_b32 v99, v102
    v_mfma_f32_16x16x32_bf16 v[180:183], v[252:255], v[88:91], v[180:183]
    v_mfma_f32_16x16x32_bf16 v[188:191], v[252:255], v[92:95], v[188:191]
    buffer_load_dwordx4 v6, s[4:7], s19 offen offset:1024 sc1 lds
    v_mfma_f32_16x16x32_bf16 v[216:219], v[96:99], v[96:99], v[216:219]
    s_waitcnt vmcnt(8)
    ds_read_b64 v[104:105], v7 offset:6144
    ds_read_b64 v[108:109], v7 offset:6656
    v_mfma_f32_16x16x32_bf16 v[220:223], v[100:103], v[100:103], v[220:223]
    ds_read_b64 v[106:107], v7 offset:7168
    ds_read_b64 v[110:111], v7 offset:7680
    s_waitcnt lgkmcnt(4)
    v_mfma_f32_16x16x32_bf16 v[160:163], v[224:227], v[96:99], v[160:163]
    ds_read_b128 v[240:243], v1 offset:36864
    v_mfma_f32_16x16x32_bf16 v[168:171], v[224:227], v[100:103], v[168:171]
    ds_read_b128 v[244:247], v1 offset:37888
    ds_read_b128 v[248:251], v1 offset:38912
    v_mfma_f32_16x16x32_bf16 v[164:167], v[228:231], v[96:99], v[164:167]
    s_add_u32 m0, s16, 4096
    s_add_u32 s19, s17, 114688
    ds_read_b128 v[252:255], v1 offset:39936
    v_mfma_f32_16x16x32_bf16 v[172:175], v[228:231], v[100:103], v[172:175]
    buffer_load_dwordx4 v5, s[4:7], s19 offen offset:0 sc1 lds
    v_mfma_f32_16x16x32_bf16 v[176:179], v[232:235], v[96:99], v[176:179]
    s_waitcnt lgkmcnt(4)
    v_swap_b32 v105, v108
    v_mfma_f32_16x16x32_bf16 v[184:187], v[232:235], v[100:103], v[184:187]
    v_swap_b32 v107, v110
    v_mfma_f32_16x16x32_bf16 v[180:183], v[236:239], v[96:99], v[180:183]
    v_mfma_f32_16x16x32_bf16 v[188:191], v[236:239], v[100:103], v[188:191]
    buffer_load_dwordx4 v6, s[4:7], s19 offen offset:1024 sc1 lds
    v_mfma_f32_16x16x32_bf16 v[216:219], v[104:107], v[104:107], v[216:219]
    s_waitcnt vmcnt(8)
    ds_read_b64 v[112:113], v7 offset:8192
    ds_read_b64 v[116:117], v7 offset:8704
    v_mfma_f32_16x16x32_bf16 v[220:223], v[108:111], v[108:111], v[220:223]
    ds_read_b64 v[114:115], v7 offset:9216
    ds_read_b64 v[118:119], v7 offset:9728
    s_waitcnt lgkmcnt(4)
    v_mfma_f32_16x16x32_bf16 v[160:163], v[240:243], v[104:107], v[160:163]
    ds_read_b128 v[224:227], v1 offset:40960
    v_mfma_f32_16x16x32_bf16 v[168:171], v[240:243], v[108:111], v[168:171]
    ds_read_b128 v[228:231], v1 offset:41984
    ds_read_b128 v[232:235], v1 offset:43008
    v_mfma_f32_16x16x32_bf16 v[164:167], v[244:247], v[104:107], v[164:167]
    s_add_u32 m0, s16, 6144
    s_add_u32 s19, s17, 122880
    ds_read_b128 v[236:239], v1 offset:44032
    v_mfma_f32_16x16x32_bf16 v[172:175], v[244:247], v[108:111], v[172:175]
    buffer_load_dwordx4 v5, s[4:7], s19 offen offset:0 sc1 lds
    v_mfma_f32_16x16x32_bf16 v[176:179], v[248:251], v[104:107], v[176:179]
    s_waitcnt lgkmcnt(4)
    v_swap_b32 v113, v116
    v_mfma_f32_16x16x32_bf16 v[184:187], v[248:251], v[108:111], v[184:187]
    v_swap_b32 v115, v118
    v_mfma_f32_16x16x32_bf16 v[180:183], v[252:255], v[104:107], v[180:183]
    v_mfma_f32_16x16x32_bf16 v[188:191], v[252:255], v[108:111], v[188:191]
    buffer_load_dwordx4 v6, s[4:7], s19 offen offset:1024 sc1 lds
    v_mfma_f32_16x16x32_bf16 v[216:219], v[112:115], v[112:115], v[216:219]
    s_waitcnt vmcnt(8)
    ds_read_b64 v[120:121], v7 offset:10240
    ds_read_b64 v[124:125], v7 offset:10752
    v_mfma_f32_16x16x32_bf16 v[220:223], v[116:119], v[116:119], v[220:223]
    ds_read_b64 v[122:123], v7 offset:11264
    ds_read_b64 v[126:127], v7 offset:11776
    s_waitcnt lgkmcnt(4)
    v_mfma_f32_16x16x32_bf16 v[160:163], v[224:227], v[112:115], v[160:163]
    ds_read_b128 v[240:243], v1 offset:45056
    v_mfma_f32_16x16x32_bf16 v[168:171], v[224:227], v[116:119], v[168:171]
    ds_read_b128 v[244:247], v1 offset:46080
    ds_read_b128 v[248:251], v1 offset:47104
    v_mfma_f32_16x16x32_bf16 v[164:167], v[228:231], v[112:115], v[164:167]
    s_add_u32 m0, s16, 8192
    ds_read_b128 v[252:255], v1 offset:48128
    v_mfma_f32_16x16x32_bf16 v[172:175], v[228:231], v[116:119], v[172:175]
    buffer_load_dwordx4 v1, s[4:7], s29 offen offset:0 sc1 lds
    v_mfma_f32_16x16x32_bf16 v[176:179], v[232:235], v[112:115], v[176:179]
    s_waitcnt lgkmcnt(4)
    v_swap_b32 v121, v124
    v_mfma_f32_16x16x32_bf16 v[184:187], v[232:235], v[116:119], v[184:187]
    v_swap_b32 v123, v126
    v_mfma_f32_16x16x32_bf16 v[180:183], v[236:239], v[112:115], v[180:183]
    s_add_u32 s20, s21, 45056
    v_mfma_f32_16x16x32_bf16 v[188:191], v[236:239], v[116:119], v[188:191]
    buffer_load_dwordx4 a[176:179], v1, s[4:7], s20 offen offset:0 sc1
    v_mfma_f32_16x16x32_bf16 v[216:219], v[120:123], v[120:123], v[216:219]
    s_waitcnt vmcnt(8)
    ds_read_b64 v[128:129], v7 offset:0
    ds_read_b64 v[132:133], v7 offset:512
    v_mfma_f32_16x16x32_bf16 v[220:223], v[124:127], v[124:127], v[220:223]
    ds_read_b64 v[130:131], v7 offset:1024
    ds_read_b64 v[134:135], v7 offset:1536
    s_waitcnt lgkmcnt(4)
    v_mfma_f32_16x16x32_bf16 v[160:163], v[240:243], v[120:123], v[160:163]
    ds_read_b128 v[224:227], v1 offset:49152
    v_mfma_f32_16x16x32_bf16 v[168:171], v[240:243], v[124:127], v[168:171]
    ds_read_b128 v[228:231], v1 offset:50176
    ds_read_b128 v[232:235], v1 offset:51200
    v_mfma_f32_16x16x32_bf16 v[164:167], v[244:247], v[120:123], v[164:167]
    ds_read_b128 v[236:239], v1 offset:52224
    v_mfma_f32_16x16x32_bf16 v[172:175], v[244:247], v[124:127], v[172:175]
    buffer_load_dwordx4 a[180:183], v1, s[4:7], s20 offen offset:1024 sc1
    v_mfma_f32_16x16x32_bf16 v[176:179], v[248:251], v[120:123], v[176:179]
    s_waitcnt lgkmcnt(4)
    v_swap_b32 v129, v132
    v_mfma_f32_16x16x32_bf16 v[184:187], v[248:251], v[124:127], v[184:187]
    v_swap_b32 v131, v134
    v_mfma_f32_16x16x32_bf16 v[180:183], v[252:255], v[120:123], v[180:183]
    s_xor_b32 s20, s20, 0x800
    v_mfma_f32_16x16x32_bf16 v[188:191], v[252:255], v[124:127], v[188:191]
    buffer_load_dwordx4 a[184:187], v1, s[4:7], s20 offen offset:0 sc1
    v_mfma_f32_16x16x32_bf16 v[216:219], v[128:131], v[128:131], v[216:219]
    s_waitcnt vmcnt(8)
    ds_read_b64 v[136:137], v7 offset:2048
    ds_read_b64 v[140:141], v7 offset:2560
    v_mfma_f32_16x16x32_bf16 v[220:223], v[132:135], v[132:135], v[220:223]
    ds_read_b64 v[138:139], v7 offset:3072
    ds_read_b64 v[142:143], v7 offset:3584
    s_waitcnt lgkmcnt(4)
    v_mfma_f32_16x16x32_bf16 v[160:163], v[224:227], v[128:131], v[160:163]
    ds_read_b128 v[240:243], v1 offset:53248
    v_mfma_f32_16x16x32_bf16 v[168:171], v[224:227], v[132:135], v[168:171]
    ds_read_b128 v[244:247], v1 offset:54272
    ds_read_b128 v[248:251], v1 offset:55296
    v_mfma_f32_16x16x32_bf16 v[164:167], v[228:231], v[128:131], v[164:167]
    ds_read_b128 v[252:255], v1 offset:56320
    v_mfma_f32_16x16x32_bf16 v[172:175], v[228:231], v[132:135], v[172:175]
    buffer_load_dwordx4 a[188:191], v1, s[4:7], s20 offen offset:1024 sc1
    v_mfma_f32_16x16x32_bf16 v[176:179], v[232:235], v[128:131], v[176:179]
    s_waitcnt lgkmcnt(4)
    v_swap_b32 v137, v140
    v_mfma_f32_16x16x32_bf16 v[184:187], v[232:235], v[132:135], v[184:187]
    v_swap_b32 v139, v142
    v_mfma_f32_16x16x32_bf16 v[180:183], v[236:239], v[128:131], v[180:183]
    s_add_u32 s20, s21, 49152
    v_mfma_f32_16x16x32_bf16 v[188:191], v[236:239], v[132:135], v[188:191]
    buffer_load_dwordx4 a[192:195], v1, s[4:7], s20 offen offset:0 sc1
    v_mfma_f32_16x16x32_bf16 v[216:219], v[136:139], v[136:139], v[216:219]
    s_waitcnt vmcnt(8)
    ds_read_b64 v[144:145], v7 offset:4096
    ds_read_b64 v[148:149], v7 offset:4608
    v_mfma_f32_16x16x32_bf16 v[220:223], v[140:143], v[140:143], v[220:223]
    ds_read_b64 v[146:147], v7 offset:5120
    ds_read_b64 v[150:151], v7 offset:5632
    s_waitcnt lgkmcnt(4)
    v_mfma_f32_16x16x32_bf16 v[160:163], v[240:243], v[136:139], v[160:163]
    ds_read_b128 v[224:227], v1 offset:57344
    v_mfma_f32_16x16x32_bf16 v[168:171], v[240:243], v[140:143], v[168:171]
    ds_read_b128 v[228:231], v1 offset:58368
    ds_read_b128 v[232:235], v1 offset:59392
    v_mfma_f32_16x16x32_bf16 v[164:167], v[244:247], v[136:139], v[164:167]
    ds_read_b128 v[236:239], v1 offset:60416
    v_mfma_f32_16x16x32_bf16 v[172:175], v[244:247], v[140:143], v[172:175]
    buffer_load_dwordx4 a[196:199], v1, s[4:7], s20 offen offset:1024 sc1
    v_mfma_f32_16x16x32_bf16 v[176:179], v[248:251], v[136:139], v[176:179]
    s_waitcnt lgkmcnt(4)
    v_swap_b32 v145, v148
    v_mfma_f32_16x16x32_bf16 v[184:187], v[248:251], v[140:143], v[184:187]
    v_swap_b32 v147, v150
    v_mfma_f32_16x16x32_bf16 v[180:183], v[252:255], v[136:139], v[180:183]
    s_xor_b32 s20, s20, 0x800
    v_mfma_f32_16x16x32_bf16 v[188:191], v[252:255], v[140:143], v[188:191]
    buffer_load_dwordx4 a[200:203], v1, s[4:7], s20 offen offset:0 sc1
    v_mfma_f32_16x16x32_bf16 v[216:219], v[144:147], v[144:147], v[216:219]
    s_waitcnt vmcnt(8)
    ds_read_b64 v[152:153], v7 offset:6144
    ds_read_b64 v[156:157], v7 offset:6656
    v_mfma_f32_16x16x32_bf16 v[220:223], v[148:151], v[148:151], v[220:223]
    ds_read_b64 v[154:155], v7 offset:7168
    ds_read_b64 v[158:159], v7 offset:7680
    s_waitcnt lgkmcnt(4)
    v_mfma_f32_16x16x32_bf16 v[160:163], v[224:227], v[144:147], v[160:163]
    ds_read_b128 v[240:243], v1 offset:61440
    v_mfma_f32_16x16x32_bf16 v[168:171], v[224:227], v[148:151], v[168:171]
    ds_read_b128 v[244:247], v1 offset:62464
    ds_read_b128 v[248:251], v1 offset:63488
    v_mfma_f32_16x16x32_bf16 v[164:167], v[228:231], v[144:147], v[164:167]
    ds_read_b128 v[252:255], v1 offset:64512
    v_mfma_f32_16x16x32_bf16 v[172:175], v[228:231], v[148:151], v[172:175]
    buffer_load_dwordx4 a[204:207], v1, s[4:7], s20 offen offset:1024 sc1
    v_mfma_f32_16x16x32_bf16 v[176:179], v[232:235], v[144:147], v[176:179]
    s_waitcnt lgkmcnt(4)
    v_swap_b32 v153, v156
    v_mfma_f32_16x16x32_bf16 v[184:187], v[232:235], v[148:151], v[184:187]
    v_swap_b32 v155, v158
    v_mfma_f32_16x16x32_bf16 v[180:183], v[236:239], v[144:147], v[180:183]
    s_add_u32 s20, s21, 53248
    v_mfma_f32_16x16x32_bf16 v[188:191], v[236:239], v[148:151], v[188:191]
    buffer_load_dwordx4 a[208:211], v1, s[4:7], s20 offen offset:0 sc1
    s_waitcnt vmcnt(9)
    v_mfma_f32_16x16x32_bf16 v[216:219], v[152:155], v[152:155], v[216:219]
    ds_read_b128 v[224:227], v9 offset:8192
    ds_read_b128 v[228:231], v9 offset:8256
    v_mfma_f32_16x16x32_bf16 v[220:223], v[156:159], v[156:159], v[220:223]
    ds_read_b128 v[232:235], v9 offset:8320
    ds_read_b128 v[236:239], v9 offset:8384
    s_waitcnt lgkmcnt(7)
    v_mfma_f32_16x16x32_bf16 v[160:163], v[240:243], v[152:155], v[160:163]
    v_mfma_f32_16x16x32_bf16 v[168:171], v[240:243], v[156:159], v[168:171]
    s_waitcnt lgkmcnt(6)
    v_mfma_f32_16x16x32_bf16 v[164:167], v[244:247], v[152:155], v[164:167]
    v_cndmask_b32 v16, v216, v217, s[8:9]
    v_cndmask_b32 v16, v16, v218, s[10:11]
    v_cndmask_b32 v16, v16, v219, s[36:37]
    ds_bpermute_b32 v12, v18, v16
    v_mfma_f32_16x16x32_bf16 v[172:175], v[244:247], v[156:159], v[172:175]
    s_waitcnt lgkmcnt(6)
    v_mfma_f32_16x16x32_bf16 v[176:179], v[248:251], v[152:155], v[176:179]
    v_cndmask_b32 v17, v220, v221, s[8:9]
    v_cndmask_b32 v17, v17, v222, s[10:11]
    v_cndmask_b32 v17, v17, v223, s[36:37]
    ds_bpermute_b32 v13, v18, v17
    v_mfma_f32_16x16x32_bf16 v[184:187], v[248:251], v[156:159], v[184:187]
    s_waitcnt lgkmcnt(6)
    v_mfma_f32_16x16x32_bf16 v[180:183], v[252:255], v[152:155], v[180:183]
    v_mfma_f32_16x16x32_bf16 v[188:191], v[252:255], v[156:159], v[188:191]
    s_waitcnt lgkmcnt(0)
    v_cmp_u_f32 vcc, v12, v13
    s_cbranch_vccz A_OK1
    s_add_u32 s35, s35, 1
    s_waitcnt vmcnt(0) lgkmcnt(0)
    s_nop 7
    s_cmp_lt_u32 s35, 64
    s_cbranch_scc1 PASS_A1
A_OK1:
    ds_read_b128 v[240:243], v10 offset:0
    ds_read_b128 v[244:247], v10 offset:1024
    ds_read_b128 v[248:251], v10 offset:2048
    ds_read_b128 v[252:255], v10 offset:3072
    v_fmamk_f32 v12, v12, 0x3b000054, v19
    v_fmamk_f32 v13, v13, 0x3b000054, v19
    v_rsq_f32 v12, v12
    v_rsq_f32_e64 v13, v13
    s_nop 0
    v_pk_fma_f32 v[160:161], v[160:161], v[12:13], v[224:225] op_sel:[0,0,0] op_sel_hi:[1,0,1]
    v_pk_fma_f32 v[162:163], v[162:163], v[12:13], v[226:227] op_sel:[0,0,0] op_sel_hi:[1,0,1]
    v_pk_fma_f32 v[164:165], v[164:165], v[12:13], v[228:229] op_sel:[0,0,0] op_sel_hi:[1,0,1]
    v_pk_fma_f32 v[166:167], v[166:167], v[12:13], v[230:231] op_sel:[0,0,0] op_sel_hi:[1,0,1]
    v_pk_mul_f32 v[16:17], v[160:161], v[160:161]
    v_pk_mul_f32 v[18:19], v[162:163], v[162:163]
    v_pk_mul_f32 v[20:21], v[164:165], v[164:165]
    v_pk_mul_f32 v[22:23], v[166:167], v[166:167]
    v_pk_fma_f32 v[16:17], v[16:17], v[14:15], v[14:15] op_sel:[0,0,1] op_sel_hi:[1,0,1]
    v_pk_fma_f32 v[18:19], v[18:19], v[14:15], v[14:15] op_sel:[0,0,1] op_sel_hi:[1,0,1]
    v_pk_fma_f32 v[20:21], v[20:21], v[14:15], v[14:15] op_sel:[0,0,1] op_sel_hi:[1,0,1]
    v_pk_fma_f32 v[22:23], v[22:23], v[14:15], v[14:15] op_sel:[0,0,1] op_sel_hi:[1,0,1]
    v_pk_mul_f32 v[16:17], v[160:161], v[16:17]
    v_pk_mul_f32 v[18:19], v[162:163], v[18:19]
    v_pk_mul_f32 v[20:21], v[164:165], v[20:21]
    v_pk_mul_f32 v[22:23], v[166:167], v[22:23]
    v_exp_f32 v16, v16
    v_exp_f32 v17, v17
    v_exp_f32 v18, v18
    v_exp_f32 v19, v19
    v_exp_f32 v20, v20
    v_exp_f32 v21, v21
    v_exp_f32 v22, v22
    v_exp_f32 v23, v23
    v_pk_add_f32 v[16:17], v[16:17], 1.0 op_sel_hi:[1,0]
    v_pk_add_f32 v[18:19], v[18:19], 1.0 op_sel_hi:[1,0]
    v_pk_add_f32 v[20:21], v[20:21], 1.0 op_sel_hi:[1,0]
    v_pk_add_f32 v[22:23], v[22:23], 1.0 op_sel_hi:[1,0]
    v_rcp_f32 v16, v16
    v_rcp_f32 v17, v17
    v_rcp_f32 v18, v18
    v_rcp_f32 v19, v19
    v_rcp_f32 v20, v20
    v_rcp_f32 v21, v21
    v_rcp_f32 v22, v22
    v_rcp_f32 v23, v23
    v_pk_mul_f32 v[16:17], v[160:161], v[16:17]
    v_pk_mul_f32 v[18:19], v[162:163], v[18:19]
    v_pk_mul_f32 v[20:21], v[164:165], v[20:21]
    v_pk_mul_f32 v[22:23], v[166:167], v[22:23]
    v_cvt_pk_bf16_f32 v24, v16, v17
    v_cvt_pk_bf16_f32 v26, v20, v21
    v_cvt_pk_bf16_f32 v25, v18, v19
    v_cvt_pk_bf16_f32 v27, v22, v23
    buffer_store_dwordx4 v[24:27], v1, s[4:7], s26 offen offset:0 sc1
    v_pk_fma_f32 v[176:177], v[176:177], v[12:13], v[232:233] op_sel:[0,0,0] op_sel_hi:[1,0,1]
    v_pk_fma_f32 v[178:179], v[178:179], v[12:13], v[234:235] op_sel:[0,0,0] op_sel_hi:[1,0,1]
    v_pk_fma_f32 v[180:181], v[180:181], v[12:13], v[236:237] op_sel:[0,0,0] op_sel_hi:[1,0,1]
    v_pk_fma_f32 v[182:183], v[182:183], v[12:13], v[238:239] op_sel:[0,0,0] op_sel_hi:[1,0,1]
    v_pk_mul_f32 v[16:17], v[176:177], v[176:177]
    v_pk_mul_f32 v[18:19], v[178:179], v[178:179]
    v_pk_mul_f32 v[20:21], v[180:181], v[180:181]
    v_pk_mul_f32 v[22:23], v[182:183], v[182:183]
    v_pk_fma_f32 v[16:17], v[16:17], v[14:15], v[14:15] op_sel:[0,0,1] op_sel_hi:[1,0,1]
    v_pk_fma_f32 v[18:19], v[18:19], v[14:15], v[14:15] op_sel:[0,0,1] op_sel_hi:[1,0,1]
    v_pk_fma_f32 v[20:21], v[20:21], v[14:15], v[14:15] op_sel:[0,0,1] op_sel_hi:[1,0,1]
    v_pk_fma_f32 v[22:23], v[22:23], v[14:15], v[14:15] op_sel:[0,0,1] op_sel_hi:[1,0,1]
    v_pk_mul_f32 v[16:17], v[176:177], v[16:17]
    v_pk_mul_f32 v[18:19], v[178:179], v[18:19]
    v_pk_mul_f32 v[20:21], v[180:181], v[20:21]
    v_pk_mul_f32 v[22:23], v[182:183], v[22:23]
    v_exp_f32 v16, v16
    v_exp_f32 v17, v17
    v_exp_f32 v18, v18
    v_exp_f32 v19, v19
    v_exp_f32 v20, v20
    v_exp_f32 v21, v21
    v_exp_f32 v22, v22
    v_exp_f32 v23, v23
    v_pk_add_f32 v[16:17], v[16:17], 1.0 op_sel_hi:[1,0]
    v_pk_add_f32 v[18:19], v[18:19], 1.0 op_sel_hi:[1,0]
    v_pk_add_f32 v[20:21], v[20:21], 1.0 op_sel_hi:[1,0]
    v_pk_add_f32 v[22:23], v[22:23], 1.0 op_sel_hi:[1,0]
    v_rcp_f32 v16, v16
    v_rcp_f32 v17, v17
    v_rcp_f32 v18, v18
    v_rcp_f32 v19, v19
    v_rcp_f32 v20, v20
    v_rcp_f32 v21, v21
    v_rcp_f32 v22, v22
    v_rcp_f32 v23, v23
    v_pk_mul_f32 v[16:17], v[176:177], v[16:17]
    v_pk_mul_f32 v[18:19], v[178:179], v[18:19]
    v_pk_mul_f32 v[20:21], v[180:181], v[20:21]
    v_pk_mul_f32 v[22:23], v[182:183], v[22:23]
    v_cvt_pk_bf16_f32 v28, v16, v17
    v_cvt_pk_bf16_f32 v30, v20, v21
    v_cvt_pk_bf16_f32 v29, v18, v19
    v_cvt_pk_bf16_f32 v31, v22, v23
    buffer_store_dwordx4 v[28:31], v1, s[4:7], s26 offen offset:1024 sc1
    s_add_u32 s26, s26, 229376
    s_barrier
    v_pk_fma_f32 v[168:169], v[168:169], v[12:13], v[224:225] op_sel:[0,1,0] op_sel_hi:[1,1,1]
    v_pk_fma_f32 v[170:171], v[170:171], v[12:13], v[226:227] op_sel:[0,1,0] op_sel_hi:[1,1,1]
    v_pk_fma_f32 v[172:173], v[172:173], v[12:13], v[228:229] op_sel:[0,1,0] op_sel_hi:[1,1,1]
    v_pk_fma_f32 v[174:175], v[174:175], v[12:13], v[230:231] op_sel:[0,1,0] op_sel_hi:[1,1,1]
    v_pk_mul_f32 v[16:17], v[168:169], v[168:169]
    v_pk_mul_f32 v[18:19], v[170:171], v[170:171]
    v_pk_mul_f32 v[20:21], v[172:173], v[172:173]
    v_pk_mul_f32 v[22:23], v[174:175], v[174:175]
    v_pk_fma_f32 v[16:17], v[16:17], v[14:15], v[14:15] op_sel:[0,0,1] op_sel_hi:[1,0,1]
    v_pk_fma_f32 v[18:19], v[18:19], v[14:15], v[14:15] op_sel:[0,0,1] op_sel_hi:[1,0,1]
    v_pk_fma_f32 v[20:21], v[20:21], v[14:15], v[14:15] op_sel:[0,0,1] op_sel_hi:[1,0,1]
    v_pk_fma_f32 v[22:23], v[22:23], v[14:15], v[14:15] op_sel:[0,0,1] op_sel_hi:[1,0,1]
    v_pk_mul_f32 v[16:17], v[168:169], v[16:17]
    v_pk_mul_f32 v[18:19], v[170:171], v[18:19]
    v_pk_mul_f32 v[20:21], v[172:173], v[20:21]
    v_pk_mul_f32 v[22:23], v[174:175], v[22:23]
    v_exp_f32 v16, v16
    v_exp_f32 v17, v17
    v_exp_f32 v18, v18
    v_exp_f32 v19, v19
    v_exp_f32 v20, v20
    v_exp_f32 v21, v21
    v_exp_f32 v22, v22
    v_exp_f32_e64 v23, v23
    v_pk_add_f32 v[16:17], v[16:17], 1.0 op_sel_hi:[1,0]
    v_pk_add_f32 v[18:19], v[18:19], 1.0 op_sel_hi:[1,0]
    v_pk_add_f32 v[20:21], v[20:21], 1.0 op_sel_hi:[1,0]
    v_pk_add_f32 v[22:23], v[22:23], 1.0 op_sel_hi:[1,0]
    v_rcp_f32 v16, v16
    v_rcp_f32 v17, v17
    v_rcp_f32 v18, v18
    v_rcp_f32 v19, v19
    v_rcp_f32 v20, v20
    v_rcp_f32 v21, v21
    v_rcp_f32 v22, v22
    v_rcp_f32 v23, v23
    v_pk_mul_f32 v[16:17], v[168:169], v[16:17]
    v_pk_mul_f32 v[18:19], v[170:171], v[18:19]
    v_pk_mul_f32 v[20:21], v[172:173], v[20:21]
    v_pk_mul_f32 v[22:23], v[174:175], v[22:23]
    v_cvt_pk_bf16_f32 v24, v16, v17
    v_cvt_pk_bf16_f32 v26, v20, v21
    v_cvt_pk_bf16_f32 v25, v18, v19
    v_cvt_pk_bf16_f32 v27, v22, v23
    buffer_store_dwordx4 v[24:27], v1, s[4:7], s26 offen offset:0 sc1
    v_pk_fma_f32 v[184:185], v[184:185], v[12:13], v[232:233] op_sel:[0,1,0] op_sel_hi:[1,1,1]
    v_pk_fma_f32 v[186:187], v[186:187], v[12:13], v[234:235] op_sel:[0,1,0] op_sel_hi:[1,1,1]
    v_pk_fma_f32 v[188:189], v[188:189], v[12:13], v[236:237] op_sel:[0,1,0] op_sel_hi:[1,1,1]
    v_pk_fma_f32 v[190:191], v[190:191], v[12:13], v[238:239] op_sel:[0,1,0] op_sel_hi:[1,1,1]
    v_pk_mul_f32 v[16:17], v[184:185], v[184:185]
    v_pk_mul_f32 v[18:19], v[186:187], v[186:187]
    v_pk_mul_f32 v[20:21], v[188:189], v[188:189]
    v_pk_mul_f32 v[22:23], v[190:191], v[190:191]
    v_pk_fma_f32 v[16:17], v[16:17], v[14:15], v[14:15] op_sel:[0,0,1] op_sel_hi:[1,0,1]
    v_pk_fma_f32 v[18:19], v[18:19], v[14:15], v[14:15] op_sel:[0,0,1] op_sel_hi:[1,0,1]
    v_pk_fma_f32 v[20:21], v[20:21], v[14:15], v[14:15] op_sel:[0,0,1] op_sel_hi:[1,0,1]
    v_pk_fma_f32 v[22:23], v[22:23], v[14:15], v[14:15] op_sel:[0,0,1] op_sel_hi:[1,0,1]
    v_pk_mul_f32 v[16:17], v[184:185], v[16:17]
    v_pk_mul_f32 v[18:19], v[186:187], v[18:19]
    v_pk_mul_f32 v[20:21], v[188:189], v[20:21]
    v_pk_mul_f32 v[22:23], v[190:191], v[22:23]
    v_exp_f32 v16, v16
    v_exp_f32 v17, v17
    v_exp_f32 v18, v18
    v_exp_f32 v19, v19
    v_exp_f32 v20, v20
    v_exp_f32 v21, v21
    v_exp_f32 v22, v22
    v_exp_f32 v23, v23
    v_pk_add_f32 v[16:17], v[16:17], 1.0 op_sel_hi:[1,0]
    v_pk_add_f32 v[18:19], v[18:19], 1.0 op_sel_hi:[1,0]
    v_pk_add_f32 v[20:21], v[20:21], 1.0 op_sel_hi:[1,0]
    v_pk_add_f32 v[22:23], v[22:23], 1.0 op_sel_hi:[1,0]
    v_rcp_f32 v16, v16
    v_rcp_f32 v17, v17
    v_rcp_f32 v18, v18
    v_rcp_f32 v19, v19
    v_rcp_f32 v20, v20
    v_rcp_f32 v21, v21
    v_rcp_f32 v22, v22
    v_rcp_f32 v23, v23
    v_pk_mul_f32 v[16:17], v[184:185], v[16:17]
    v_pk_mul_f32 v[18:19], v[186:187], v[18:19]
    v_pk_mul_f32 v[20:21], v[188:189], v[20:21]
    v_pk_mul_f32 v[22:23], v[190:191], v[22:23]
    v_cvt_pk_bf16_f32 v28, v16, v17
    v_cvt_pk_bf16_f32 v30, v20, v21
    v_cvt_pk_bf16_f32 v29, v18, v19
    v_cvt_pk_bf16_f32 v31, v22, v23
    buffer_store_dwordx4 v[28:31], v1, s[4:7], s26 offen offset:1024 sc1
    s_lshl_b32 s35, s3, 14
    s_and_b32 s17, s15, 3
    s_lshl_b32 s17, s17, 16
    s_add_u32 s17, s17, s35
    s_add_u32 s17, s17, 0xf80000
    ds_read_b128 v[224:227], v10 offset:4096
    ds_read_b128 v[228:231], v10 offset:5120
    ds_read_b128 v[232:235], v10 offset:6144
    s_waitcnt lgkmcnt(6)
    v_mfma_f32_16x16x32_bf16 v[192:195], v[240:243], v[32:35], 0
    ds_read_b128 v[236:239], v10 offset:7168
    v_mfma_f32_16x16x32_bf16 v[200:203], v[240:243], v[36:39], 0
    s_waitcnt lgkmcnt(6)
    v_mfma_f32_16x16x32_bf16 v[196:199], v[244:247], v[32:35], 0
    ds_read_b128 v[240:243], v10 offset:8192
    s_add_u32 m0, s35, 0
    s_add_u32 s19, s17, 0
    v_mfma_f32_16x16x32_bf16 v[204:207], v[244:247], v[36:39], 0
    buffer_load_dwordx4 v1, s[4:7], s19 offen offset:0 sc1 lds
    s_waitcnt lgkmcnt(6)
    v_mfma_f32_16x16x32_bf16 v[208:211], v[248:251], v[32:35], 0
    ds_read_b128 v[244:247], v10 offset:9216
    v_mfma_f32_16x16x32_bf16 v[212:215], v[248:251], v[36:39], 0
    s_waitcnt lgkmcnt(6)
    v_mfma_f32_16x16x32_bf16 v[192:195], v[252:255], v[40:43], v[192:195]
    ds_read_b128 v[248:251], v10 offset:10240
    v_mfma_f32_16x16x32_bf16 v[200:203], v[252:255], v[44:47], v[200:203]
    buffer_load_dwordx4 v1, s[4:7], s19 offen offset:1024 sc1 lds
    s_waitcnt lgkmcnt(6)
    v_mfma_f32_16x16x32_bf16 v[196:199], v[224:227], v[40:43], v[196:199]
    ds_read_b128 v[252:255], v10 offset:11264
    v_mfma_f32_16x16x32_bf16 v[204:207], v[224:227], v[44:47], v[204:207]
    s_waitcnt lgkmcnt(6)
    v_mfma_f32_16x16x32_bf16 v[208:211], v[228:231], v[40:43], v[208:211]
    ds_read_b128 v[224:227], v10 offset:12288
    v_mfma_f32_16x16x32_bf16 v[212:215], v[228:231], v[44:47], v[212:215]
    buffer_load_dwordx4 v1, s[4:7], s19 offen offset:2048 sc1 lds
    s_waitcnt lgkmcnt(6)
    v_mfma_f32_16x16x32_bf16 v[192:195], v[232:235], v[48:51], v[192:195]
    ds_read_b128 v[228:231], v10 offset:13312
    v_mfma_f32_16x16x32_bf16 v[200:203], v[232:235], v[52:55], v[200:203]
    s_waitcnt lgkmcnt(6)
    v_mfma_f32_16x16x32_bf16 v[196:199], v[236:239], v[48:51], v[196:199]
    ds_read_b128 v[232:235], v10 offset:14336
    v_mfma_f32_16x16x32_bf16 v[204:207], v[236:239], v[52:55], v[204:207]
    buffer_load_dwordx4 v1, s[4:7], s19 offen offset:3072 sc1 lds
    s_waitcnt lgkmcnt(6)
    v_mfma_f32_16x16x32_bf16 v[208:211], v[240:243], v[48:51], v[208:211]
    ds_read_b128 v[236:239], v10 offset:15360
    v_mfma_f32_16x16x32_bf16 v[212:215], v[240:243], v[52:55], v[212:215]
    s_waitcnt lgkmcnt(6)
    v_mfma_f32_16x16x32_bf16 v[192:195], v[244:247], v[56:59], v[192:195]
    ds_read_b128 v[240:243], v10 offset:16384
    s_add_u32 m0, s35, 4096
    s_add_u32 s19, s17, 4096
    v_mfma_f32_16x16x32_bf16 v[200:203], v[244:247], v[60:63], v[200:203]
    buffer_load_dwordx4 v1, s[4:7], s19 offen offset:0 sc1 lds
    s_waitcnt lgkmcnt(6)
    v_mfma_f32_16x16x32_bf16 v[196:199], v[248:251], v[56:59], v[196:199]
    ds_read_b128 v[244:247], v10 offset:17408
    v_mfma_f32_16x16x32_bf16 v[204:207], v[248:251], v[60:63], v[204:207]
    s_waitcnt lgkmcnt(6)
    v_mfma_f32_16x16x32_bf16 v[208:211], v[252:255], v[56:59], v[208:211]
    ds_read_b128 v[248:251], v10 offset:18432
    v_mfma_f32_16x16x32_bf16 v[212:215], v[252:255], v[60:63], v[212:215]
    buffer_load_dwordx4 v1, s[4:7], s19 offen offset:1024 sc1 lds
    s_waitcnt lgkmcnt(6)
    v_mfma_f32_16x16x32_bf16 v[192:195], v[224:227], v[64:67], v[192:195]
    ds_read_b128 v[252:255], v10 offset:19456
    v_mfma_f32_16x16x32_bf16 v[200:203], v[224:227], v[68:71], v[200:203]
    s_waitcnt lgkmcnt(6)
    v_mfma_f32_16x16x32_bf16 v[196:199], v[228:231], v[64:67], v[196:199]
    ds_read_b128 v[224:227], v10 offset:20480
    v_mfma_f32_16x16x32_bf16 v[204:207], v[228:231], v[68:71], v[204:207]
    buffer_load_dwordx4 v1, s[4:7], s19 offen offset:2048 sc1 lds
    s_waitcnt lgkmcnt(6)
    v_mfma_f32_16x16x32_bf16 v[208:211], v[232:235], v[64:67], v[208:211]
    ds_read_b128 v[228:231], v10 offset:21504
    v_mfma_f32_16x16x32_bf16 v[212:215], v[232:235], v[68:71], v[212:215]
    s_waitcnt lgkmcnt(6)
    v_mfma_f32_16x16x32_bf16 v[192:195], v[236:239], v[72:75], v[192:195]
    ds_read_b128 v[232:235], v10 offset:22528
    v_mfma_f32_16x16x32_bf16 v[200:203], v[236:239], v[76:79], v[200:203]
    buffer_load_dwordx4 v1, s[4:7], s19 offen offset:3072 sc1 lds
    s_waitcnt lgkmcnt(6)
    v_mfma_f32_16x16x32_bf16 v[196:199], v[240:243], v[72:75], v[196:199]
    ds_read_b128 v[236:239], v10 offset:23552
    v_mfma_f32_16x16x32_bf16 v[204:207], v[240:243], v[76:79], v[204:207]
    s_waitcnt lgkmcnt(6)
    v_mfma_f32_16x16x32_bf16 v[208:211], v[244:247], v[72:75], v[208:211]
    ds_read_b128 v[240:243], v10 offset:24576
    s_add_u32 m0, s35, 8192
    s_add_u32 s19, s17, 8192
    v_mfma_f32_16x16x32_bf16 v[212:215], v[244:247], v[76:79], v[212:215]
    buffer_load_dwordx4 v1, s[4:7], s19 offen offset:0 sc1 lds
    s_waitcnt lgkmcnt(6)
    v_mfma_f32_16x16x32_bf16 v[192:195], v[248:251], v[80:83], v[192:195]
    ds_read_b128 v[244:247], v10 offset:25600
    v_mfma_f32_16x16x32_bf16 v[200:203], v[248:251], v[84:87], v[200:203]
    s_waitcnt lgkmcnt(6)
    v_mfma_f32_16x16x32_bf16 v[196:199], v[252:255], v[80:83], v[196:199]
    ds_read_b128 v[248:251], v10 offset:26624
    v_mfma_f32_16x16x32_bf16 v[204:207], v[252:255], v[84:87], v[204:207]
    buffer_load_dwordx4 v1, s[4:7], s19 offen offset:1024 sc1 lds
    s_waitcnt lgkmcnt(6)
    v_mfma_f32_16x16x32_bf16 v[208:211], v[224:227], v[80:83], v[208:211]
    ds_read_b128 v[252:255], v10 offset:27648
    v_mfma_f32_16x16x32_bf16 v[212:215], v[224:227], v[84:87], v[212:215]
    s_waitcnt lgkmcnt(6)
    v_mfma_f32_16x16x32_bf16 v[192:195], v[228:231], v[88:91], v[192:195]
    ds_read_b128 v[224:227], v10 offset:28672
    v_mfma_f32_16x16x32_bf16 v[200:203], v[228:231], v[92:95], v[200:203]
    buffer_load_dwordx4 v1, s[4:7], s19 offen offset:2048 sc1 lds
    s_waitcnt lgkmcnt(6)
    v_mfma_f32_16x16x32_bf16 v[196:199], v[232:235], v[88:91], v[196:199]
    ds_read_b128 v[228:231], v10 offset:29696
    v_mfma_f32_16x16x32_bf16 v[204:207], v[232:235], v[92:95], v[204:207]
    s_waitcnt lgkmcnt(6)
    v_mfma_f32_16x16x32_bf16 v[208:211], v[236:239], v[88:91], v[208:211]
    ds_read_b128 v[232:235], v10 offset:30720
    v_mfma_f32_16x16x32_bf16 v[212:215], v[236:239], v[92:95], v[212:215]
    buffer_load_dwordx4 v1, s[4:7], s19 offen offset:3072 sc1 lds
    s_waitcnt lgkmcnt(6)
    v_mfma_f32_16x16x32_bf16 v[192:195], v[240:243], v[96:99], v[192:195]
    ds_read_b128 v[236:239], v10 offset:31744
    v_mfma_f32_16x16x32_bf16 v[200:203], v[240:243], v[100:103], v[200:203]
    s_waitcnt lgkmcnt(6)
    v_mfma_f32_16x16x32_bf16 v[196:199], v[244:247], v[96:99], v[196:199]
    ds_read_b128 v[240:243], v10 offset:32768
    s_add_u32 m0, s35, 12288
    s_add_u32 s19, s17, 12288
    s_waitcnt vmcnt(12)
    s_mov_b32 exec_hi, 0
    buffer_store_dword v3, v4, s[4:7], s23 offen sc1
    s_mov_b64 exec, -1
    s_add_u32 s23, s23, 131072
    v_mfma_f32_16x16x32_bf16 v[204:207], v[244:247], v[100:103], v[204:207]
    buffer_load_dwordx4 v1, s[4:7], s19 offen offset:0 sc1 lds
    s_waitcnt lgkmcnt(6)
    v_mfma_f32_16x16x32_bf16 v[208:211], v[248:251], v[96:99], v[208:211]
    ds_read_b128 v[244:247], v10 offset:33792
    v_mfma_f32_16x16x32_bf16 v[212:215], v[248:251], v[100:103], v[212:215]
    s_waitcnt lgkmcnt(6)
    v_mfma_f32_16x16x32_bf16 v[192:195], v[252:255], v[104:107], v[192:195]
    ds_read_b128 v[248:251], v10 offset:34816
    v_mfma_f32_16x16x32_bf16 v[200:203], v[252:255], v[108:111], v[200:203]
    buffer_load_dwordx4 v1, s[4:7], s19 offen offset:1024 sc1 lds
    s_waitcnt lgkmcnt(6)
    v_mfma_f32_16x16x32_bf16 v[196:199], v[224:227], v[104:107], v[196:199]
    ds_read_b128 v[252:255], v10 offset:35840
    v_mfma_f32_16x16x32_bf16 v[204:207], v[224:227], v[108:111], v[204:207]
    s_waitcnt lgkmcnt(6)
    v_mfma_f32_16x16x32_bf16 v[208:211], v[228:231], v[104:107], v[208:211]
    ds_read_b128 v[224:227], v10 offset:36864
    v_mfma_f32_16x16x32_bf16 v[212:215], v[228:231], v[108:111], v[212:215]
    buffer_load_dwordx4 v1, s[4:7], s19 offen offset:2048 sc1 lds
    s_waitcnt lgkmcnt(6)
    v_mfma_f32_16x16x32_bf16 v[192:195], v[232:235], v[112:115], v[192:195]
    ds_read_b128 v[228:231], v10 offset:37888
    v_mfma_f32_16x16x32_bf16 v[200:203], v[232:235], v[116:119], v[200:203]
    s_waitcnt lgkmcnt(6)
    v_mfma_f32_16x16x32_bf16 v[196:199], v[236:239], v[112:115], v[196:199]
    ds_read_b128 v[232:235], v10 offset:38912
    v_mfma_f32_16x16x32_bf16 v[204:207], v[236:239], v[116:119], v[204:207]
    buffer_load_dwordx4 v1, s[4:7], s19 offen offset:3072 sc1 lds
    s_waitcnt lgkmcnt(6)
    v_mfma_f32_16x16x32_bf16 v[208:211], v[240:243], v[112:115], v[208:211]
    ds_read_b128 v[236:239], v10 offset:39936
    v_mfma_f32_16x16x32_bf16 v[212:215], v[240:243], v[116:119], v[212:215]
    s_waitcnt lgkmcnt(6)
    v_mfma_f32_16x16x32_bf16 v[192:195], v[244:247], v[120:123], v[192:195]
    ds_read_b128 v[240:243], v10 offset:40960
    v_mfma_f32_16x16x32_bf16 v[200:203], v[244:247], v[124:127], v[200:203]
    buffer_load_dwordx4 a[212:215], v1, s[4:7], s20 offen offset:1024 sc1
    s_waitcnt lgkmcnt(6)
    v_mfma_f32_16x16x32_bf16 v[196:199], v[248:251], v[120:123], v[196:199]
    ds_read_b128 v[244:247], v10 offset:41984
    v_mfma_f32_16x16x32_bf16 v[204:207], v[248:251], v[124:127], v[204:207]
    s_waitcnt lgkmcnt(6)
    v_mfma_f32_16x16x32_bf16 v[208:211], v[252:255], v[120:123], v[208:211]
    ds_read_b128 v[248:251], v10 offset:43008
    s_xor_b32 s20, s20, 0x800
    v_mfma_f32_16x16x32_bf16 v[212:215], v[252:255], v[124:127], v[212:215]
    buffer_load_dwordx4 a[216:219], v1, s[4:7], s20 offen offset:0 sc1
    s_waitcnt lgkmcnt(6)
    v_mfma_f32_16x16x32_bf16 v[192:195], v[224:227], v[128:131], v[192:195]
    ds_read_b128 v[252:255], v10 offset:44032
    v_mfma_f32_16x16x32_bf16 v[200:203], v[224:227], v[132:135], v[200:203]
    s_waitcnt lgkmcnt(6)
    v_mfma_f32_16x16x32_bf16 v[196:199], v[228:231], v[128:131], v[196:199]
    ds_read_b128 v[224:227], v10 offset:45056
    v_mfma_f32_16x16x32_bf16 v[204:207], v[228:231], v[132:135], v[204:207]
    buffer_load_dwordx4 a[220:223], v1, s[4:7], s20 offen offset:1024 sc1
    s_waitcnt lgkmcnt(6)
    v_mfma_f32_16x16x32_bf16 v[208:211], v[232:235], v[128:131], v[208:211]
    ds_read_b128 v[228:231], v10 offset:46080
    v_mfma_f32_16x16x32_bf16 v[212:215], v[232:235], v[132:135], v[212:215]
    s_waitcnt lgkmcnt(6)
    v_mfma_f32_16x16x32_bf16 v[192:195], v[236:239], v[136:139], v[192:195]
    ds_read_b128 v[232:235], v10 offset:47104
    v_mfma_f32_16x16x32_bf16 v[200:203], v[236:239], v[140:143], v[200:203]
    s_waitcnt lgkmcnt(6)
    v_mfma_f32_16x16x32_bf16 v[196:199], v[240:243], v[136:139], v[196:199]
    ds_read_b128 v[236:239], v10 offset:48128
    v_mfma_f32_16x16x32_bf16 v[204:207], v[240:243], v[140:143], v[204:207]
    s_waitcnt lgkmcnt(6)
    v_mfma_f32_16x16x32_bf16 v[208:211], v[244:247], v[136:139], v[208:211]
    ds_read_b128 v[240:243], v9 offset:8448
    v_mfma_f32_16x16x32_bf16 v[212:215], v[244:247], v[140:143], v[212:215]
    s_waitcnt lgkmcnt(6)
    v_mfma_f32_16x16x32_bf16 v[192:195], v[248:251], v[144:147], v[192:195]
    ds_read_b128 v[244:247], v9 offset:8512
    v_mfma_f32_16x16x32_bf16 v[200:203], v[248:251], v[148:151], v[200:203]
    s_waitcnt lgkmcnt(6)
    v_mfma_f32_16x16x32_bf16 v[196:199], v[252:255], v[144:147], v[196:199]
    ds_read_b128 v[248:251], v9 offset:8576
    v_mfma_f32_16x16x32_bf16 v[204:207], v[252:255], v[148:151], v[204:207]
    s_waitcnt lgkmcnt(6)
    v_mfma_f32_16x16x32_bf16 v[208:211], v[224:227], v[144:147], v[208:211]
    v_mfma_f32_16x16x32_bf16 v[212:215], v[224:227], v[148:151], v[212:215]
    s_waitcnt lgkmcnt(5)
    v_mfma_f32_16x16x32_bf16 v[192:195], v[228:231], v[152:155], v[192:195]
    v_mfma_f32_16x16x32_bf16 v[200:203], v[228:231], v[156:159], v[200:203]
    s_waitcnt lgkmcnt(4)
    v_mfma_f32_16x16x32_bf16 v[196:199], v[232:235], v[152:155], v[196:199]
    v_mfma_f32_16x16x32_bf16 v[204:207], v[232:235], v[156:159], v[204:207]
    s_waitcnt lgkmcnt(3)
    v_mfma_f32_16x16x32_bf16 v[208:211], v[236:239], v[152:155], v[208:211]
    v_mfma_f32_16x16x32_bf16 v[212:215], v[236:239], v[156:159], v[212:215]
    v_and_b32 v6, 48, v0
    v_lshlrev_b32 v6, 1, v6
    s_lshl_b32 s35, s15, 7
    buffer_load_dwordx4 v[224:227], v6, s[40:43], s35 offen offset:0
    buffer_load_dwordx4 v[228:231], v6, s[40:43], s35 offen offset:16
    s_waitcnt lgkmcnt(2)
    v_pk_fma_f32 v[192:193], v[192:193], v[12:13], v[240:241] op_sel:[0,0,0] op_sel_hi:[1,0,1]
    v_pk_fma_f32 v[194:195], v[194:195], v[12:13], v[242:243] op_sel:[0,0,0] op_sel_hi:[1,0,1]
    s_waitcnt lgkmcnt(1)
    v_pk_fma_f32 v[196:197], v[196:197], v[12:13], v[244:245] op_sel:[0,0,0] op_sel_hi:[1,0,1]
    v_pk_fma_f32 v[198:199], v[198:199], v[12:13], v[246:247] op_sel:[0,0,0] op_sel_hi:[1,0,1]
    v_pk_mul_f32 v[16:17], v[192:193], v[192:193]
    v_pk_mul_f32 v[18:19], v[194:195], v[194:195]
    v_pk_mul_f32 v[20:21], v[196:197], v[196:197]
    v_pk_mul_f32 v[22:23], v[198:199], v[198:199]
    v_pk_fma_f32 v[16:17], v[16:17], v[14:15], v[14:15] op_sel:[0,0,1] op_sel_hi:[1,0,1]
    v_pk_fma_f32 v[18:19], v[18:19], v[14:15], v[14:15] op_sel:[0,0,1] op_sel_hi:[1,0,1]
    v_pk_fma_f32 v[20:21], v[20:21], v[14:15], v[14:15] op_sel:[0,0,1] op_sel_hi:[1,0,1]
    v_pk_fma_f32 v[22:23], v[22:23], v[14:15], v[14:15] op_sel:[0,0,1] op_sel_hi:[1,0,1]
    v_pk_mul_f32 v[16:17], v[192:193], v[16:17]
    v_pk_mul_f32 v[18:19], v[194:195], v[18:19]
    v_pk_mul_f32 v[20:21], v[196:197], v[20:21]
    v_pk_mul_f32 v[22:23], v[198:199], v[22:23]
    v_exp_f32 v16, v16
    v_exp_f32 v17, v17
    v_exp_f32 v18, v18
    v_exp_f32 v19, v19
    v_exp_f32 v20, v20
    v_exp_f32 v21, v21
    v_exp_f32 v22, v22
    v_exp_f32 v23, v23
    v_pk_add_f32 v[16:17], v[16:17], 1.0 op_sel_hi:[1,0]
    v_pk_add_f32 v[18:19], v[18:19], 1.0 op_sel_hi:[1,0]
    v_pk_add_f32 v[20:21], v[20:21], 1.0 op_sel_hi:[1,0]
    v_pk_add_f32 v[22:23], v[22:23], 1.0 op_sel_hi:[1,0]
    v_rcp_f32 v16, v16
    v_rcp_f32 v17, v17
    v_rcp_f32 v18, v18
    v_rcp_f32 v19, v19
    v_rcp_f32 v20, v20
    v_rcp_f32 v21, v21
    v_rcp_f32 v22, v22
    v_rcp_f32 v23, v23
    v_pk_mul_f32 v[16:17], v[192:193], v[16:17]
    v_pk_mul_f32 v[18:19], v[194:195], v[18:19]
    v_pk_mul_f32 v[20:21], v[196:197], v[20:21]
    v_pk_mul_f32 v[22:23], v[198:199], v[22:23]
    v_cvt_pk_bf16_f32 v24, v16, v17
    v_cvt_pk_bf16_f32 v26, v20, v21
    v_cvt_pk_bf16_f32 v25, v18, v19
    v_cvt_pk_bf16_f32 v27, v22, v23
    buffer_store_dwordx4 v[24:27], v1, s[4:7], s27 offen offset:0 sc1
    s_add_u32 s27, s27, 229376
    buffer_load_dword v2, v11, s[4:7], s24 offen sc1
    v_pk_fma_f32 v[200:201], v[200:201], v[12:13], v[240:241] op_sel:[0,1,0] op_sel_hi:[1,1,1]
    v_pk_fma_f32 v[202:203], v[202:203], v[12:13], v[242:243] op_sel:[0,1,0] op_sel_hi:[1,1,1]
    v_pk_fma_f32 v[204:205], v[204:205], v[12:13], v[244:245] op_sel:[0,1,0] op_sel_hi:[1,1,1]
    v_pk_fma_f32 v[206:207], v[206:207], v[12:13], v[246:247] op_sel:[0,1,0] op_sel_hi:[1,1,1]
    v_pk_mul_f32 v[16:17], v[200:201], v[200:201]
    v_pk_mul_f32 v[18:19], v[202:203], v[202:203]
    v_pk_mul_f32 v[20:21], v[204:205], v[204:205]
    v_pk_mul_f32 v[22:23], v[206:207], v[206:207]
    v_pk_fma_f32 v[16:17], v[16:17], v[14:15], v[14:15] op_sel:[0,0,1] op_sel_hi:[1,0,1]
    v_pk_fma_f32 v[18:19], v[18:19], v[14:15], v[14:15] op_sel:[0,0,1] op_sel_hi:[1,0,1]
    v_pk_fma_f32 v[20:21], v[20:21], v[14:15], v[14:15] op_sel:[0,0,1] op_sel_hi:[1,0,1]
    v_pk_fma_f32 v[22:23], v[22:23], v[14:15], v[14:15] op_sel:[0,0,1] op_sel_hi:[1,0,1]
    v_pk_mul_f32 v[16:17], v[200:201], v[16:17]
    v_pk_mul_f32 v[18:19], v[202:203], v[18:19]
    v_pk_mul_f32 v[20:21], v[204:205], v[20:21]
    v_pk_mul_f32 v[22:23], v[206:207], v[22:23]
    v_exp_f32 v16, v16
    v_exp_f32 v17, v17
    v_exp_f32 v18, v18
    v_exp_f32 v19, v19
    v_exp_f32 v20, v20
    v_exp_f32 v21, v21
    v_exp_f32 v22, v22
    v_exp_f32 v23, v23
    v_pk_add_f32 v[16:17], v[16:17], 1.0 op_sel_hi:[1,0]
    v_pk_add_f32 v[18:19], v[18:19], 1.0 op_sel_hi:[1,0]
    v_pk_add_f32 v[20:21], v[20:21], 1.0 op_sel_hi:[1,0]
    v_pk_add_f32 v[22:23], v[22:23], 1.0 op_sel_hi:[1,0]
    v_rcp_f32 v16, v16
    v_rcp_f32 v17, v17
    v_rcp_f32 v18, v18
    v_rcp_f32 v19, v19
    v_rcp_f32 v20, v20
    v_rcp_f32 v21, v21
    v_rcp_f32 v22, v22
    v_rcp_f32 v23, v23
    v_pk_mul_f32 v[16:17], v[200:201], v[16:17]
    v_pk_mul_f32 v[18:19], v[202:203], v[18:19]
    v_pk_mul_f32 v[20:21], v[204:205], v[20:21]
    v_pk_mul_f32 v[22:23], v[206:207], v[22:23]
    v_cvt_pk_bf16_f32 v28, v16, v17
    v_cvt_pk_bf16_f32 v30, v20, v21
    v_cvt_pk_bf16_f32 v29, v18, v19
    v_cvt_pk_bf16_f32 v31, v22, v23
    buffer_store_dwordx4 v[28:31], v1, s[4:7], s27 offen offset:0 sc1
    s_waitcnt lgkmcnt(0)
    v_pk_fma_f32 v[208:209], v[208:209], v[12:13], v[248:249] op_sel:[0,0,0] op_sel_hi:[1,0,1]
    v_pk_fma_f32 v[210:211], v[210:211], v[12:13], v[250:251] op_sel:[0,0,0] op_sel_hi:[1,0,1]
    v_pk_fma_f32 v[212:213], v[212:213], v[12:13], v[248:249] op_sel:[0,1,0] op_sel_hi:[1,1,1]
    v_pk_fma_f32 v[214:215], v[214:215], v[12:13], v[250:251] op_sel:[0,1,0] op_sel_hi:[1,1,1]
    v_pk_mul_f32 v[16:17], v[208:209], v[208:209]
    v_pk_mul_f32 v[18:19], v[210:211], v[210:211]
    v_pk_mul_f32 v[20:21], v[212:213], v[212:213]
    v_pk_mul_f32 v[22:23], v[214:215], v[214:215]
    v_pk_fma_f32 v[16:17], v[16:17], v[14:15], v[14:15] op_sel:[0,0,1] op_sel_hi:[1,0,1]
    v_pk_fma_f32 v[18:19], v[18:19], v[14:15], v[14:15] op_sel:[0,0,1] op_sel_hi:[1,0,1]
    v_pk_fma_f32 v[20:21], v[20:21], v[14:15], v[14:15] op_sel:[0,0,1] op_sel_hi:[1,0,1]
    v_pk_fma_f32 v[22:23], v[22:23], v[14:15], v[14:15] op_sel:[0,0,1] op_sel_hi:[1,0,1]
    v_pk_mul_f32 v[16:17], v[208:209], v[16:17]
    v_pk_mul_f32 v[18:19], v[210:211], v[18:19]
    v_pk_mul_f32 v[20:21], v[212:213], v[20:21]
    v_pk_mul_f32 v[22:23], v[214:215], v[22:23]
    v_exp_f32 v16, v16
    v_exp_f32 v17, v17
    v_exp_f32 v18, v18
    v_exp_f32 v19, v19
    v_exp_f32 v20, v20
    v_exp_f32 v21, v21
    v_exp_f32 v22, v22
    v_exp_f32_e64 v23, v23
    v_pk_add_f32 v[16:17], v[16:17], 1.0 op_sel_hi:[1,0]
    v_pk_add_f32 v[18:19], v[18:19], 1.0 op_sel_hi:[1,0]
    v_pk_add_f32 v[20:21], v[20:21], 1.0 op_sel_hi:[1,0]
    v_pk_add_f32 v[22:23], v[22:23], 1.0 op_sel_hi:[1,0]
    v_rcp_f32 v16, v16
    v_rcp_f32 v17, v17
    v_rcp_f32 v18, v18
    v_rcp_f32 v19, v19
    v_rcp_f32 v20, v20
    v_rcp_f32 v21, v21
    v_rcp_f32 v22, v22
    v_rcp_f32 v23, v23
    v_pk_mul_f32 v[16:17], v[208:209], v[16:17]
    v_pk_mul_f32 v[18:19], v[210:211], v[18:19]
    v_pk_mul_f32 v[20:21], v[212:213], v[20:21]
    v_pk_mul_f32 v[22:23], v[214:215], v[22:23]
    v_cvt_pk_bf16_f32 v24, v16, v17
    v_cvt_pk_bf16_f32 v26, v20, v21
    v_cvt_pk_bf16_f32 v25, v18, v19
    v_cvt_pk_bf16_f32 v27, v22, v23
    v_permlane16_swap_b32 v24, v26
    s_nop 0
    v_permlane16_swap_b32 v25, v27
    buffer_store_dwordx4 v[24:27], v8, s[4:7], s28 offen sc1
    s_waitcnt vmcnt(5)
    v_lshlrev_b32 v208, 16, v224
    v_and_b32 v209, 0xffff0000, v224
    v_lshlrev_b32 v210, 16, v225
    v_and_b32 v211, 0xffff0000, v225
    v_lshlrev_b32 v212, 16, v226
    v_and_b32 v213, 0xffff0000, v226
    v_lshlrev_b32 v214, 16, v227
    v_and_b32 v215, 0xffff0000, v227
    s_waitcnt vmcnt(4)
    v_lshlrev_b32 v216, 16, v228
    v_and_b32 v217, 0xffff0000, v228
    v_lshlrev_b32 v218, 16, v229
    v_and_b32 v219, 0xffff0000, v229
    v_lshlrev_b32 v220, 16, v230
    v_and_b32 v221, 0xffff0000, v230
    v_lshlrev_b32 v222, 16, v231
    v_and_b32 v223, 0xffff0000, v231
    s_barrier
    s_cmp_eq_u32 s14, 1
    s_cbranch_scc1 X3B
    ds_read_b128 v[224:227], v1 offset:0
    ds_read_b128 v[228:231], v1 offset:1024
    ds_read_b128 v[232:235], v1 offset:2048
    ds_read_b128 v[236:239], v1 offset:3072
    ds_read_b128 v[240:243], v1 offset:4096
    ds_read_b128 v[244:247], v1 offset:5120
    ds_read_b128 v[248:251], v1 offset:6144
    s_waitcnt lgkmcnt(6)
    v_mfma_f32_16x16x32_bf16 v[208:211], v[224:227], v[32:35], v[208:211]
    ds_read_b128 v[252:255], v1 offset:7168
    s_waitcnt lgkmcnt(6)
    v_mfma_f32_16x16x32_bf16 v[212:215], v[228:231], v[32:35], v[212:215]
    ds_read_b128 v[224:227], v1 offset:8192
    s_waitcnt lgkmcnt(6)
    v_mfma_f32_16x16x32_bf16 v[216:219], v[232:235], v[32:35], v[216:219]
    ds_read_b128 v[228:231], v1 offset:9216
    s_waitcnt lgkmcnt(6)
    v_mfma_f32_16x16x32_bf16 v[220:223], v[236:239], v[32:35], v[220:223]
    ds_read_b128 v[232:235], v1 offset:10240
    s_waitcnt lgkmcnt(6)
    v_mfma_f32_16x16x32_bf16 v[16:19], v[240:243], v[40:43], 0
    ds_read_b128 v[236:239], v1 offset:11264
    s_waitcnt lgkmcnt(6)
    v_mfma_f32_16x16x32_bf16 v[20:23], v[244:247], v[40:43], 0
    ds_read_b128 v[240:243], v1 offset:12288
    s_waitcnt vmcnt(2)
    v_cmp_ne_u32 vcc, s48, v2
    s_cbranch_vccz GO10
    s_mov_b32 s25, 0
POLL10:
    s_mov_b64 exec, vcc
    buffer_load_dword v2, v11, s[4:7], s24 offen sc1
    s_add_u32 s25, s25, 1
    s_waitcnt vmcnt(0)
    v_cmp_ne_u32 vcc, s48, v2
    s_cmp_lt_u32 s25, 0x8000
    s_cselect_b64 vcc, vcc, 0
    s_cbranch_vccnz POLL10
    s_mov_b64 exec, -1
GO10:
    s_add_u32 s22, s30, 0
    buffer_load_dwordx4 v[32:35], v1, s[4:7], s22 offen offset:0 sc1
    s_waitcnt lgkmcnt(6)
    v_mfma_f32_16x16x32_bf16 v[24:27], v[248:251], v[40:43], 0
    ds_read_b128 v[244:247], v1 offset:13312
    s_waitcnt lgkmcnt(6)
    v_mfma_f32_16x16x32_bf16 v[28:31], v[252:255], v[40:43], 0
    ds_read_b128 v[248:251], v1 offset:14336
    s_waitcnt lgkmcnt(6)
    v_mfma_f32_16x16x32_bf16 v[208:211], v[224:227], v[48:51], v[208:211]
    ds_read_b128 v[252:255], v1 offset:15360
    s_waitcnt lgkmcnt(6)
    v_mfma_f32_16x16x32_bf16 v[212:215], v[228:231], v[48:51], v[212:215]
    ds_read_b128 v[224:227], v1 offset:16384
    buffer_load_dwordx4 v[36:39], v1, s[4:7], s22 offen offset:1024 sc1
    s_waitcnt lgkmcnt(6)
    v_mfma_f32_16x16x32_bf16 v[216:219], v[232:235], v[48:51], v[216:219]
    ds_read_b128 v[228:231], v1 offset:17408
    s_waitcnt lgkmcnt(6)
    v_mfma_f32_16x16x32_bf16 v[220:223], v[236:239], v[48:51], v[220:223]
    ds_read_b128 v[232:235], v1 offset:18432
    s_waitcnt lgkmcnt(6)
    v_mfma_f32_16x16x32_bf16 v[16:19], v[240:243], v[56:59], v[16:19]
    ds_read_b128 v[236:239], v1 offset:19456
    s_waitcnt lgkmcnt(6)
    v_mfma_f32_16x16x32_bf16 v[20:23], v[244:247], v[56:59], v[20:23]
    ds_read_b128 v[240:243], v1 offset:20480
    buffer_load_dwordx4 v[40:43], v1, s[4:7], s22 offen offset:2048 sc1
    s_waitcnt lgkmcnt(6)
    v_mfma_f32_16x16x32_bf16 v[24:27], v[248:251], v[56:59], v[24:27]
    ds_read_b128 v[244:247], v1 offset:21504
    s_waitcnt lgkmcnt(6)
    v_mfma_f32_16x16x32_bf16 v[28:31], v[252:255], v[56:59], v[28:31]
    ds_read_b128 v[248:251], v1 offset:22528
    s_waitcnt lgkmcnt(6)
    v_mfma_f32_16x16x32_bf16 v[208:211], v[224:227], v[64:67], v[208:211]
    ds_read_b128 v[252:255], v1 offset:23552
    s_waitcnt lgkmcnt(6)
    v_mfma_f32_16x16x32_bf16 v[212:215], v[228:231], v[64:67], v[212:215]
    ds_read_b128 v[224:227], v1 offset:24576
    buffer_load_dwordx4 v[44:47], v1, s[4:7], s22 offen offset:3072 sc1
    s_waitcnt lgkmcnt(6)
    v_mfma_f32_16x16x32_bf16 v[216:219], v[232:235], v[64:67], v[216:219]
    ds_read_b128 v[228:231], v1 offset:25600
    s_waitcnt lgkmcnt(6)
    v_mfma_f32_16x16x32_bf16 v[220:223], v[236:239], v[64:67], v[220:223]
    ds_read_b128 v[232:235], v1 offset:26624
    s_waitcnt lgkmcnt(6)
    v_mfma_f32_16x16x32_bf16 v[16:19], v[240:243], v[72:75], v[16:19]
    ds_read_b128 v[236:239], v1 offset:27648
    s_waitcnt lgkmcnt(6)
    v_mfma_f32_16x16x32_bf16 v[20:23], v[244:247], v[72:75], v[20:23]
    ds_read_b128 v[240:243], v1 offset:28672
    s_add_u32 s22, s30, 4096
    buffer_load_dwordx4 v[48:51], v1, s[4:7], s22 offen offset:0 sc1
    s_waitcnt lgkmcnt(6)
    v_mfma_f32_16x16x32_bf16 v[24:27], v[248:251], v[72:75], v[24:27]
    ds_read_b128 v[244:247], v1 offset:29696
    s_waitcnt lgkmcnt(6)
    v_mfma_f32_16x16x32_bf16 v[28:31], v[252:255], v[72:75], v[28:31]
    ds_read_b128 v[248:251], v1 offset:30720
    s_waitcnt lgkmcnt(6)
    v_mfma_f32_16x16x32_bf16 v[208:211], v[224:227], v[80:83], v[208:211]
    ds_read_b128 v[252:255], v1 offset:31744
    s_waitcnt lgkmcnt(6)
    v_mfma_f32_16x16x32_bf16 v[212:215], v[228:231], v[80:83], v[212:215]
    ds_read_b128 v[224:227], v1 offset:32768
    buffer_load_dwordx4 v[52:55], v1, s[4:7], s22 offen offset:1024 sc1
    s_waitcnt lgkmcnt(6)
    v_mfma_f32_16x16x32_bf16 v[216:219], v[232:235], v[80:83], v[216:219]
    ds_read_b128 v[228:231], v1 offset:33792
    s_waitcnt lgkmcnt(6)
    v_mfma_f32_16x16x32_bf16 v[220:223], v[236:239], v[80:83], v[220:223]
    ds_read_b128 v[232:235], v1 offset:34816
    s_waitcnt lgkmcnt(6)
    v_mfma_f32_16x16x32_bf16 v[16:19], v[240:243], v[88:91], v[16:19]
    ds_read_b128 v[236:239], v1 offset:35840
    s_waitcnt lgkmcnt(6)
    v_mfma_f32_16x16x32_bf16 v[20:23], v[244:247], v[88:91], v[20:23]
    ds_read_b128 v[240:243], v1 offset:36864
    buffer_load_dwordx4 v[56:59], v1, s[4:7], s22 offen offset:2048 sc1
    s_waitcnt lgkmcnt(6)
    v_mfma_f32_16x16x32_bf16 v[24:27], v[248:251], v[88:91], v[24:27]
    ds_read_b128 v[244:247], v1 offset:37888
    s_waitcnt lgkmcnt(6)
    v_mfma_f32_16x16x32_bf16 v[28:31], v[252:255], v[88:91], v[28:31]
    ds_read_b128 v[248:251], v1 offset:38912
    s_waitcnt lgkmcnt(6)
    v_mfma_f32_16x16x32_bf16 v[208:211], v[224:227], v[96:99], v[208:211]
    ds_read_b128 v[252:255], v1 offset:39936
    s_waitcnt lgkmcnt(6)
    v_mfma_f32_16x16x32_bf16 v[212:215], v[228:231], v[96:99], v[212:215]
    ds_read_b128 v[224:227], v1 offset:40960
    buffer_load_dwordx4 v[60:63], v1, s[4:7], s22 offen offset:3072 sc1
    s_waitcnt lgkmcnt(6)
    v_mfma_f32_16x16x32_bf16 v[216:219], v[232:235], v[96:99], v[216:219]
    ds_read_b128 v[228:231], v1 offset:41984
    s_waitcnt lgkmcnt(6)
    v_mfma_f32_16x16x32_bf16 v[220:223], v[236:239], v[96:99], v[220:223]
    ds_read_b128 v[232:235], v1 offset:43008
    s_waitcnt lgkmcnt(6)
    v_mfma_f32_16x16x32_bf16 v[16:19], v[240:243], v[104:107], v[16:19]
    ds_read_b128 v[236:239], v1 offset:44032
    s_waitcnt lgkmcnt(6)
    v_mfma_f32_16x16x32_bf16 v[20:23], v[244:247], v[104:107], v[20:23]
    ds_read_b128 v[240:243], v1 offset:45056
    s_add_u32 s22, s31, 0
    buffer_load_dwordx4 v[64:67], v1, s[4:7], s22 offen offset:0 sc1
    s_waitcnt lgkmcnt(6)
    v_mfma_f32_16x16x32_bf16 v[24:27], v[248:251], v[104:107], v[24:27]
    ds_read_b128 v[244:247], v1 offset:46080
    s_waitcnt lgkmcnt(6)
    v_mfma_f32_16x16x32_bf16 v[28:31], v[252:255], v[104:107], v[28:31]
    ds_read_b128 v[248:251], v1 offset:47104
    s_waitcnt lgkmcnt(6)
    v_mfma_f32_16x16x32_bf16 v[208:211], v[224:227], v[112:115], v[208:211]
    ds_read_b128 v[252:255], v1 offset:48128
    s_waitcnt lgkmcnt(6)
    v_mfma_f32_16x16x32_bf16 v[212:215], v[228:231], v[112:115], v[212:215]
    ds_read_b128 v[224:227], v1 offset:49152
    buffer_load_dwordx4 v[68:71], v1, s[4:7], s22 offen offset:1024 sc1
    s_waitcnt lgkmcnt(6)
    v_mfma_f32_16x16x32_bf16 v[216:219], v[232:235], v[112:115], v[216:219]
    ds_read_b128 v[228:231], v1 offset:50176
    s_waitcnt lgkmcnt(6)
    v_mfma_f32_16x16x32_bf16 v[220:223], v[236:239], v[112:115], v[220:223]
    ds_read_b128 v[232:235], v1 offset:51200
    s_waitcnt lgkmcnt(6)
    v_mfma_f32_16x16x32_bf16 v[16:19], v[240:243], v[120:123], v[16:19]
    ds_read_b128 v[236:239], v1 offset:52224
    s_waitcnt vmcnt(10)
    s_mov_b32 exec_hi, 0
    buffer_store_dword v3, v4, s[4:7], s23 offen sc1
    s_mov_b64 exec, -1
    s_waitcnt lgkmcnt(6)
    v_mfma_f32_16x16x32_bf16 v[20:23], v[244:247], v[120:123], v[20:23]
    ds_read_b128 v[240:243], v1 offset:53248
    buffer_load_dwordx4 v[72:75], v1, s[4:7], s22 offen offset:2048 sc1
    s_waitcnt lgkmcnt(6)
    v_mfma_f32_16x16x32_bf16 v[24:27], v[248:251], v[120:123], v[24:27]
    ds_read_b128 v[244:247], v1 offset:54272
    s_waitcnt lgkmcnt(6)
    v_mfma_f32_16x16x32_bf16 v[28:31], v[252:255], v[120:123], v[28:31]
    ds_read_b128 v[248:251], v1 offset:55296
    s_waitcnt lgkmcnt(6)
    v_mfma_f32_16x16x32_bf16 v[208:211], v[224:227], v[128:131], v[208:211]
    ds_read_b128 v[252:255], v1 offset:56320
    s_waitcnt lgkmcnt(6)
    v_mfma_f32_16x16x32_bf16 v[212:215], v[228:231], v[128:131], v[212:215]
    ds_read_b128 v[224:227], v1 offset:57344
    buffer_load_dwordx4 v[76:79], v1, s[4:7], s22 offen offset:3072 sc1
    s_waitcnt lgkmcnt(6)
    v_mfma_f32_16x16x32_bf16 v[216:219], v[232:235], v[128:131], v[216:219]
    ds_read_b128 v[228:231], v1 offset:58368
    s_waitcnt lgkmcnt(6)
    v_mfma_f32_16x16x32_bf16 v[220:223], v[236:239], v[128:131], v[220:223]
    ds_read_b128 v[232:235], v1 offset:59392
    s_waitcnt lgkmcnt(6)
    v_mfma_f32_16x16x32_bf16 v[16:19], v[240:243], v[136:139], v[16:19]
    ds_read_b128 v[236:239], v1 offset:60416
    s_waitcnt lgkmcnt(6)
    v_mfma_f32_16x16x32_bf16 v[20:23], v[244:247], v[136:139], v[20:23]
    ds_read_b128 v[240:243], v1 offset:61440
    s_add_u32 s22, s31, 4096
    buffer_load_dwordx4 v[80:83], v1, s[4:7], s22 offen offset:0 sc1
    s_waitcnt lgkmcnt(6)
    v_mfma_f32_16x16x32_bf16 v[24:27], v[248:251], v[136:139], v[24:27]
    ds_read_b128 v[244:247], v1 offset:62464
    s_waitcnt lgkmcnt(6)
    v_mfma_f32_16x16x32_bf16 v[28:31], v[252:255], v[136:139], v[28:31]
    ds_read_b128 v[248:251], v1 offset:63488
    s_waitcnt lgkmcnt(6)
    v_mfma_f32_16x16x32_bf16 v[208:211], v[224:227], v[144:147], v[208:211]
    ds_read_b128 v[252:255], v1 offset:64512
    s_waitcnt lgkmcnt(6)
    v_mfma_f32_16x16x32_bf16 v[212:215], v[228:231], v[144:147], v[212:215]
    buffer_load_dwordx4 v[84:87], v1, s[4:7], s22 offen offset:1024 sc1
    s_waitcnt lgkmcnt(5)
    v_mfma_f32_16x16x32_bf16 v[216:219], v[232:235], v[144:147], v[216:219]
    s_waitcnt lgkmcnt(4)
    v_mfma_f32_16x16x32_bf16 v[220:223], v[236:239], v[144:147], v[220:223]
    s_waitcnt lgkmcnt(3)
    v_mfma_f32_16x16x32_bf16 v[16:19], v[240:243], v[152:155], v[16:19]
    s_waitcnt lgkmcnt(2)
    v_mfma_f32_16x16x32_bf16 v[20:23], v[244:247], v[152:155], v[20:23]
    s_waitcnt lgkmcnt(1)
    v_mfma_f32_16x16x32_bf16 v[24:27], v[248:251], v[152:155], v[24:27]
    s_waitcnt lgkmcnt(0)
    v_mfma_f32_16x16x32_bf16 v[28:31], v[252:255], v[152:155], v[28:31]
    s_branch X3E
X3B:
    ds_read_b128 v[224:227], v1 offset:0
    ds_read_b128 v[228:231], v1 offset:1024
    ds_read_b128 v[232:235], v1 offset:2048
    ds_read_b128 v[236:239], v1 offset:3072
    ds_read_b128 v[240:243], v1 offset:4096
    ds_read_b128 v[244:247], v1 offset:5120
    ds_read_b128 v[248:251], v1 offset:6144
    s_waitcnt lgkmcnt(6)
    v_mfma_f32_16x16x32_bf16 v[208:211], v[224:227], v[36:39], v[208:211]
    ds_read_b128 v[252:255], v1 offset:7168
    s_waitcnt lgkmcnt(6)
    v_mfma_f32_16x16x32_bf16 v[212:215], v[228:231], v[36:39], v[212:215]
    ds_read_b128 v[224:227], v1 offset:8192
    s_waitcnt lgkmcnt(6)
    v_mfma_f32_16x16x32_bf16 v[216:219], v[232:235], v[36:39], v[216:219]
    ds_read_b128 v[228:231], v1 offset:9216
    s_waitcnt lgkmcnt(6)
    v_mfma_f32_16x16x32_bf16 v[220:223], v[236:239], v[36:39], v[220:223]
    ds_read_b128 v[232:235], v1 offset:10240
    s_waitcnt lgkmcnt(6)
    v_mfma_f32_16x16x32_bf16 v[16:19], v[240:243], v[44:47], 0
    ds_read_b128 v[236:239], v1 offset:11264
    s_waitcnt lgkmcnt(6)
    v_mfma_f32_16x16x32_bf16 v[20:23], v[244:247], v[44:47], 0
    ds_read_b128 v[240:243], v1 offset:12288
    s_waitcnt vmcnt(2)
    v_cmp_ne_u32 vcc, s48, v2
    s_cbranch_vccz GO11
    s_mov_b32 s25, 0
POLL11:
    s_mov_b64 exec, vcc
    buffer_load_dword v2, v11, s[4:7], s24 offen sc1
    s_add_u32 s25, s25, 1
    s_waitcnt vmcnt(0)
    v_cmp_ne_u32 vcc, s48, v2
    s_cmp_lt_u32 s25, 0x8000
    s_cselect_b64 vcc, vcc, 0
    s_cbranch_vccnz POLL11
    s_mov_b64 exec, -1
GO11:
    s_add_u32 s22, s30, 0
    buffer_load_dwordx4 v[32:35], v1, s[4:7], s22 offen offset:0 sc1
    s_waitcnt lgkmcnt(6)
    v_mfma_f32_16x16x32_bf16 v[24:27], v[248:251], v[44:47], 0
    ds_read_b128 v[244:247], v1 offset:13312
    s_waitcnt lgkmcnt(6)
    v_mfma_f32_16x16x32_bf16 v[28:31], v[252:255], v[44:47], 0
    ds_read_b128 v[248:251], v1 offset:14336
    s_waitcnt lgkmcnt(6)
    v_mfma_f32_16x16x32_bf16 v[208:211], v[224:227], v[52:55], v[208:211]
    ds_read_b128 v[252:255], v1 offset:15360
    s_waitcnt lgkmcnt(6)
    v_mfma_f32_16x16x32_bf16 v[212:215], v[228:231], v[52:55], v[212:215]
    ds_read_b128 v[224:227], v1 offset:16384
    buffer_load_dwordx4 v[36:39], v1, s[4:7], s22 offen offset:1024 sc1
    s_waitcnt lgkmcnt(6)
    v_mfma_f32_16x16x32_bf16 v[216:219], v[232:235], v[52:55], v[216:219]
    ds_read_b128 v[228:231], v1 offset:17408
    s_waitcnt lgkmcnt(6)
    v_mfma_f32_16x16x32_bf16 v[220:223], v[236:239], v[52:55], v[220:223]
    ds_read_b128 v[232:235], v1 offset:18432
    s_waitcnt lgkmcnt(6)
    v_mfma_f32_16x16x32_bf16 v[16:19], v[240:243], v[60:63], v[16:19]
    ds_read_b128 v[236:239], v1 offset:19456
    s_waitcnt lgkmcnt(6)
    v_mfma_f32_16x16x32_bf16 v[20:23], v[244:247], v[60:63], v[20:23]
    ds_read_b128 v[240:243], v1 offset:20480
    buffer_load_dwordx4 v[40:43], v1, s[4:7], s22 offen offset:2048 sc1
    s_waitcnt lgkmcnt(6)
    v_mfma_f32_16x16x32_bf16 v[24:27], v[248:251], v[60:63], v[24:27]
    ds_read_b128 v[244:247], v1 offset:21504
    s_waitcnt lgkmcnt(6)
    v_mfma_f32_16x16x32_bf16 v[28:31], v[252:255], v[60:63], v[28:31]
    ds_read_b128 v[248:251], v1 offset:22528
    s_waitcnt lgkmcnt(6)
    v_mfma_f32_16x16x32_bf16 v[208:211], v[224:227], v[68:71], v[208:211]
    ds_read_b128 v[252:255], v1 offset:23552
    s_waitcnt lgkmcnt(6)
    v_mfma_f32_16x16x32_bf16 v[212:215], v[228:231], v[68:71], v[212:215]
    ds_read_b128 v[224:227], v1 offset:24576
    buffer_load_dwordx4 v[44:47], v1, s[4:7], s22 offen offset:3072 sc1
    s_waitcnt lgkmcnt(6)
    v_mfma_f32_16x16x32_bf16 v[216:219], v[232:235], v[68:71], v[216:219]
    ds_read_b128 v[228:231], v1 offset:25600
    s_waitcnt lgkmcnt(6)
    v_mfma_f32_16x16x32_bf16 v[220:223], v[236:239], v[68:71], v[220:223]
    ds_read_b128 v[232:235], v1 offset:26624
    s_waitcnt lgkmcnt(6)
    v_mfma_f32_16x16x32_bf16 v[16:19], v[240:243], v[76:79], v[16:19]
    ds_read_b128 v[236:239], v1 offset:27648
    s_waitcnt lgkmcnt(6)
    v_mfma_f32_16x16x32_bf16 v[20:23], v[244:247], v[76:79], v[20:23]
    ds_read_b128 v[240:243], v1 offset:28672
    s_add_u32 s22, s30, 4096
    buffer_load_dwordx4 v[48:51], v1, s[4:7], s22 offen offset:0 sc1
    s_waitcnt lgkmcnt(6)
    v_mfma_f32_16x16x32_bf16 v[24:27], v[248:251], v[76:79], v[24:27]
    ds_read_b128 v[244:247], v1 offset:29696
    s_waitcnt lgkmcnt(6)
    v_mfma_f32_16x16x32_bf16 v[28:31], v[252:255], v[76:79], v[28:31]
    ds_read_b128 v[248:251], v1 offset:30720
    s_waitcnt lgkmcnt(6)
    v_mfma_f32_16x16x32_bf16 v[208:211], v[224:227], v[84:87], v[208:211]
    ds_read_b128 v[252:255], v1 offset:31744
    s_waitcnt lgkmcnt(6)
    v_mfma_f32_16x16x32_bf16 v[212:215], v[228:231], v[84:87], v[212:215]
    ds_read_b128 v[224:227], v1 offset:32768
    buffer_load_dwordx4 v[52:55], v1, s[4:7], s22 offen offset:1024 sc1
    s_waitcnt lgkmcnt(6)
    v_mfma_f32_16x16x32_bf16 v[216:219], v[232:235], v[84:87], v[216:219]
    ds_read_b128 v[228:231], v1 offset:33792
    s_waitcnt lgkmcnt(6)
    v_mfma_f32_16x16x32_bf16 v[220:223], v[236:239], v[84:87], v[220:223]
    ds_read_b128 v[232:235], v1 offset:34816
    s_waitcnt lgkmcnt(6)
    v_mfma_f32_16x16x32_bf16 v[16:19], v[240:243], v[92:95], v[16:19]
    ds_read_b128 v[236:239], v1 offset:35840
    s_waitcnt lgkmcnt(6)
    v_mfma_f32_16x16x32_bf16 v[20:23], v[244:247], v[92:95], v[20:23]
    ds_read_b128 v[240:243], v1 offset:36864
    buffer_load_dwordx4 v[56:59], v1, s[4:7], s22 offen offset:2048 sc1
    s_waitcnt lgkmcnt(6)
    v_mfma_f32_16x16x32_bf16 v[24:27], v[248:251], v[92:95], v[24:27]
    ds_read_b128 v[244:247], v1 offset:37888
    s_waitcnt lgkmcnt(6)
    v_mfma_f32_16x16x32_bf16 v[28:31], v[252:255], v[92:95], v[28:31]
    ds_read_b128 v[248:251], v1 offset:38912
    s_waitcnt lgkmcnt(6)
    v_mfma_f32_16x16x32_bf16 v[208:211], v[224:227], v[100:103], v[208:211]
    ds_read_b128 v[252:255], v1 offset:39936
    s_waitcnt lgkmcnt(6)
    v_mfma_f32_16x16x32_bf16 v[212:215], v[228:231], v[100:103], v[212:215]
    ds_read_b128 v[224:227], v1 offset:40960
    buffer_load_dwordx4 v[60:63], v1, s[4:7], s22 offen offset:3072 sc1
    s_waitcnt lgkmcnt(6)
    v_mfma_f32_16x16x32_bf16 v[216:219], v[232:235], v[100:103], v[216:219]
    ds_read_b128 v[228:231], v1 offset:41984
    s_waitcnt lgkmcnt(6)
    v_mfma_f32_16x16x32_bf16 v[220:223], v[236:239], v[100:103], v[220:223]
    ds_read_b128 v[232:235], v1 offset:43008
    s_waitcnt lgkmcnt(6)
    v_mfma_f32_16x16x32_bf16 v[16:19], v[240:243], v[108:111], v[16:19]
    ds_read_b128 v[236:239], v1 offset:44032
    s_waitcnt lgkmcnt(6)
    v_mfma_f32_16x16x32_bf16 v[20:23], v[244:247], v[108:111], v[20:23]
    ds_read_b128 v[240:243], v1 offset:45056
    s_add_u32 s22, s31, 0
    buffer_load_dwordx4 v[64:67], v1, s[4:7], s22 offen offset:0 sc1
    s_waitcnt lgkmcnt(6)
    v_mfma_f32_16x16x32_bf16 v[24:27], v[248:251], v[108:111], v[24:27]
    ds_read_b128 v[244:247], v1 offset:46080
    s_waitcnt lgkmcnt(6)
    v_mfma_f32_16x16x32_bf16 v[28:31], v[252:255], v[108:111], v[28:31]
    ds_read_b128 v[248:251], v1 offset:47104
    s_waitcnt lgkmcnt(6)
    v_mfma_f32_16x16x32_bf16 v[208:211], v[224:227], v[116:119], v[208:211]
    ds_read_b128 v[252:255], v1 offset:48128
    s_waitcnt lgkmcnt(6)
    v_mfma_f32_16x16x32_bf16 v[212:215], v[228:231], v[116:119], v[212:215]
    ds_read_b128 v[224:227], v1 offset:49152
    buffer_load_dwordx4 v[68:71], v1, s[4:7], s22 offen offset:1024 sc1
    s_waitcnt lgkmcnt(6)
    v_mfma_f32_16x16x32_bf16 v[216:219], v[232:235], v[116:119], v[216:219]
    ds_read_b128 v[228:231], v1 offset:50176
    s_waitcnt lgkmcnt(6)
    v_mfma_f32_16x16x32_bf16 v[220:223], v[236:239], v[116:119], v[220:223]
    ds_read_b128 v[232:235], v1 offset:51200
    s_waitcnt lgkmcnt(6)
    v_mfma_f32_16x16x32_bf16 v[16:19], v[240:243], v[124:127], v[16:19]
    ds_read_b128 v[236:239], v1 offset:52224
    s_waitcnt vmcnt(10)
    s_mov_b32 exec_hi, 0
    buffer_store_dword v3, v4, s[4:7], s23 offen sc1
    s_mov_b64 exec, -1
    s_waitcnt lgkmcnt(6)
    v_mfma_f32_16x16x32_bf16 v[20:23], v[244:247], v[124:127], v[20:23]
    ds_read_b128 v[240:243], v1 offset:53248
    buffer_load_dwordx4 v[72:75], v1, s[4:7], s22 offen offset:2048 sc1
    s_waitcnt lgkmcnt(6)
    v_mfma_f32_16x16x32_bf16 v[24:27], v[248:251], v[124:127], v[24:27]
    ds_read_b128 v[244:247], v1 offset:54272
    s_waitcnt lgkmcnt(6)
    v_mfma_f32_16x16x32_bf16 v[28:31], v[252:255], v[124:127], v[28:31]
    ds_read_b128 v[248:251], v1 offset:55296
    s_waitcnt lgkmcnt(6)
    v_mfma_f32_16x16x32_bf16 v[208:211], v[224:227], v[132:135], v[208:211]
    ds_read_b128 v[252:255], v1 offset:56320
    s_waitcnt lgkmcnt(6)
    v_mfma_f32_16x16x32_bf16 v[212:215], v[228:231], v[132:135], v[212:215]
    ds_read_b128 v[224:227], v1 offset:57344
    buffer_load_dwordx4 v[76:79], v1, s[4:7], s22 offen offset:3072 sc1
    s_waitcnt lgkmcnt(6)
    v_mfma_f32_16x16x32_bf16 v[216:219], v[232:235], v[132:135], v[216:219]
    ds_read_b128 v[228:231], v1 offset:58368
    s_waitcnt lgkmcnt(6)
    v_mfma_f32_16x16x32_bf16 v[220:223], v[236:239], v[132:135], v[220:223]
    ds_read_b128 v[232:235], v1 offset:59392
    s_waitcnt lgkmcnt(6)
    v_mfma_f32_16x16x32_bf16 v[16:19], v[240:243], v[140:143], v[16:19]
    ds_read_b128 v[236:239], v1 offset:60416
    s_waitcnt lgkmcnt(6)
    v_mfma_f32_16x16x32_bf16 v[20:23], v[244:247], v[140:143], v[20:23]
    ds_read_b128 v[240:243], v1 offset:61440
    s_add_u32 s22, s31, 4096
    buffer_load_dwordx4 v[80:83], v1, s[4:7], s22 offen offset:0 sc1
    s_waitcnt lgkmcnt(6)
    v_mfma_f32_16x16x32_bf16 v[24:27], v[248:251], v[140:143], v[24:27]
    ds_read_b128 v[244:247], v1 offset:62464
    s_waitcnt lgkmcnt(6)
    v_mfma_f32_16x16x32_bf16 v[28:31], v[252:255], v[140:143], v[28:31]
    ds_read_b128 v[248:251], v1 offset:63488
    s_waitcnt lgkmcnt(6)
    v_mfma_f32_16x16x32_bf16 v[208:211], v[224:227], v[148:151], v[208:211]
    ds_read_b128 v[252:255], v1 offset:64512
    s_waitcnt lgkmcnt(6)
    v_mfma_f32_16x16x32_bf16 v[212:215], v[228:231], v[148:151], v[212:215]
    buffer_load_dwordx4 v[84:87], v1, s[4:7], s22 offen offset:1024 sc1
    s_waitcnt lgkmcnt(5)
    v_mfma_f32_16x16x32_bf16 v[216:219], v[232:235], v[148:151], v[216:219]
    s_waitcnt lgkmcnt(4)
    v_mfma_f32_16x16x32_bf16 v[220:223], v[236:239], v[148:151], v[220:223]
    s_waitcnt lgkmcnt(3)
    v_mfma_f32_16x16x32_bf16 v[16:19], v[240:243], v[156:159], v[16:19]
    s_waitcnt lgkmcnt(2)
    v_mfma_f32_16x16x32_bf16 v[20:23], v[244:247], v[156:159], v[20:23]
    s_waitcnt lgkmcnt(1)
    v_mfma_f32_16x16x32_bf16 v[24:27], v[248:251], v[156:159], v[24:27]
    s_waitcnt lgkmcnt(0)
    v_mfma_f32_16x16x32_bf16 v[28:31], v[252:255], v[156:159], v[28:31]
X3E:
    s_add_u32 s24, s24, 131072
    s_waitcnt vmcnt(14)
    v_mfma_f32_16x16x32_bf16 v[160:163], a[0:3], v[32:35], 0
    s_waitcnt vmcnt(13)
    v_mfma_f32_16x16x32_bf16 v[160:163], a[16:19], v[36:39], v[160:163]
    buffer_load_dwordx4 v[88:91], v1, s[4:7], s22 offen offset:2048 sc1
    v_mfma_f32_16x16x32_bf16 v[164:167], a[4:7], v[32:35], 0
    v_mfma_f32_16x16x32_bf16 v[164:167], a[20:23], v[36:39], v[164:167]
    v_mfma_f32_16x16x32_bf16 v[168:171], a[8:11], v[32:35], 0
    v_mfma_f32_16x16x32_bf16 v[168:171], a[24:27], v[36:39], v[168:171]
    buffer_load_dwordx4 v[92:95], v1, s[4:7], s22 offen offset:3072 sc1
    v_mfma_f32_16x16x32_bf16 v[172:175], a[12:15], v[32:35], 0
    v_mfma_f32_16x16x32_bf16 v[172:175], a[28:31], v[36:39], v[172:175]
    s_waitcnt vmcnt(14)
    v_mfma_f32_16x16x32_bf16 v[160:163], a[32:35], v[40:43], v[160:163]
    s_cmp_ge_u32 s15, 4
    s_cselect_b32 s28, -1.0, 1.0
    s_waitcnt vmcnt(13)
    v_mfma_f32_16x16x32_bf16 v[160:163], a[48:51], v[44:47], v[160:163]
    s_add_u32 s22, s32, 0
    buffer_load_dwordx4 v[96:99], v1, s[4:7], s22 offen offset:0 sc1
    v_mfma_f32_16x16x32_bf16 v[164:167], a[36:39], v[40:43], v[164:167]
    v_fmac_f32 v208, s28, v16
    v_fmac_f32 v209, s28, v17
    v_mfma_f32_16x16x32_bf16 v[164:167], a[52:55], v[44:47], v[164:167]
    v_mfma_f32_16x16x32_bf16 v[168:171], a[40:43], v[40:43], v[168:171]
    v_fmac_f32 v210, s28, v18
    v_fmac_f32 v211, s28, v19
    v_mfma_f32_16x16x32_bf16 v[168:171], a[56:59], v[44:47], v[168:171]
    buffer_load_dwordx4 v[100:103], v1, s[4:7], s22 offen offset:1024 sc1
    v_mfma_f32_16x16x32_bf16 v[172:175], a[44:47], v[40:43], v[172:175]
    v_fmac_f32 v212, s28, v20
    v_fmac_f32 v213, s28, v21
    v_mfma_f32_16x16x32_bf16 v[172:175], a[60:63], v[44:47], v[172:175]
    s_waitcnt vmcnt(14)
    v_mfma_f32_16x16x32_bf16 v[160:163], a[64:67], v[48:51], v[160:163]
    v_fmac_f32 v214, s28, v22
    v_fmac_f32 v215, s28, v23
    s_waitcnt vmcnt(13)
    v_mfma_f32_16x16x32_bf16 v[160:163], a[80:83], v[52:55], v[160:163]
    buffer_load_dwordx4 v[104:107], v1, s[4:7], s22 offen offset:2048 sc1
    v_mfma_f32_16x16x32_bf16 v[164:167], a[68:71], v[48:51], v[164:167]
    v_fmac_f32 v216, s28, v24
    v_fmac_f32 v217, s28, v25
    v_mfma_f32_16x16x32_bf16 v[164:167], a[84:87], v[52:55], v[164:167]
    v_mfma_f32_16x16x32_bf16 v[168:171], a[72:75], v[48:51], v[168:171]
    v_fmac_f32 v218, s28, v26
    v_fmac_f32 v219, s28, v27
    v_mfma_f32_16x16x32_bf16 v[168:171], a[88:91], v[52:55], v[168:171]
    buffer_load_dwordx4 v[108:111], v1, s[4:7], s22 offen offset:3072 sc1
    v_mfma_f32_16x16x32_bf16 v[172:175], a[76:79], v[48:51], v[172:175]
    v_fmac_f32 v220, s28, v28
    v_fmac_f32 v221, s28, v29
    v_mfma_f32_16x16x32_bf16 v[172:175], a[92:95], v[52:55], v[172:175]
    s_waitcnt vmcnt(14)
    v_mfma_f32_16x16x32_bf16 v[160:163], a[96:99], v[56:59], v[160:163]
    v_fmac_f32 v222, s28, v30
    v_fmac_f32 v223, s28, v31
    s_waitcnt vmcnt(13)
    v_mfma_f32_16x16x32_bf16 v[160:163], a[112:115], v[60:63], v[160:163]
    s_add_u32 s22, s32, 4096
    buffer_load_dwordx4 v[112:115], v1, s[4:7], s22 offen offset:0 sc1
    v_mfma_f32_16x16x32_bf16 v[164:167], a[100:103], v[56:59], v[164:167]
    v_mfma_f32_16x16x32_bf16 v[164:167], a[116:119], v[60:63], v[164:167]
    v_mfma_f32_16x16x32_bf16 v[168:171], a[104:107], v[56:59], v[168:171]
    v_mfma_f32_16x16x32_bf16 v[168:171], a[120:123], v[60:63], v[168:171]
    buffer_load_dwordx4 v[116:119], v1, s[4:7], s22 offen offset:1024 sc1
    v_mfma_f32_16x16x32_bf16 v[172:175], a[108:111], v[56:59], v[172:175]
    v_mfma_f32_16x16x32_bf16 v[172:175], a[124:127], v[60:63], v[172:175]
    s_waitcnt vmcnt(14)
    v_mfma_f32_16x16x32_bf16 v[176:179], a[0:3], v[64:67], 0
    s_waitcnt vmcnt(13)
    v_mfma_f32_16x16x32_bf16 v[176:179], a[16:19], v[68:71], v[176:179]
    buffer_load_dwordx4 v[120:123], v1, s[4:7], s22 offen offset:2048 sc1
    v_mfma_f32_16x16x32_bf16 v[180:183], a[4:7], v[64:67], 0
    v_mfma_f32_16x16x32_bf16 v[180:183], a[20:23], v[68:71], v[180:183]
    v_mfma_f32_16x16x32_bf16 v[184:187], a[8:11], v[64:67], 0
    v_mfma_f32_16x16x32_bf16 v[184:187], a[24:27], v[68:71], v[184:187]
    buffer_load_dwordx4 v[124:127], v1, s[4:7], s22 offen offset:3072 sc1
    v_mfma_f32_16x16x32_bf16 v[188:191], a[12:15], v[64:67], 0
    v_mfma_f32_16x16x32_bf16 v[188:191], a[28:31], v[68:71], v[188:191]
    s_waitcnt vmcnt(13)
    v_mfma_f32_16x16x32_bf16 v[176:179], a[32:35], v[72:75], v[176:179]
    s_waitcnt vmcnt(12)
    v_mfma_f32_16x16x32_bf16 v[176:179], a[48:51], v[76:79], v[176:179]
    s_add_u32 s22, s33, 0
    buffer_load_dwordx4 v[128:131], v1, s[4:7], s22 offen offset:0 sc1
    v_mfma_f32_16x16x32_bf16 v[180:183], a[36:39], v[72:75], v[180:183]
    v_mfma_f32_16x16x32_bf16 v[180:183], a[52:55], v[76:79], v[180:183]
    buffer_load_dword v2, v11, s[4:7], s24 offen sc1
    v_mfma_f32_16x16x32_bf16 v[184:187], a[40:43], v[72:75], v[184:187]
    v_mfma_f32_16x16x32_bf16 v[184:187], a[56:59], v[76:79], v[184:187]
    buffer_load_dwordx4 v[132:135], v1, s[4:7], s22 offen offset:1024 sc1
    v_mfma_f32_16x16x32_bf16 v[188:191], a[44:47], v[72:75], v[188:191]
    v_mfma_f32_16x16x32_bf16 v[188:191], a[60:63], v[76:79], v[188:191]
    s_waitcnt vmcnt(14)
    v_mfma_f32_16x16x32_bf16 v[176:179], a[64:67], v[80:83], v[176:179]
    s_waitcnt vmcnt(13)
    v_mfma_f32_16x16x32_bf16 v[176:179], a[80:83], v[84:87], v[176:179]
    buffer_load_dwordx4 v[136:139], v1, s[4:7], s22 offen offset:2048 sc1
    v_mfma_f32_16x16x32_bf16 v[180:183], a[68:71], v[80:83], v[180:183]
    v_mfma_f32_16x16x32_bf16 v[180:183], a[84:87], v[84:87], v[180:183]
    v_mfma_f32_16x16x32_bf16 v[184:187], a[72:75], v[80:83], v[184:187]
    v_mfma_f32_16x16x32_bf16 v[184:187], a[88:91], v[84:87], v[184:187]
    buffer_load_dwordx4 v[140:143], v1, s[4:7], s22 offen offset:3072 sc1
    v_mfma_f32_16x16x32_bf16 v[188:191], a[76:79], v[80:83], v[188:191]
    v_mfma_f32_16x16x32_bf16 v[188:191], a[92:95], v[84:87], v[188:191]
    s_waitcnt vmcnt(14)
    v_mfma_f32_16x16x32_bf16 v[176:179], a[96:99], v[88:91], v[176:179]
    s_waitcnt vmcnt(13)
    v_mfma_f32_16x16x32_bf16 v[176:179], a[112:115], v[92:95], v[176:179]
    s_add_u32 s22, s33, 4096
    buffer_load_dwordx4 v[144:147], v1, s[4:7], s22 offen offset:0 sc1
    v_mfma_f32_16x16x32_bf16 v[180:183], a[100:103], v[88:91], v[180:183]
    v_mfma_f32_16x16x32_bf16 v[180:183], a[116:119], v[92:95], v[180:183]
    v_mfma_f32_16x16x32_bf16 v[184:187], a[104:107], v[88:91], v[184:187]
    v_mfma_f32_16x16x32_bf16 v[184:187], a[120:123], v[92:95], v[184:187]
    buffer_load_dwordx4 v[148:151], v1, s[4:7], s22 offen offset:1024 sc1
    v_mfma_f32_16x16x32_bf16 v[188:191], a[108:111], v[88:91], v[188:191]
    v_mfma_f32_16x16x32_bf16 v[188:191], a[124:127], v[92:95], v[188:191]
    s_waitcnt vmcnt(14)
    v_mfma_f32_16x16x32_bf16 v[192:195], a[0:3], v[96:99], 0
    s_waitcnt vmcnt(13)
    v_mfma_f32_16x16x32_bf16 v[192:195], a[16:19], v[100:103], v[192:195]
    buffer_load_dwordx4 v[152:155], v1, s[4:7], s22 offen offset:2048 sc1
    v_mfma_f32_16x16x32_bf16 v[196:199], a[4:7], v[96:99], 0
    v_mfma_f32_16x16x32_bf16 v[196:199], a[20:23], v[100:103], v[196:199]
    v_mfma_f32_16x16x32_bf16 v[200:203], a[8:11], v[96:99], 0
    v_mfma_f32_16x16x32_bf16 v[200:203], a[24:27], v[100:103], v[200:203]
    buffer_load_dwordx4 v[156:159], v1, s[4:7], s22 offen offset:3072 sc1
    v_mfma_f32_16x16x32_bf16 v[204:207], a[12:15], v[96:99], 0
    v_mfma_f32_16x16x32_bf16 v[204:207], a[28:31], v[100:103], v[204:207]
    s_waitcnt vmcnt(14)
    v_mfma_f32_16x16x32_bf16 v[192:195], a[32:35], v[104:107], v[192:195]
    s_waitcnt vmcnt(13)
    v_mfma_f32_16x16x32_bf16 v[192:195], a[48:51], v[108:111], v[192:195]
    s_waitcnt vmcnt(7)
    v_cmp_ne_u32 vcc, s48, v2
    s_cbranch_vccz GO12
    s_mov_b32 s25, 0
POLL12:
    s_mov_b64 exec, vcc
    buffer_load_dword v2, v11, s[4:7], s24 offen sc1
    s_add_u32 s25, s25, 1
    s_waitcnt vmcnt(0)
    v_cmp_ne_u32 vcc, s48, v2
    s_cmp_lt_u32 s25, 0x8000
    s_cselect_b64 vcc, vcc, 0
    s_cbranch_vccnz POLL12
    s_mov_b64 exec, -1
GO12:
    s_add_u32 s22, s30, 8192
    buffer_load_dwordx4 v[32:35], v1, s[4:7], s22 offen offset:0 sc1
    v_mfma_f32_16x16x32_bf16 v[196:199], a[36:39], v[104:107], v[196:199]
    v_mfma_f32_16x16x32_bf16 v[196:199], a[52:55], v[108:111], v[196:199]
    v_mfma_f32_16x16x32_bf16 v[200:203], a[40:43], v[104:107], v[200:203]
    v_mfma_f32_16x16x32_bf16 v[200:203], a[56:59], v[108:111], v[200:203]
    buffer_load_dwordx4 v[36:39], v1, s[4:7], s22 offen offset:1024 sc1
    v_mfma_f32_16x16x32_bf16 v[204:207], a[44:47], v[104:107], v[204:207]
    v_add_u32 v7, s16, v1
    v_mfma_f32_16x16x32_bf16 v[204:207], a[60:63], v[108:111], v[204:207]
    v_mfma_f32_16x16x32_bf16 v[192:195], a[64:67], v[112:115], v[192:195]
    s_xor_b32 s25, s3, 1
    s_mul_i32 s25, s25, 12288
    v_mfma_f32_16x16x32_bf16 v[192:195], a[80:83], v[116:119], v[192:195]
    buffer_load_dwordx4 v[40:43], v1, s[4:7], s22 offen offset:2048 sc1
    v_mfma_f32_16x16x32_bf16 v[196:199], a[68:71], v[112:115], v[196:199]
    s_add_u32 s25, s25, 122880
    v_add_u32 v240, s25, v1
    v_mfma_f32_16x16x32_bf16 v[196:199], a[84:87], v[116:119], v[196:199]
    v_mfma_f32_16x16x32_bf16 v[200:203], a[72:75], v[112:115], v[200:203]
    s_xor_b32 s25, s3, 2
    s_mul_i32 s25, s25, 12288
    v_mfma_f32_16x16x32_bf16 v[200:203], a[88:91], v[116:119], v[200:203]
    buffer_load_dwordx4 v[44:47], v1, s[4:7], s22 offen offset:3072 sc1
    v_mfma_f32_16x16x32_bf16 v[204:207], a[76:79], v[112:115], v[204:207]
    s_add_u32 s25, s25, 118784
    v_add_u32 v241, s25, v1
    v_mfma_f32_16x16x32_bf16 v[204:207], a[92:95], v[116:119], v[204:207]
    v_mfma_f32_16x16x32_bf16 v[192:195], a[96:99], v[120:123], v[192:195]
    s_xor_b32 s25, s3, 3
    s_mul_i32 s25, s25, 12288
    v_mfma_f32_16x16x32_bf16 v[192:195], a[112:115], v[124:127], v[192:195]
    s_add_u32 s22, s30, 12288
    buffer_load_dwordx4 v[48:51], v1, s[4:7], s22 offen offset:0 sc1
    v_mfma_f32_16x16x32_bf16 v[196:199], a[100:103], v[120:123], v[196:199]
    s_add_u32 s25, s25, 114688
    v_add_u32_e64 v242, s25, v1
    v_mfma_f32_16x16x32_bf16 v[196:199], a[116:119], v[124:127], v[196:199]
    v_mfma_f32_16x16x32_bf16 v[200:203], a[104:107], v[120:123], v[200:203]
    s_mul_i32 s25, s3, 2304
    s_add_u32 s25, s25, 65536
    v_mfma_f32_16x16x32_bf16 v[200:203], a[120:123], v[124:127], v[200:203]
    buffer_load_dwordx4 v[52:55], v1, s[4:7], s22 offen offset:1024 sc1
    v_mfma_f32_16x16x32_bf16 v[204:207], a[108:111], v[120:123], v[204:207]
    v_and_b32_e64 v16, 15, v0
    v_mul_u32_u24 v16, 144, v16
    v_mfma_f32_16x16x32_bf16 v[204:207], a[124:127], v[124:127], v[204:207]
    v_mfma_f32_16x16x32_bf16 v[208:211], a[0:3], v[128:131], v[208:211]
    v_add3_u32 v243, v16, v6, s25
    v_bfe_u32 v16, v0, 3, 3
    s_waitcnt vmcnt(12)
    v_mfma_f32_16x16x32_bf16 v[208:211], a[16:19], v[132:135], v[208:211]
    s_add_u32 s22, s31, 8192
    buffer_load_dwordx4 v[56:59], v1, s[4:7], s22 offen offset:0 sc1
    v_mfma_f32_16x16x32_bf16 v[212:215], a[4:7], v[128:131], v[212:215]
    v_and_b32 v6, 0x70, v1
    v_mul_u32_u24 v17, 144, v16
    v_mfma_f32_16x16x32_bf16 v[212:215], a[20:23], v[132:135], v[212:215]
    v_mfma_f32_16x16x32_bf16 v[216:219], a[8:11], v[128:131], v[216:219]
    v_add3_u32 v244, v17, v6, s25
    v_lshl_add_u32 v18, v16, 1, s14
    v_mfma_f32_16x16x32_bf16 v[216:219], a[24:27], v[132:135], v[216:219]
    buffer_load_dwordx4 v[60:63], v1, s[4:7], s22 offen offset:1024 sc1
    v_mfma_f32_16x16x32_bf16 v[220:223], a[12:15], v[128:131], v[220:223]
    v_and_b32 v18, 3, v18
    v_lshrrev_b32 v16, 1, v16
    v_mfma_f32_16x16x32_bf16 v[220:223], a[28:31], v[132:135], v[220:223]
    s_waitcnt vmcnt(13)
    v_mfma_f32_16x16x32_bf16 v[208:211], a[32:35], v[136:139], v[208:211]
    v_lshl_add_u32 v16, v18, 5, v16
    v_lshl_add_u32 v5, v16, 10, v6
    s_waitcnt vmcnt(12)
    v_mfma_f32_16x16x32_bf16 v[208:211], a[48:51], v[140:143], v[208:211]
    buffer_load_dwordx4 v[64:67], v1, s[4:7], s22 offen offset:2048 sc1
    v_mfma_f32_16x16x32_bf16 v[212:215], a[36:39], v[136:139], v[212:215]
    s_lshr_b32 s25, s12, 3
    s_and_b32 s17, s12, 2
    v_mfma_f32_16x16x32_bf16 v[212:215], a[52:55], v[140:143], v[212:215]
    v_mfma_f32_16x16x32_bf16 v[216:219], a[40:43], v[136:139], v[216:219]
    s_add_u32 s17, s17, s25
    s_lshl_b32 s17, s17, 9
    v_mfma_f32_16x16x32_bf16 v[216:219], a[56:59], v[140:143], v[216:219]
    buffer_load_dwordx4 v[68:71], v1, s[4:7], s22 offen offset:3072 sc1
    v_mfma_f32_16x16x32_bf16 v[220:223], a[44:47], v[136:139], v[220:223]
    s_and_b32 s25, s12, 1
    s_lshl_b32 s25, s25, 8
    v_mfma_f32_16x16x32_bf16 v[220:223], a[60:63], v[140:143], v[220:223]
    s_waitcnt vmcnt(13)
    v_mfma_f32_16x16x32_bf16 v[208:211], a[64:67], v[144:147], v[208:211]
    s_add_u32 s17, s17, s25
    s_lshr_b32 s25, s3, 1
    s_waitcnt vmcnt(12)
    v_mfma_f32_16x16x32_bf16 v[208:211], a[80:83], v[148:151], v[208:211]
    s_add_u32 s22, s31, 12288
    buffer_load_dwordx4 v[72:75], v1, s[4:7], s22 offen offset:0 sc1
    v_mfma_f32_16x16x32_bf16 v[212:215], a[68:71], v[144:147], v[212:215]
    s_lshl_b32 s25, s25, 7
    s_add_u32 s17, s17, s25
    v_mfma_f32_16x16x32_bf16 v[212:215], a[84:87], v[148:151], v[212:215]
    v_mfma_f32_16x16x32_bf16 v[216:219], a[72:75], v[144:147], v[216:219]
    s_bfe_u32 s25, s12, 0x10002
    s_lshl_b32 s25, s25, 4
    v_mfma_f32_16x16x32_bf16 v[216:219], a[88:91], v[148:151], v[216:219]
    buffer_load_dwordx4 v[76:79], v1, s[4:7], s22 offen offset:1024 sc1
    v_mfma_f32_16x16x32_bf16 v[220:223], a[76:79], v[144:147], v[220:223]
    s_add_u32 s17, s17, s25
    s_and_b32 s25, s3, 1
    v_mfma_f32_16x16x32_bf16 v[220:223], a[92:95], v[148:151], v[220:223]
    s_waitcnt vmcnt(13)
    v_mfma_f32_16x16x32_bf16 v[208:211], a[96:99], v[152:155], v[208:211]
    s_lshl_b32 s25, s25, 3
    s_add_u32 s17, s17, s25
    s_waitcnt vmcnt(12)
    v_mfma_f32_16x16x32_bf16 v[208:211], a[112:115], v[156:159], v[208:211]
    s_add_u32 s22, s32, 8192
    buffer_load_dwordx4 v[80:83], v1, s[4:7], s22 offen offset:0 sc1
    v_mfma_f32_16x16x32_bf16 v[212:215], a[100:103], v[152:155], v[212:215]
    s_lshl_b32 s17, s17, 10
    s_add_u32 s17, s17, s35
    v_mfma_f32_16x16x32_bf16 v[212:215], a[116:119], v[156:159], v[212:215]
    v_mfma_f32_16x16x32_bf16 v[216:219], a[104:107], v[152:155], v[216:219]
    v_mfma_f32_16x16x32_bf16 v[216:219], a[120:123], v[156:159], v[216:219]
    buffer_load_dwordx4 v[84:87], v1, s[4:7], s22 offen offset:1024 sc1
    v_mfma_f32_16x16x32_bf16 v[220:223], a[108:111], v[152:155], v[220:223]
    v_mfma_f32_16x16x32_bf16 v[220:223], a[124:127], v[156:159], v[220:223]
    s_waitcnt vmcnt(13)
    v_mfma_f32_16x16x32_bf16 v[160:163], a[128:131], v[32:35], v[160:163]
    s_waitcnt vmcnt(12)
    v_mfma_f32_16x16x32_bf16 v[160:163], a[144:147], v[36:39], v[160:163]
    buffer_load_dwordx4 v[88:91], v1, s[4:7], s22 offen offset:2048 sc1
    v_mfma_f32_16x16x32_bf16 v[164:167], a[132:135], v[32:35], v[164:167]
    v_mfma_f32_16x16x32_bf16 v[164:167], a[148:151], v[36:39], v[164:167]
    v_mfma_f32_16x16x32_bf16 v[168:171], a[136:139], v[32:35], v[168:171]
    v_mfma_f32_16x16x32_bf16 v[168:171], a[152:155], v[36:39], v[168:171]
    buffer_load_dwordx4 v[92:95], v1, s[4:7], s22 offen offset:3072 sc1
    v_mfma_f32_16x16x32_bf16 v[172:175], a[140:143], v[32:35], v[172:175]
    v_mfma_f32_16x16x32_bf16 v[172:175], a[156:159], v[36:39], v[172:175]
    s_waitcnt vmcnt(13)
    v_mfma_f32_16x16x32_bf16 v[160:163], a[160:163], v[40:43], v[160:163]
    s_waitcnt vmcnt(12)
    v_mfma_f32_16x16x32_bf16 v[160:163], a[176:179], v[44:47], v[160:163]
    s_add_u32 s22, s32, 12288
    buffer_load_dwordx4 v[96:99], v1, s[4:7], s22 offen offset:0 sc1
    v_mfma_f32_16x16x32_bf16 v[164:167], a[164:167], v[40:43], v[164:167]
    v_mfma_f32_16x16x32_bf16 v[164:167], a[180:183], v[44:47], v[164:167]
    v_mfma_f32_16x16x32_bf16 v[168:171], a[168:171], v[40:43], v[168:171]
    v_mfma_f32_16x16x32_bf16 v[168:171], a[184:187], v[44:47], v[168:171]
    buffer_load_dwordx4 v[100:103], v1, s[4:7], s22 offen offset:1024 sc1
    v_mfma_f32_16x16x32_bf16 v[172:175], a[172:175], v[40:43], v[172:175]
    v_mfma_f32_16x16x32_bf16 v[172:175], a[188:191], v[44:47], v[172:175]
    s_waitcnt vmcnt(13)
    v_mfma_f32_16x16x32_bf16 v[160:163], a[192:195], v[48:51], v[160:163]
    s_waitcnt vmcnt(12)
    v_mfma_f32_16x16x32_bf16 v[160:163], a[208:211], v[52:55], v[160:163]
    s_add_u32 s22, s33, 8192
    buffer_load_dwordx4 v[104:107], v1, s[4:7], s22 offen offset:0 sc1
    v_mfma_f32_16x16x32_bf16 v[164:167], a[196:199], v[48:51], v[164:167]
    v_mfma_f32_16x16x32_bf16 v[164:167], a[212:215], v[52:55], v[164:167]
    v_mfma_f32_16x16x32_bf16 v[168:171], a[200:203], v[48:51], v[168:171]
    v_mfma_f32_16x16x32_bf16 v[168:171], a[216:219], v[52:55], v[168:171]
    buffer_load_dwordx4 v[108:111], v1, s[4:7], s22 offen offset:1024 sc1
    v_mfma_f32_16x16x32_bf16 v[172:175], a[204:207], v[48:51], v[172:175]
    v_mfma_f32_16x16x32_bf16 v[172:175], a[220:223], v[52:55], v[172:175]
    s_waitcnt vmcnt(13)
    v_mfma_f32_16x16x32_bf16 v[176:179], a[128:131], v[56:59], v[176:179]
    s_waitcnt vmcnt(12)
    v_mfma_f32_16x16x32_bf16 v[176:179], a[144:147], v[60:63], v[176:179]
    buffer_load_dwordx4 v[112:115], v1, s[4:7], s22 offen offset:2048 sc1
    v_mfma_f32_16x16x32_bf16 v[180:183], a[132:135], v[56:59], v[180:183]
    v_mfma_f32_16x16x32_bf16 v[180:183], a[148:151], v[60:63], v[180:183]
    v_mfma_f32_16x16x32_bf16 v[184:187], a[136:139], v[56:59], v[184:187]
    v_mfma_f32_16x16x32_bf16 v[184:187], a[152:155], v[60:63], v[184:187]
    buffer_load_dwordx4 v[116:119], v1, s[4:7], s22 offen offset:3072 sc1
    v_mfma_f32_16x16x32_bf16 v[188:191], a[140:143], v[56:59], v[188:191]
    ds_write_b128 v7, v[160:163] offset:0
    v_mfma_f32_16x16x32_bf16 v[188:191], a[156:159], v[60:63], v[188:191]
    s_waitcnt vmcnt(13)
    v_mfma_f32_16x16x32_bf16 v[176:179], a[160:163], v[64:67], v[176:179]
    ds_write_b128 v7, v[164:167] offset:1024
    s_waitcnt vmcnt(12)
    v_mfma_f32_16x16x32_bf16 v[176:179], a[176:179], v[68:71], v[176:179]
    s_add_u32 s22, s33, 12288
    buffer_load_dwordx4 v[120:123], v1, s[4:7], s22 offen offset:0 sc1
    v_mfma_f32_16x16x32_bf16 v[180:183], a[164:167], v[64:67], v[180:183]
    ds_write_b128 v7, v[168:171] offset:2048
    v_mfma_f32_16x16x32_bf16 v[180:183], a[180:183], v[68:71], v[180:183]
    v_mfma_f32_16x16x32_bf16 v[184:187], a[168:171], v[64:67], v[184:187]
    ds_write_b128 v7, v[172:175] offset:3072
    v_mfma_f32_16x16x32_bf16 v[184:187], a[184:187], v[68:71], v[184:187]
    buffer_load_dwordx4 v[124:127], v1, s[4:7], s22 offen offset:1024 sc1
    v_mfma_f32_16x16x32_bf16 v[188:191], a[172:175], v[64:67], v[188:191]
    v_mfma_f32_16x16x32_bf16 v[188:191], a[188:191], v[68:71], v[188:191]
    s_waitcnt vmcnt(13)
    v_mfma_f32_16x16x32_bf16 v[176:179], a[192:195], v[72:75], v[176:179]
    s_waitcnt vmcnt(12)
    v_mfma_f32_16x16x32_bf16 v[176:179], a[208:211], v[76:79], v[176:179]
    v_mfma_f32_16x16x32_bf16 v[180:183], a[196:199], v[72:75], v[180:183]
    v_mfma_f32_16x16x32_bf16 v[180:183], a[212:215], v[76:79], v[180:183]
    v_mfma_f32_16x16x32_bf16 v[184:187], a[200:203], v[72:75], v[184:187]
    v_mfma_f32_16x16x32_bf16 v[184:187], a[216:219], v[76:79], v[184:187]
    v_mfma_f32_16x16x32_bf16 v[188:191], a[204:207], v[72:75], v[188:191]
    v_mfma_f32_16x16x32_bf16 v[188:191], a[220:223], v[76:79], v[188:191]
    s_waitcnt vmcnt(11)
    v_mfma_f32_16x16x32_bf16 v[192:195], a[128:131], v[80:83], v[192:195]
    s_waitcnt vmcnt(10)
    v_mfma_f32_16x16x32_bf16 v[192:195], a[144:147], v[84:87], v[192:195]
    v_mfma_f32_16x16x32_bf16 v[196:199], a[132:135], v[80:83], v[196:199]
    v_mfma_f32_16x16x32_bf16 v[196:199], a[148:151], v[84:87], v[196:199]
    v_mfma_f32_16x16x32_bf16 v[200:203], a[136:139], v[80:83], v[200:203]
    v_mfma_f32_16x16x32_bf16 v[200:203], a[152:155], v[84:87], v[200:203]
    v_mfma_f32_16x16x32_bf16 v[204:207], a[140:143], v[80:83], v[204:207]
    ds_write_b128 v7, v[176:179] offset:4096
    v_mfma_f32_16x16x32_bf16 v[204:207], a[156:159], v[84:87], v[204:207]
    s_waitcnt vmcnt(9)
    v_mfma_f32_16x16x32_bf16 v[192:195], a[160:163], v[88:91], v[192:195]
    ds_write_b128 v7, v[180:183] offset:5120
    s_waitcnt vmcnt(8)
    v_mfma_f32_16x16x32_bf16 v[192:195], a[176:179], v[92:95], v[192:195]
    v_mfma_f32_16x16x32_bf16 v[196:199], a[164:167], v[88:91], v[196:199]
    ds_write_b128 v7, v[184:187] offset:6144
    v_mfma_f32_16x16x32_bf16 v[196:199], a[180:183], v[92:95], v[196:199]
    v_mfma_f32_16x16x32_bf16 v[200:203], a[168:171], v[88:91], v[200:203]
    ds_write_b128 v7, v[188:191] offset:7168
    v_mfma_f32_16x16x32_bf16 v[200:203], a[184:187], v[92:95], v[200:203]
    v_mfma_f32_16x16x32_bf16 v[204:207], a[172:175], v[88:91], v[204:207]
    v_mfma_f32_16x16x32_bf16 v[204:207], a[188:191], v[92:95], v[204:207]
    s_waitcnt vmcnt(7)
    v_mfma_f32_16x16x32_bf16 v[192:195], a[192:195], v[96:99], v[192:195]
    s_waitcnt vmcnt(6)
    v_mfma_f32_16x16x32_bf16 v[192:195], a[208:211], v[100:103], v[192:195]
    v_mfma_f32_16x16x32_bf16 v[196:199], a[196:199], v[96:99], v[196:199]
    v_mfma_f32_16x16x32_bf16 v[196:199], a[212:215], v[100:103], v[196:199]
    v_mfma_f32_16x16x32_bf16 v[200:203], a[200:203], v[96:99], v[200:203]
    v_mfma_f32_16x16x32_bf16 v[200:203], a[216:219], v[100:103], v[200:203]
    v_mfma_f32_16x16x32_bf16 v[204:207], a[204:207], v[96:99], v[204:207]
    v_mfma_f32_16x16x32_bf16 v[204:207], a[220:223], v[100:103], v[204:207]
    s_waitcnt vmcnt(5)
    v_mfma_f32_16x16x32_bf16 v[208:211], a[128:131], v[104:107], v[208:211]
    s_waitcnt vmcnt(4)
    v_mfma_f32_16x16x32_bf16 v[208:211], a[144:147], v[108:111], v[208:211]
    v_mfma_f32_16x16x32_bf16 v[212:215], a[132:135], v[104:107], v[212:215]
    v_mfma_f32_16x16x32_bf16 v[212:215], a[148:151], v[108:111], v[212:215]
    v_mfma_f32_16x16x32_bf16 v[216:219], a[136:139], v[104:107], v[216:219]
    v_mfma_f32_16x16x32_bf16 v[216:219], a[152:155], v[108:111], v[216:219]
    ds_write_b128 v7, v[192:195] offset:8192
    v_mfma_f32_16x16x32_bf16 v[220:223], a[140:143], v[104:107], v[220:223]
    ds_write_b128 v7, v[196:199] offset:9216
    v_mfma_f32_16x16x32_bf16 v[220:223], a[156:159], v[108:111], v[220:223]
    ds_write_b128 v7, v[200:203] offset:10240
    s_waitcnt vmcnt(3)
    v_mfma_f32_16x16x32_bf16 v[208:211], a[160:163], v[112:115], v[208:211]
    ds_write_b128 v7, v[204:207] offset:11264
    s_waitcnt vmcnt(2)
    v_mfma_f32_16x16x32_bf16 v[208:211], a[176:179], v[116:119], v[208:211]
    v_mfma_f32_16x16x32_bf16 v[212:215], a[164:167], v[112:115], v[212:215]
    v_mfma_f32_16x16x32_bf16 v[212:215], a[180:183], v[116:119], v[212:215]
    v_mfma_f32_16x16x32_bf16 v[216:219], a[168:171], v[112:115], v[216:219]
    v_mfma_f32_16x16x32_bf16 v[216:219], a[184:187], v[116:119], v[216:219]
    v_mfma_f32_16x16x32_bf16 v[220:223], a[172:175], v[112:115], v[220:223]
    v_mfma_f32_16x16x32_bf16 v[220:223], a[188:191], v[116:119], v[220:223]
    s_waitcnt vmcnt(1)
    v_mfma_f32_16x16x32_bf16 v[208:211], a[192:195], v[120:123], v[208:211]
    s_waitcnt lgkmcnt(0)
    s_barrier
    ds_read_b128 v[32:35], v240 offset:0
    ds_read_b128 v[36:39], v240 offset:1024
    s_waitcnt vmcnt(0)
    v_mfma_f32_16x16x32_bf16 v[208:211], a[208:211], v[124:127], v[208:211]
    ds_read_b128 v[40:43], v240 offset:2048
    ds_read_b128 v[44:47], v240 offset:3072
    v_mfma_f32_16x16x32_bf16 v[212:215], a[196:199], v[120:123], v[212:215]
    ds_read_b128 v[48:51], v241 offset:0
    ds_read_b128 v[52:55], v241 offset:1024
    v_mfma_f32_16x16x32_bf16 v[212:215], a[212:215], v[124:127], v[212:215]
    ds_read_b128 v[56:59], v241 offset:2048
    ds_read_b128 v[60:63], v241 offset:3072
    v_mfma_f32_16x16x32_bf16 v[216:219], a[200:203], v[120:123], v[216:219]
    ds_read_b128 v[64:67], v242 offset:0
    ds_read_b128 v[68:71], v242 offset:1024
    v_mfma_f32_16x16x32_bf16 v[216:219], a[216:219], v[124:127], v[216:219]
    ds_read_b128 v[72:75], v242 offset:2048
    ds_read_b128 v[76:79], v242 offset:3072
    v_mfma_f32_16x16x32_bf16 v[220:223], a[204:207], v[120:123], v[220:223]
    v_mfma_f32_16x16x32_bf16 v[220:223], a[220:223], v[124:127], v[220:223]
    s_waitcnt lgkmcnt(7)
    v_pk_add_f32 v[32:33], v[32:33], v[48:49]
    v_pk_add_f32 v[34:35], v[34:35], v[50:51]
    s_waitcnt lgkmcnt(6)
    v_pk_add_f32 v[36:37], v[36:37], v[52:53]
    v_pk_add_f32 v[38:39], v[38:39], v[54:55]
    s_waitcnt lgkmcnt(5)
    v_pk_add_f32 v[40:41], v[40:41], v[56:57]
    v_pk_add_f32 v[42:43], v[42:43], v[58:59]
    s_waitcnt lgkmcnt(4)
    v_pk_add_f32 v[44:45], v[44:45], v[60:61]
    v_pk_add_f32 v[46:47], v[46:47], v[62:63]
    s_waitcnt lgkmcnt(3)
    v_pk_add_f32 v[32:33], v[32:33], v[64:65]
    v_pk_add_f32 v[34:35], v[34:35], v[66:67]
    s_waitcnt lgkmcnt(2)
    v_pk_add_f32 v[36:37], v[36:37], v[68:69]
    v_pk_add_f32 v[38:39], v[38:39], v[70:71]
    s_waitcnt lgkmcnt(1)
    v_pk_add_f32 v[40:41], v[40:41], v[72:73]
    v_pk_add_f32 v[42:43], v[42:43], v[74:75]
    s_waitcnt lgkmcnt(0)
    v_pk_add_f32 v[44:45], v[44:45], v[76:77]
    v_pk_add_f32 v[46:47], v[46:47], v[78:79]
    v_pk_add_f32 v[208:209], v[208:209], v[32:33]
    v_pk_add_f32 v[210:211], v[210:211], v[34:35]
    v_pk_add_f32 v[212:213], v[212:213], v[36:37]
    v_pk_add_f32 v[214:215], v[214:215], v[38:39]
    v_pk_add_f32 v[216:217], v[216:217], v[40:41]
    v_pk_add_f32 v[218:219], v[218:219], v[42:43]
    v_pk_add_f32 v[220:221], v[220:221], v[44:45]
    v_pk_add_f32 v[222:223], v[222:223], v[46:47]
    v_cvt_pk_bf16_f32 v16, v208, v209
    v_cvt_pk_bf16_f32 v17, v210, v211
    v_cvt_pk_bf16_f32 v18, v212, v213
    v_cvt_pk_bf16_f32 v19, v214, v215
    ds_write_b128 v243, v[16:19] offset:0
    v_cvt_pk_bf16_f32 v20, v216, v217
    v_cvt_pk_bf16_f32 v21, v218, v219
    v_cvt_pk_bf16_f32 v22, v220, v221
    v_cvt_pk_bf16_f32 v23, v222, v223
    ds_write_b128 v243, v[20:23] offset:16
    ds_read_b128 v[24:27], v244 offset:0
    ds_read_b128 v[28:31], v244 offset:1152
    s_add_u32 s19, s17, 4096
    s_waitcnt lgkmcnt(1)
    buffer_store_dwordx4 v[24:27], v5, s[44:47], s17 offen sc1
    s_waitcnt lgkmcnt(0)
    buffer_store_dwordx4 v[28:31], v5, s[44:47], s19 offen sc1
MAIN_END:
    s_endpgm
CODE_END:
.section .rodata,"a"
.p2align 6
.amdhsa_kernel interleave_layers__spectral_gfnet__mixer_channel_mlp__prompt_kernel
  .amdhsa_next_free_vgpr 512
  .amdhsa_next_free_sgpr 54
  .amdhsa_accum_offset 256
  .amdhsa_group_segment_fixed_size 0
  .amdhsa_kernarg_size 88
  .amdhsa_user_sgpr_count 2
  .amdhsa_user_sgpr_kernarg_segment_ptr 1
  .amdhsa_system_sgpr_workgroup_id_x 1
  .amdhsa_float_denorm_mode_32 3
.end_amdhsa_kernel
```
